```python
import torch

def _softmax(x, axis=-1):
    return torch.softmax(x, dim=axis)
def _gelu(x):
    return torch.nn.functional.gelu(x, approximate="tanh")
def _silu(x):
    return torch.nn.functional.silu(x)
def _sigmoid(x):
    return torch.sigmoid(x)
def _layernorm(x, axis=-1, eps=1e-5):
    m = x.mean(dim=axis, keepdim=True)
    v = x.var(dim=axis, keepdim=True, unbiased=False)
    return (x - m) / torch.sqrt(v + eps)
def _scatter_add(tgt, idx, src, axis=0):
    return tgt.clone().index_add_(axis, idx, src)
def _segment_sum(src, seg, n):
    out = torch.zeros((n,) + src.shape[1:], dtype=src.dtype)
    return out.index_add_(0, seg, src)
def _pad(x, pw):
    flat = tuple(v for pair in reversed(pw) for v in pair)
    return torch.nn.functional.pad(x, flat)

kernel_name = 'concat_heads__gqa_block_cached__gqa_block_cached__near_ridge'

def setup_inputs():

    _w = (lambda a: (lambda t: t.to(torch.bfloat16) if t.is_floating_point() else t)(torch.as_tensor(a)))
    def _A_setup():
        B, Sq, D = 8, 144, 512
        Hq, Hkv, Sk, Dh = 32, 32, 1024, 128
        assert Hq % Hkv == 0, (Hq, Hkv)
        return {
            "x": _w((lambda *s: torch.randn(*s, dtype=torch.bfloat16) * 0.8)(B, Sq, D)),
            "k_cache": _w((lambda *s: torch.randn(*s, dtype=torch.bfloat16) * 0.8)(B, Hkv, Sk, Dh)),
            "v_cache": _w((lambda *s: torch.randn(*s, dtype=torch.bfloat16) * 0.05)(B, Hkv, Sk, Dh)),
            "wq": _w((lambda *s: torch.randn(*s, dtype=torch.bfloat16) * 0.8)(D, Hq * Dh) * (D ** -0.5)),
            "wo": _w((lambda *s: torch.randn(*s, dtype=torch.bfloat16) * 0.05)(Hq * Dh, D) * ((Hq * Dh) ** -0.5)),
        }
    _A_in = _A_setup()

    def _B_setup():
        B, Sq, D = 8, 144, 512
        Hq, Hkv, Sk, Dh = 32, 32, 1024, 128
        assert Hq % Hkv == 0, (Hq, Hkv)
        return {
            "x": _w((lambda *s: torch.randn(*s, dtype=torch.bfloat16) * 0.8)(B, Sq, D)),
            "k_cache": _w((lambda *s: torch.randn(*s, dtype=torch.bfloat16) * 0.8)(B, Hkv, Sk, Dh)),
            "v_cache": _w((lambda *s: torch.randn(*s, dtype=torch.bfloat16) * 0.05)(B, Hkv, Sk, Dh)),
            "wq": _w((lambda *s: torch.randn(*s, dtype=torch.bfloat16) * 0.8)(D, Hq * Dh) * (D ** -0.5)),
            "wo": _w((lambda *s: torch.randn(*s, dtype=torch.bfloat16) * 0.05)(Hq * Dh, D) * ((Hq * Dh) ** -0.5)),
        }
    _B_in = _B_setup()

    return {
        "A_x": _A_in["x"],
        "A_k_cache": _A_in["k_cache"],
        "A_v_cache": _A_in["v_cache"],
        "A_wq": _A_in["wq"],
        "A_wo": _A_in["wo"],
        "B_x": _B_in["x"],
        "B_k_cache": _B_in["k_cache"],
        "B_v_cache": _B_in["v_cache"],
        "B_wq": _B_in["wq"],
        "B_wo": _B_in["wo"],
    }

def reference(A_x, A_k_cache, A_v_cache, A_wq, A_wo, B_x, B_k_cache, B_v_cache, B_wq, B_wo):
    def _A_ref(x, k_cache, v_cache, wq, wo):
        B, Sq, D = x.shape
        Hq, Dh = 32, 128
        Hkv = k_cache.shape[1]
        rep = Hq // Hkv
        q = (lambda x, *d: x.permute(*d))((x @ wq).reshape(B, Sq, Hq, Dh), 0, 2, 1, 3)
        k = (lambda x, n, axis: torch.repeat_interleave(x, n, dim=axis))(k_cache, rep, axis=1)
        v = (lambda x, n, axis: torch.repeat_interleave(x, n, dim=axis))(v_cache, rep, axis=1)
        scores = torch.einsum("bhqd,bhkd->bhqk", q, k) * (Dh ** -0.5)
        p = _softmax(scores, axis=-1)
        o = torch.einsum("bhqk,bhkd->bhqd", p, v)
        return (lambda x, *d: x.permute(*d))(o, 0, 2, 1, 3).reshape(B, Sq, Hq * Dh) @ wo

    def _B_ref(x, k_cache, v_cache, wq, wo):
        B, Sq, D = x.shape
        Hq, Dh = 32, 128
        Hkv = k_cache.shape[1]
        rep = Hq // Hkv
        q = (lambda x, *d: x.permute(*d))((x @ wq).reshape(B, Sq, Hq, Dh), 0, 2, 1, 3)
        k = (lambda x, n, axis: torch.repeat_interleave(x, n, dim=axis))(k_cache, rep, axis=1)
        v = (lambda x, n, axis: torch.repeat_interleave(x, n, dim=axis))(v_cache, rep, axis=1)
        scores = torch.einsum("bhqd,bhkd->bhqk", q, k) * (Dh ** -0.5)
        p = _softmax(scores, axis=-1)
        o = torch.einsum("bhqk,bhkd->bhqd", p, v)
        return (lambda x, *d: x.permute(*d))(o, 0, 2, 1, 3).reshape(B, Sq, Hq * Dh) @ wo

    a = _A_ref(A_x, A_k_cache, A_v_cache, A_wq, A_wo)
    b = _B_ref(B_x, B_k_cache, B_v_cache, B_wq, B_wo)
    return torch.concatenate([a, b], axis=-1)
```

```asm
; @launch grid=(256,1,1) block=(256,1,1) lds=163840
.amdgcn_target "amdgcn-amd-amdhsa--gfx950"
.text
.globl concat_heads__gqa_block_cached__gqa_block_cached__near_ridge_kernel
.p2align 8
.type concat_heads__gqa_block_cached__gqa_block_cached__near_ridge_kernel,@function
concat_heads__gqa_block_cached__gqa_block_cached__near_ridge_kernel:
  s_cmp_ge_u32 s2, 256
  s_cbranch_scc1 L_k1_end
  s_load_dwordx16 s[64:79], s[0:1], 0
  s_load_dwordx8 s[80:87], s[0:1], 64
  s_load_dwordx2 s[88:89], s[0:1], 96
  v_lshrrev_b32 v1, 6, v0
  s_nop 0
  v_readfirstlane_b32 s3, v1
  s_getpc_b64 s[90:91]
L_pc:
  s_sub_u32 s90, s90, L_pc-concat_heads__gqa_block_cached__gqa_block_cached__near_ridge_kernel
  s_subb_u32 s91, s91, 0
  s_lshr_b32 s6, s2, 3
  s_lshl_b32 s6, s6, 10
  v_lshlrev_b32 v140, 4, v0
  v_lshl_add_u32 v140, s6, 2, v140
  v_min_u32 v140, L_k1_end-concat_heads__gqa_block_cached__gqa_block_cached__near_ridge_kernel-16, v140
  global_load_dwordx4 v[136:139], v140, s[90:91]
  v_and_b32 v0, 63, v0
  v_mov_b32 v251, 131072
  v_mov_b32 v252, 0
  v_mov_b32 v253, 0
  v_mov_b32 v254, 0
  v_mov_b32 v255, 0
  ds_write_b128 v251, v[252:255] offset:20480
  ds_write_b128 v251, v[252:255] offset:20496
  s_mov_b32 s32, 0
  s_bfe_u32 s8, s2, 65539
  s_bfe_u32 s4, s2, 65538
  s_lshl_b32 s4, s4, 2
  s_bfe_u32 s9, s2, 131076
  s_add_u32 s4, s4, s9
  s_and_b32 s5, s2, 3
  s_lshl_b32 s5, s5, 2
  s_lshr_b32 s10, s2, 6
  s_add_u32 s5, s5, s10
  s_lshl_b32 s10, s10, 1
  s_lshl_b32 s5, s5, 1
  s_mov_b32 s20, 0
  s_and_b32 s11, s9, 1
  s_lshl_b32 s33, s11, 18
  s_lshl_b32 s35, s11, 8
  s_lshl_b32 s37, s11, 12
  s_xor_b32 s11, s11, 1
  s_lshl_b32 s34, s11, 18
  s_lshl_b32 s36, s11, 8
  s_lshl_b32 s38, s11, 12
  v_lshrrev_b32 v13, 4, v0
  v_and_b32 v14, 15, v0
  v_mov_b32 v18, 120
  v_and_b32 v19, 3, v0
  v_bfe_u32 v16, v0, 2, 2
  v_lshlrev_b32 v15, 6, v13
  v_lshl_add_u32 v17, v16, 13, v15
  v_lshl_add_u32 v36, v19, 4, v17
  v_xor_b32 v38, 16, v36
  v_add_u32 v39, 95232, v38
  v_add_u32 v38, 63488, v38
  v_add_u32 v37, 31744, v36
  v_lshl_add_u32 v15, v16, 8, v15
  v_xor_b32 v17, 0, v19
  v_lshl_add_u32 v24, v17, 4, v15
  v_xor_b32 v17, 2, v19
  v_lshl_add_u32 v25, v17, 4, v15
  v_xor_b32 v17, 3, v19
  v_lshl_add_u32 v26, v17, 4, v15
  v_xor_b32 v17, 1, v19
  v_lshl_add_u32 v27, v17, 4, v15
  v_xor_b32 v17, 0, v19
  v_lshl_add_u32 v28, v17, 4, v15
  v_xor_b32 v17, 2, v19
  v_lshl_add_u32 v29, v17, 4, v15
  v_bfe_u32 v16, v0, 2, 3
  v_lshrrev_b32 v15, 5, v0
  v_lshlrev_b32 v15, 6, v15
  v_lshl_add_u32 v16, v16, 10, v15
  v_bfe_u32 v15, v0, 4, 1
  v_add_u32 v15, 0, v15
  v_lshlrev_b32 v15, 1, v15
  v_lshrrev_b32 v15, v15, v18
  v_and_b32 v15, 3, v15
  v_xor_b32 v15, v15, v19
  v_lshl_add_u32 v20, v15, 4, v16
  v_bfe_u32 v15, v0, 4, 1
  v_add_u32 v15, 2, v15
  v_lshlrev_b32 v15, 1, v15
  v_lshrrev_b32 v15, v15, v18
  v_and_b32 v15, 3, v15
  v_xor_b32 v15, v15, v19
  v_lshl_add_u32 v21, v15, 4, v16
  v_add_u32 v22, 14336, v20
  v_add_u32 v23, 21504, v21
  v_add_u32 v21, 7168, v21
  s_waitcnt lgkmcnt(0)
  s_cmp_eq_u32 s8, 1
  s_cselect_b64 s[64:65], s[74:75], s[64:65]
  s_cselect_b64 s[66:67], s[76:77], s[66:67]
  s_cselect_b64 s[68:69], s[78:79], s[68:69]
  s_cselect_b64 s[70:71], s[80:81], s[70:71]
  s_cselect_b64 s[72:73], s[82:83], s[72:73]
  s_mul_i32 s6, s4, 147456
  s_add_u32 s16, s64, s6
  s_addc_u32 s17, s65, 0
  s_mov_b32 s18, 147456
  s_mov_b32 s19, 131072
  s_lshl_b32 s6, s5, 8
  s_sub_u32 s7, 4194304, s6
  s_add_u32 s40, s70, s6
  s_addc_u32 s41, s71, 0
  s_mov_b32 s42, s7
  s_mov_b32 s43, 131072
  s_cmp_eq_u32 s3, 3
  s_cbranch_scc0 L_noearly
  s_add_u32 s22, s20, 0
  s_and_b32 s22, s22, 7
  s_lshl_b32 s22, s22, 7
  s_mov_b32 m0, 114688
  s_nop 0
  buffer_load_dwordx4 v20, s[16:19], s22 offen offset:0 lds
  buffer_load_dwordx4 v21, s[16:19], s22 offen offset:1024 lds
  buffer_load_dwordx4 v22, s[16:19], s22 offen offset:2048 lds
  buffer_load_dwordx4 v23, s[16:19], s22 offen offset:3072 lds
  s_add_u32 s22, s22, 32768
  s_mov_b32 m0, 118784
  s_nop 0
  buffer_load_dwordx4 v20, s[16:19], s22 offen offset:0 lds
  buffer_load_dwordx4 v21, s[16:19], s22 offen offset:1024 lds
  buffer_load_dwordx4 v22, s[16:19], s22 offen offset:2048 lds
  buffer_load_dwordx4 v23, s[16:19], s22 offen offset:3072 lds
  s_add_u32 s22, s22, 32768
  s_mov_b32 m0, 122880
  s_nop 0
  buffer_load_dwordx4 v20, s[16:19], s22 offen offset:0 lds
  buffer_load_dwordx4 v21, s[16:19], s22 offen offset:1024 lds
  buffer_load_dwordx4 v22, s[16:19], s22 offen offset:2048 lds
  buffer_load_dwordx4 v23, s[16:19], s22 offen offset:3072 lds
  s_add_u32 s22, s22, 32768
  s_mov_b32 m0, 126976
  s_nop 0
  buffer_load_dwordx4 v20, s[16:19], s22 offen offset:0 lds
  buffer_load_dwordx4 v21, s[16:19], s22 offen offset:1024 lds
  buffer_load_dwordx4 v22, s[16:19], s22 offen offset:2048 lds
  buffer_load_dwordx4 v23, s[16:19], s22 offen offset:3072 lds
  s_add_u32 s22, s22, 32768
  s_mov_b32 m0, 131072
  s_nop 0
  buffer_load_dwordx4 v20, s[16:19], s22 offen offset:0 lds
  buffer_load_dwordx4 v21, s[16:19], s22 offen offset:1024 lds
  s_add_u32 s21, s20, 0
  s_and_b32 s21, s21, 7
  s_lshl_b32 s21, s21, 19
  s_add_u32 s21, s21, s35
  s_mov_b32 m0, 32768
  s_nop 0
  buffer_load_dwordx4 v36, s[40:43], s21 offen offset:0 lds
  buffer_load_dwordx4 v37, s[40:43], s21 offen offset:1024 lds
  buffer_load_dwordx4 v38, s[40:43], s21 offen offset:2048 lds
  buffer_load_dwordx4 v39, s[40:43], s21 offen offset:3072 lds
  s_add_u32 s21, s21, 131072
  s_mov_b32 m0, 36864
  s_nop 0
  buffer_load_dwordx4 v36, s[40:43], s21 offen offset:0 lds
  buffer_load_dwordx4 v37, s[40:43], s21 offen offset:1024 lds
  buffer_load_dwordx4 v38, s[40:43], s21 offen offset:2048 lds
  buffer_load_dwordx4 v39, s[40:43], s21 offen offset:3072 lds
  s_add_u32 s21, s21, 131072
  s_mov_b32 m0, 40960
  s_nop 0
  buffer_load_dwordx4 v36, s[40:43], s21 offen offset:0 lds
  buffer_load_dwordx4 v37, s[40:43], s21 offen offset:1024 lds
  buffer_load_dwordx4 v38, s[40:43], s21 offen offset:2048 lds
  buffer_load_dwordx4 v39, s[40:43], s21 offen offset:3072 lds
  s_add_u32 s21, s21, 131072
  s_mov_b32 m0, 45056
  s_nop 0
  buffer_load_dwordx4 v36, s[40:43], s21 offen offset:0 lds
  buffer_load_dwordx4 v37, s[40:43], s21 offen offset:1024 lds
  buffer_load_dwordx4 v38, s[40:43], s21 offen offset:2048 lds
  buffer_load_dwordx4 v39, s[40:43], s21 offen offset:3072 lds
  s_add_u32 s21, s20, 0
  s_and_b32 s21, s21, 7
  s_lshl_b32 s21, s21, 19
  s_add_u32 s21, s21, s36
  s_mov_b32 m0, 98304
  s_nop 0
  buffer_load_dwordx4 v36, s[40:43], s21 offen offset:0 lds
  buffer_load_dwordx4 v37, s[40:43], s21 offen offset:1024 lds
  buffer_load_dwordx4 v38, s[40:43], s21 offen offset:2048 lds
  buffer_load_dwordx4 v39, s[40:43], s21 offen offset:3072 lds
  s_add_u32 s21, s21, 131072
  s_mov_b32 m0, 102400
  s_nop 0
  buffer_load_dwordx4 v36, s[40:43], s21 offen offset:0 lds
  buffer_load_dwordx4 v37, s[40:43], s21 offen offset:1024 lds
  buffer_load_dwordx4 v38, s[40:43], s21 offen offset:2048 lds
  buffer_load_dwordx4 v39, s[40:43], s21 offen offset:3072 lds
  s_add_u32 s21, s21, 131072
  s_mov_b32 m0, 106496
  s_nop 0
  buffer_load_dwordx4 v36, s[40:43], s21 offen offset:0 lds
  buffer_load_dwordx4 v37, s[40:43], s21 offen offset:1024 lds
  buffer_load_dwordx4 v38, s[40:43], s21 offen offset:2048 lds
  buffer_load_dwordx4 v39, s[40:43], s21 offen offset:3072 lds
  s_add_u32 s21, s21, 131072
  s_mov_b32 m0, 110592
  s_nop 0
  buffer_load_dwordx4 v36, s[40:43], s21 offen offset:0 lds
  buffer_load_dwordx4 v37, s[40:43], s21 offen offset:1024 lds
  buffer_load_dwordx4 v38, s[40:43], s21 offen offset:2048 lds
  buffer_load_dwordx4 v39, s[40:43], s21 offen offset:3072 lds
L_noearly:
  s_lshl_b32 s6, s4, 5
  s_add_u32 s6, s6, s5
  s_lshl_b32 s6, s6, 18
  s_add_u32 s24, s66, s6
  s_addc_u32 s25, s67, 0
  s_mov_b32 s26, 524288
  s_mov_b32 s27, 131072
  s_add_u32 s28, s68, s6
  s_addc_u32 s29, s69, 0
  s_mov_b32 s30, 524288
  s_mov_b32 s31, 131072
  s_lshl_b32 s6, s8, 3
  s_add_u32 s6, s6, s4
  s_mul_i32 s6, s6, 9
  s_min_u32 s7, s3, 2
  s_mul_i32 s7, s7, 3
  s_add_u32 s6, s6, s7
  s_lshl_b32 s6, s6, 17
  s_lshl_b32 s7, s5, 12
  s_add_u32 s6, s6, s7
  s_sub_u32 s7, 18874368, s6
  s_add_u32 s48, s88, s6
  s_addc_u32 s49, s89, 0
  s_mov_b32 s50, s7
  s_mov_b32 s51, 131072
  s_lshl_b32 s6, s8, 3
  s_add_u32 s96, s6, s4
  s_lshl_b32 s97, s8, 10
  s_mul_i32 s6, s4, 294912
  s_add_u32 s97, s97, s6
  s_lshr_b32 s8, s37, 12
  s_lshr_b32 s4, s5, 3
  s_bfe_u32 s5, s5, 131073
  s_mov_b32 s9, s96
  s_barrier
  s_cmp_eq_u32 s3, 3
  s_cbranch_scc1 L_loader
  s_mov_b64 s[98:99], s[86:87]
  s_or_b32 s6, s2, s3
  s_cmp_eq_u32 s6, 0
  s_cbranch_scc0 L_nononce
  s_memrealtime s[6:7]
  s_waitcnt lgkmcnt(0)
  s_or_b32 s39, s6, 1
  s_mov_b64 exec, 1
  v_mov_b32 v130, s39
  v_mov_b32 v132, 0
  global_store_dword v132, v130, s[98:99] sc1
  s_mov_b64 exec, -1
L_nononce:
  s_mul_i32 s6, s9, 9
  s_mul_i32 s7, s3, 3
  s_add_u32 s6, s6, s7
  s_lshl_b32 s6, s6, 17
  s_add_u32 s16, s88, s6
  s_addc_u32 s17, s89, 0
  s_mov_b32 s18, 393216
  s_mov_b32 s19, 131072
  s_lshl_b32 s6, s9, 2
  s_add_u32 s6, s6, s5
  s_lshl_b32 s45, s6, 8
  s_lshl_b32 s7, s3, 4
  s_add_u32 s45, s45, s7
  s_add_u32 s45, s45, 24576
  s_lshl_b32 s7, s4, 6
  s_add_u32 s11, s45, s7
  s_mul_i32 s6, s6, 221184
  s_add_u32 s6, s6, 18874368
  s_add_u32 s24, s88, s6
  s_addc_u32 s25, s89, 0
  s_mov_b32 s26, 221184
  s_mov_b32 s27, 131072
  s_lshl_b32 s6, s9, 2
  s_add_u32 s6, s6, s4
  s_mul_i32 s10, s6, 384
  s_lshl_b32 s7, s3, 4
  s_add_u32 s10, s10, s7
  s_lshl_b32 s7, s5, 2
  s_add_u32 s44, s10, s7
  s_mul_i32 s6, s3, 98304
  s_add_u32 s6, s6, s97
  s_lshl_b32 s7, s5, 8
  s_add_u32 s6, s6, s7
  s_lshl_b32 s7, s4, 6
  s_add_u32 s6, s6, s7
  s_sub_u32 s7, 2359296, s6
  s_add_u32 s28, s84, s6
  s_addc_u32 s29, s85, 0
  s_mov_b32 s30, s7
  s_mov_b32 s31, 131072
  s_add_u32 s40, s88, 37748736
  s_addc_u32 s41, s89, 0
  s_mov_b32 s42, 40960
  s_mov_b32 s43, 131072
  s_add_u32 s6, s5, 0
  s_and_b32 s6, s6, 3
  s_lshl_b32 s7, s4, 2
  s_add_u32 s6, s6, s7
  s_lshl_b32 s6, s6, 13
  s_add_u32 s20, s6, s37
  s_add_u32 s33, s6, s38
  s_add_u32 s6, s5, 1
  s_and_b32 s6, s6, 3
  s_lshl_b32 s7, s4, 2
  s_add_u32 s6, s6, s7
  s_lshl_b32 s6, s6, 13
  s_add_u32 s21, s6, s37
  s_add_u32 s34, s6, s38
  s_add_u32 s6, s5, 2
  s_and_b32 s6, s6, 3
  s_lshl_b32 s7, s4, 2
  s_add_u32 s6, s6, s7
  s_lshl_b32 s6, s6, 13
  s_add_u32 s22, s6, s37
  s_add_u32 s35, s6, s38
  s_add_u32 s6, s5, 3
  s_and_b32 s6, s6, 3
  s_lshl_b32 s7, s4, 2
  s_add_u32 s6, s6, s7
  s_lshl_b32 s6, s6, 13
  s_add_u32 s23, s6, s37
  s_add_u32 s36, s6, s38
  s_mov_b64 s[96:97], s[90:91]
  v_and_b32 v15, 1, v13
  v_xor_b32 v15, v15, v14
  v_lshlrev_b32 v15, 4, v15
  v_and_b32 v16, 1, v14
  v_lshl_add_u32 v15, v16, 3, v15
  v_lshl_add_u32 v2, v13, 11, v15
  v_and_b32 v15, 1, v13
  v_cmp_eq_u32 s[46:47], 1, v15
  v_lshrrev_b32 v15, 2, v14
  v_lshlrev_b32 v16, 1, v15
  v_lshrrev_b32 v17, v16, v18
  v_and_b32 v17, 3, v17
  v_xor_b32 v17, v13, v17
  v_lshlrev_b32 v15, 11, v15
  v_and_b32 v16, 3, v14
  v_lshl_add_u32 v15, v16, 6, v15
  v_lshl_add_u32 v1, v17, 4, v15
  v_lshrrev_b32 v15, 3, v14
  v_lshlrev_b32 v15, 10, v15
  v_and_b32 v16, 7, v14
  v_lshl_add_u32 v15, v16, 6, v15
  v_lshl_add_u32 v129, v17, 4, v15
  s_mul_i32 s6, s3, 6144
  v_add_u32 v129, s6, v129
  v_lshlrev_b32 v15, 11, v13
  v_lshrrev_b32 v16, 2, v14
  v_lshl_add_u32 v15, v16, 6, v15
  v_and_b32 v16, 1, v13
  v_lshl_add_u32 v15, v16, 5, v15
  v_and_b32 v16, 3, v14
  v_lshl_add_u32 v8, v16, 3, v15
  v_lshlrev_b32 v9, 4, v0
  s_lshl_b32 s6, s3, 2
  s_add_u32 s6, s6, 151568
  v_mov_b32 v249, s6
  v_mov_b32 v250, 1
  s_mov_b32 s52, 0
  s_mov_b32 s53, 81920
  v_add_u32 v3, s52, v1
  v_add_u32 v4, s53, v8
  v_xor_b32 v6, 32, v4
  v_add_u32 v5, 32768, v2
  v_xor_b32 v11, 8, v5
  v_add_u32 v7, 114688, v129
  s_mov_b32 s57, 1098907648
  s_mov_b32 s58, 1040356334
  s_mov_b32 s59, 1040356334
  s_mov_b32 s54, 2
  ds_read_b32 v248, v251 offset:20480
  s_waitcnt lgkmcnt(0)
  v_readfirstlane_b32 s56, v248
  s_nop 1
  s_cmp_ge_u32 s56, s54
  s_cbranch_scc0 L_spin_init
L_spun_init:
  ds_read_b64_tr_b16 a[144:145], v5 offset:0
  ds_read_b64_tr_b16 a[146:147], v5 offset:1024
  ds_read_b64_tr_b16 a[148:149], v11 offset:0
  ds_read_b64_tr_b16 a[150:151], v11 offset:1024
  ds_read_b64_tr_b16 a[152:153], v5 offset:256
  ds_read_b64_tr_b16 a[154:155], v5 offset:1280
  ds_read_b64_tr_b16 a[156:157], v11 offset:256
  ds_read_b64_tr_b16 a[158:159], v11 offset:1280
  ds_read_b128 a[208:211], v7 offset:0
  ds_read_b128 a[212:215], v7 offset:2048
  ds_read_b128 a[216:219], v7 offset:4096
  ds_read_b64_tr_b16 a[160:161], v5 offset:512
  ds_read_b64_tr_b16 a[162:163], v5 offset:1536
  ds_read_b64_tr_b16 a[164:165], v11 offset:512
  ds_read_b64_tr_b16 a[166:167], v11 offset:1536
  ds_read_b64_tr_b16 a[168:169], v5 offset:768
  ds_read_b64_tr_b16 a[170:171], v5 offset:1792
  ds_read_b64_tr_b16 a[172:173], v11 offset:768
  ds_read_b64_tr_b16 a[174:175], v11 offset:1792
  s_waitcnt lgkmcnt(8)
  v_mfma_f32_16x16x32_bf16 v[32:35], a[144:147], a[208:211], 0
  ds_read_b64_tr_b16 a[176:177], v5 offset:8192
  s_mov_b32 s54, 3
  v_mfma_f32_16x16x32_bf16 v[44:47], a[148:151], a[208:211], 0
  ds_read_b64_tr_b16 a[178:179], v5 offset:9216
  v_mfma_f32_16x16x32_bf16 v[56:59], a[152:155], a[208:211], 0
  ds_read_b64_tr_b16 a[180:181], v11 offset:8192
  v_mfma_f32_16x16x32_bf16 v[68:71], a[156:159], a[208:211], 0
  ds_read_b64_tr_b16 a[182:183], v11 offset:9216
  v_mfma_f32_16x16x32_bf16 v[36:39], a[144:147], a[212:215], 0
  ds_read_b64_tr_b16 a[184:185], v5 offset:8448
  v_mfma_f32_16x16x32_bf16 v[48:51], a[148:151], a[212:215], 0
  ds_read_b64_tr_b16 a[186:187], v5 offset:9472
  v_mfma_f32_16x16x32_bf16 v[60:63], a[152:155], a[212:215], 0
  ds_read_b64_tr_b16 a[188:189], v11 offset:8448
  v_mfma_f32_16x16x32_bf16 v[72:75], a[156:159], a[212:215], 0
  ds_read_b64_tr_b16 a[190:191], v11 offset:9472
  v_mfma_f32_16x16x32_bf16 v[40:43], a[144:147], a[216:219], 0
  ds_read_b128 a[220:223], v7 offset:512
  v_mfma_f32_16x16x32_bf16 v[52:55], a[148:151], a[216:219], 0
  ds_read_b128 a[224:227], v7 offset:2560
  v_mfma_f32_16x16x32_bf16 v[64:67], a[152:155], a[216:219], 0
  ds_read_b128 a[228:231], v7 offset:4608
  v_mfma_f32_16x16x32_bf16 v[76:79], a[156:159], a[216:219], 0
  ds_read_b64_tr_b16 a[192:193], v5 offset:8704
  s_waitcnt lgkmcnt(12)
  v_mfma_f32_16x16x32_bf16 v[80:83], a[160:163], a[208:211], 0
  ds_read_b64_tr_b16 a[194:195], v5 offset:9728
  v_mfma_f32_16x16x32_bf16 v[92:95], a[164:167], a[208:211], 0
  ds_read_b64_tr_b16 a[196:197], v11 offset:8704
  v_mfma_f32_16x16x32_bf16 v[104:107], a[168:171], a[208:211], 0
  ds_read_b64_tr_b16 a[198:199], v11 offset:9728
  v_mfma_f32_16x16x32_bf16 v[116:119], a[172:175], a[208:211], 0
  ds_read_b64_tr_b16 a[200:201], v5 offset:8960
  v_mfma_f32_16x16x32_bf16 v[84:87], a[160:163], a[212:215], 0
  ds_read_b64_tr_b16 a[202:203], v5 offset:9984
  v_mfma_f32_16x16x32_bf16 v[96:99], a[164:167], a[212:215], 0
  ds_read_b64_tr_b16 a[204:205], v11 offset:8960
  v_mfma_f32_16x16x32_bf16 v[108:111], a[168:171], a[212:215], 0
  ds_read_b64_tr_b16 a[206:207], v11 offset:9984
  v_mfma_f32_16x16x32_bf16 v[120:123], a[172:175], a[212:215], 0
  ds_read_b32 v248, v251 offset:20480
  v_add_u32 v5, 98304, v2
  v_mfma_f32_16x16x32_bf16 v[88:91], a[160:163], a[216:219], 0
  v_xor_b32 v11, 8, v5
  v_mfma_f32_16x16x32_bf16 v[100:103], a[164:167], a[216:219], 0
  v_mfma_f32_16x16x32_bf16 v[112:115], a[168:171], a[216:219], 0
  v_mfma_f32_16x16x32_bf16 v[124:127], a[172:175], a[216:219], 0
  s_waitcnt lgkmcnt(0)
  ds_write_b32 v249, v250 offset:0
  v_add_u32 v250, 1, v250
  v_readfirstlane_b32 s56, v248
  s_nop 1
  s_cmp_ge_u32 s56, s54
  s_cbranch_scc0 L_spin_p0
L_spun_p0:
  v_mfma_f32_16x16x32_bf16 v[32:35], a[176:179], a[220:223], v[32:35]
  ds_read_b64_tr_b16 a[144:145], v5 offset:0
  v_mfma_f32_16x16x32_bf16 v[44:47], a[180:183], a[220:223], v[44:47]
  ds_read_b64_tr_b16 a[146:147], v5 offset:1024
  v_mfma_f32_16x16x32_bf16 v[56:59], a[184:187], a[220:223], v[56:59]
  ds_read_b64_tr_b16 a[148:149], v11 offset:0
  v_mfma_f32_16x16x32_bf16 v[68:71], a[188:191], a[220:223], v[68:71]
  ds_read_b64_tr_b16 a[150:151], v11 offset:1024
  v_mfma_f32_16x16x32_bf16 v[36:39], a[176:179], a[224:227], v[36:39]
  ds_read_b64_tr_b16 a[152:153], v5 offset:256
  v_mfma_f32_16x16x32_bf16 v[48:51], a[180:183], a[224:227], v[48:51]
  ds_read_b64_tr_b16 a[154:155], v5 offset:1280
  v_mfma_f32_16x16x32_bf16 v[60:63], a[184:187], a[224:227], v[60:63]
  ds_read_b64_tr_b16 a[156:157], v11 offset:256
  v_mfma_f32_16x16x32_bf16 v[72:75], a[188:191], a[224:227], v[72:75]
  ds_read_b64_tr_b16 a[158:159], v11 offset:1280
  v_mfma_f32_16x16x32_bf16 v[40:43], a[176:179], a[228:231], v[40:43]
  ds_read_b64_tr_b16 a[160:161], v5 offset:512
  v_mfma_f32_16x16x32_bf16 v[52:55], a[180:183], a[228:231], v[52:55]
  ds_read_b64_tr_b16 a[162:163], v5 offset:1536
  v_mfma_f32_16x16x32_bf16 v[64:67], a[184:187], a[228:231], v[64:67]
  ds_read_b64_tr_b16 a[164:165], v11 offset:512
  v_mfma_f32_16x16x32_bf16 v[76:79], a[188:191], a[228:231], v[76:79]
  ds_read_b64_tr_b16 a[166:167], v11 offset:1536
  v_mfma_f32_16x16x32_bf16 v[80:83], a[192:195], a[220:223], v[80:83]
  ds_read_b64_tr_b16 a[168:169], v5 offset:768
  v_mfma_f32_16x16x32_bf16 v[92:95], a[196:199], a[220:223], v[92:95]
  ds_read_b64_tr_b16 a[170:171], v5 offset:1792
  v_mfma_f32_16x16x32_bf16 v[104:107], a[200:203], a[220:223], v[104:107]
  ds_read_b64_tr_b16 a[172:173], v11 offset:768
  v_mfma_f32_16x16x32_bf16 v[116:119], a[204:207], a[220:223], v[116:119]
  ds_read_b64_tr_b16 a[174:175], v11 offset:1792
  v_mfma_f32_16x16x32_bf16 v[84:87], a[192:195], a[224:227], v[84:87]
  v_mfma_f32_16x16x32_bf16 v[96:99], a[196:199], a[224:227], v[96:99]
  v_mfma_f32_16x16x32_bf16 v[108:111], a[200:203], a[224:227], v[108:111]
  v_mfma_f32_16x16x32_bf16 v[120:123], a[204:207], a[224:227], v[120:123]
  v_mfma_f32_16x16x32_bf16 v[88:91], a[192:195], a[228:231], v[88:91]
  v_mfma_f32_16x16x32_bf16 v[100:103], a[196:199], a[228:231], v[100:103]
  v_mfma_f32_16x16x32_bf16 v[112:115], a[200:203], a[228:231], v[112:115]
  v_mfma_f32_16x16x32_bf16 v[124:127], a[204:207], a[228:231], v[124:127]
  s_waitcnt lgkmcnt(8)
  v_mfma_f32_16x16x32_bf16 a[0:3], a[144:147], a[208:211], 0
  ds_read_b64_tr_b16 a[176:177], v5 offset:8192
  s_mov_b32 s54, 5
  v_mfma_f32_16x16x32_bf16 a[12:15], a[148:151], a[208:211], 0
  ds_read_b64_tr_b16 a[178:179], v5 offset:9216
  v_mfma_f32_16x16x32_bf16 a[24:27], a[152:155], a[208:211], 0
  ds_read_b64_tr_b16 a[180:181], v11 offset:8192
  v_mfma_f32_16x16x32_bf16 a[36:39], a[156:159], a[208:211], 0
  ds_read_b64_tr_b16 a[182:183], v11 offset:9216
  v_mfma_f32_16x16x32_bf16 a[4:7], a[144:147], a[212:215], 0
  ds_read_b64_tr_b16 a[184:185], v5 offset:8448
  v_mfma_f32_16x16x32_bf16 a[16:19], a[148:151], a[212:215], 0
  ds_read_b64_tr_b16 a[186:187], v5 offset:9472
  v_mfma_f32_16x16x32_bf16 a[28:31], a[152:155], a[212:215], 0
  ds_read_b64_tr_b16 a[188:189], v11 offset:8448
  v_mfma_f32_16x16x32_bf16 a[40:43], a[156:159], a[212:215], 0
  ds_read_b64_tr_b16 a[190:191], v11 offset:9472
  v_mfma_f32_16x16x32_bf16 a[8:11], a[144:147], a[216:219], 0
  ds_read_b64_tr_b16 a[192:193], v5 offset:8704
  v_mfma_f32_16x16x32_bf16 a[20:23], a[148:151], a[216:219], 0
  ds_read_b64_tr_b16 a[194:195], v5 offset:9728
  v_mfma_f32_16x16x32_bf16 a[32:35], a[152:155], a[216:219], 0
  ds_read_b64_tr_b16 a[196:197], v11 offset:8704
  v_mfma_f32_16x16x32_bf16 a[44:47], a[156:159], a[216:219], 0
  ds_read_b64_tr_b16 a[198:199], v11 offset:9728
  s_waitcnt lgkmcnt(12)
  v_mfma_f32_16x16x32_bf16 a[48:51], a[160:163], a[208:211], 0
  ds_read_b64_tr_b16 a[200:201], v5 offset:8960
  v_mfma_f32_16x16x32_bf16 a[60:63], a[164:167], a[208:211], 0
  ds_read_b64_tr_b16 a[202:203], v5 offset:9984
  v_mfma_f32_16x16x32_bf16 a[72:75], a[168:171], a[208:211], 0
  ds_read_b64_tr_b16 a[204:205], v11 offset:8960
  v_mfma_f32_16x16x32_bf16 a[84:87], a[172:175], a[208:211], 0
  ds_read_b64_tr_b16 a[206:207], v11 offset:9984
  v_mfma_f32_16x16x32_bf16 a[52:55], a[160:163], a[212:215], 0
  ds_read_b32 v248, v251 offset:20480
  v_add_u32 v5, 49152, v2
  v_mfma_f32_16x16x32_bf16 a[64:67], a[164:167], a[212:215], 0
  v_xor_b32 v11, 8, v5
  v_add_u32 v7, 133120, v129
  v_mfma_f32_16x16x32_bf16 a[76:79], a[168:171], a[212:215], 0
  v_mfma_f32_16x16x32_bf16 a[88:91], a[172:175], a[212:215], 0
  v_mfma_f32_16x16x32_bf16 a[56:59], a[160:163], a[216:219], 0
  v_mfma_f32_16x16x32_bf16 a[68:71], a[164:167], a[216:219], 0
  v_mfma_f32_16x16x32_bf16 a[80:83], a[168:171], a[216:219], 0
  v_mfma_f32_16x16x32_bf16 a[92:95], a[172:175], a[216:219], 0
  s_waitcnt lgkmcnt(0)
  ds_write_b32 v249, v250 offset:0
  v_add_u32 v250, 1, v250
  v_readfirstlane_b32 s56, v248
  s_nop 1
  s_cmp_ge_u32 s56, s54
  s_cbranch_scc0 L_spin_p1
L_spun_p1:
  v_mfma_f32_16x16x32_bf16 a[0:3], a[176:179], a[220:223], a[0:3]
  ds_read_b64_tr_b16 a[144:145], v5 offset:0
  v_mfma_f32_16x16x32_bf16 a[12:15], a[180:183], a[220:223], a[12:15]
  ds_read_b64_tr_b16 a[146:147], v5 offset:1024
  v_mfma_f32_16x16x32_bf16 a[24:27], a[184:187], a[220:223], a[24:27]
  ds_read_b64_tr_b16 a[148:149], v11 offset:0
  v_mfma_f32_16x16x32_bf16 a[36:39], a[188:191], a[220:223], a[36:39]
  ds_read_b64_tr_b16 a[150:151], v11 offset:1024
  v_mfma_f32_16x16x32_bf16 a[4:7], a[176:179], a[224:227], a[4:7]
  ds_read_b64_tr_b16 a[152:153], v5 offset:256
  v_mfma_f32_16x16x32_bf16 a[16:19], a[180:183], a[224:227], a[16:19]
  ds_read_b64_tr_b16 a[154:155], v5 offset:1280
  v_mfma_f32_16x16x32_bf16 a[28:31], a[184:187], a[224:227], a[28:31]
  ds_read_b64_tr_b16 a[156:157], v11 offset:256
  v_mfma_f32_16x16x32_bf16 a[40:43], a[188:191], a[224:227], a[40:43]
  ds_read_b64_tr_b16 a[158:159], v11 offset:1280
  v_mfma_f32_16x16x32_bf16 a[8:11], a[176:179], a[228:231], a[8:11]
  ds_read_b128 a[208:211], v7 offset:0
  v_mfma_f32_16x16x32_bf16 a[20:23], a[180:183], a[228:231], a[20:23]
  ds_read_b128 a[212:215], v7 offset:2048
  v_mfma_f32_16x16x32_bf16 a[32:35], a[184:187], a[228:231], a[32:35]
  ds_read_b128 a[216:219], v7 offset:4096
  v_mfma_f32_16x16x32_bf16 a[44:47], a[188:191], a[228:231], a[44:47]
  ds_read_b64_tr_b16 a[160:161], v5 offset:512
  v_mfma_f32_16x16x32_bf16 a[48:51], a[192:195], a[220:223], a[48:51]
  ds_read_b64_tr_b16 a[162:163], v5 offset:1536
  v_mfma_f32_16x16x32_bf16 a[60:63], a[196:199], a[220:223], a[60:63]
  ds_read_b64_tr_b16 a[164:165], v11 offset:512
  v_mfma_f32_16x16x32_bf16 a[72:75], a[200:203], a[220:223], a[72:75]
  ds_read_b64_tr_b16 a[166:167], v11 offset:1536
  v_mfma_f32_16x16x32_bf16 a[84:87], a[204:207], a[220:223], a[84:87]
  ds_read_b64_tr_b16 a[168:169], v5 offset:768
  v_mfma_f32_16x16x32_bf16 a[52:55], a[192:195], a[224:227], a[52:55]
  ds_read_b64_tr_b16 a[170:171], v5 offset:1792
  v_mfma_f32_16x16x32_bf16 a[64:67], a[196:199], a[224:227], a[64:67]
  ds_read_b64_tr_b16 a[172:173], v11 offset:768
  v_mfma_f32_16x16x32_bf16 a[76:79], a[200:203], a[224:227], a[76:79]
  ds_read_b64_tr_b16 a[174:175], v11 offset:1792
  v_mfma_f32_16x16x32_bf16 a[88:91], a[204:207], a[224:227], a[88:91]
  v_mfma_f32_16x16x32_bf16 a[56:59], a[192:195], a[228:231], a[56:59]
  v_mfma_f32_16x16x32_bf16 a[68:71], a[196:199], a[228:231], a[68:71]
  v_mfma_f32_16x16x32_bf16 a[80:83], a[200:203], a[228:231], a[80:83]
  v_mfma_f32_16x16x32_bf16 a[92:95], a[204:207], a[228:231], a[92:95]
  s_waitcnt lgkmcnt(8)
  v_mfma_f32_16x16x32_bf16 v[32:35], a[144:147], a[208:211], v[32:35]
  ds_read_b64_tr_b16 a[176:177], v5 offset:8192
  s_mov_b32 s54, 6
  v_mfma_f32_16x16x32_bf16 v[44:47], a[148:151], a[208:211], v[44:47]
  ds_read_b64_tr_b16 a[178:179], v5 offset:9216
  v_mfma_f32_16x16x32_bf16 v[56:59], a[152:155], a[208:211], v[56:59]
  ds_read_b64_tr_b16 a[180:181], v11 offset:8192
  v_mfma_f32_16x16x32_bf16 v[68:71], a[156:159], a[208:211], v[68:71]
  ds_read_b64_tr_b16 a[182:183], v11 offset:9216
  v_mfma_f32_16x16x32_bf16 v[36:39], a[144:147], a[212:215], v[36:39]
  ds_read_b64_tr_b16 a[184:185], v5 offset:8448
  v_mfma_f32_16x16x32_bf16 v[48:51], a[148:151], a[212:215], v[48:51]
  ds_read_b64_tr_b16 a[186:187], v5 offset:9472
  v_mfma_f32_16x16x32_bf16 v[60:63], a[152:155], a[212:215], v[60:63]
  ds_read_b64_tr_b16 a[188:189], v11 offset:8448
  v_mfma_f32_16x16x32_bf16 v[72:75], a[156:159], a[212:215], v[72:75]
  ds_read_b64_tr_b16 a[190:191], v11 offset:9472
  v_mfma_f32_16x16x32_bf16 v[40:43], a[144:147], a[216:219], v[40:43]
  ds_read_b128 a[220:223], v7 offset:512
  v_mfma_f32_16x16x32_bf16 v[52:55], a[148:151], a[216:219], v[52:55]
  ds_read_b128 a[224:227], v7 offset:2560
  v_mfma_f32_16x16x32_bf16 v[64:67], a[152:155], a[216:219], v[64:67]
  ds_read_b128 a[228:231], v7 offset:4608
  v_mfma_f32_16x16x32_bf16 v[76:79], a[156:159], a[216:219], v[76:79]
  ds_read_b64_tr_b16 a[192:193], v5 offset:8704
  s_waitcnt lgkmcnt(12)
  v_mfma_f32_16x16x32_bf16 v[80:83], a[160:163], a[208:211], v[80:83]
  ds_read_b64_tr_b16 a[194:195], v5 offset:9728
  v_mfma_f32_16x16x32_bf16 v[92:95], a[164:167], a[208:211], v[92:95]
  ds_read_b64_tr_b16 a[196:197], v11 offset:8704
  v_mfma_f32_16x16x32_bf16 v[104:107], a[168:171], a[208:211], v[104:107]
  ds_read_b64_tr_b16 a[198:199], v11 offset:9728
  v_mfma_f32_16x16x32_bf16 v[116:119], a[172:175], a[208:211], v[116:119]
  ds_read_b64_tr_b16 a[200:201], v5 offset:8960
  v_mfma_f32_16x16x32_bf16 v[84:87], a[160:163], a[212:215], v[84:87]
  ds_read_b64_tr_b16 a[202:203], v5 offset:9984
  v_mfma_f32_16x16x32_bf16 v[96:99], a[164:167], a[212:215], v[96:99]
  ds_read_b64_tr_b16 a[204:205], v11 offset:8960
  v_mfma_f32_16x16x32_bf16 v[108:111], a[168:171], a[212:215], v[108:111]
  ds_read_b64_tr_b16 a[206:207], v11 offset:9984
  v_mfma_f32_16x16x32_bf16 v[120:123], a[172:175], a[212:215], v[120:123]
  ds_read_b32 v248, v251 offset:20480
  v_add_u32 v5, 65536, v2
  v_mfma_f32_16x16x32_bf16 v[88:91], a[160:163], a[216:219], v[88:91]
  v_xor_b32 v11, 8, v5
  v_mfma_f32_16x16x32_bf16 v[100:103], a[164:167], a[216:219], v[100:103]
  v_mfma_f32_16x16x32_bf16 v[112:115], a[168:171], a[216:219], v[112:115]
  v_mfma_f32_16x16x32_bf16 v[124:127], a[172:175], a[216:219], v[124:127]
  s_waitcnt lgkmcnt(0)
  ds_write_b32 v249, v250 offset:0
  v_add_u32 v250, 1, v250
  v_readfirstlane_b32 s56, v248
  s_nop 1
  s_cmp_ge_u32 s56, s54
  s_cbranch_scc0 L_spin_p2
L_spun_p2:
  v_mfma_f32_16x16x32_bf16 v[32:35], a[176:179], a[220:223], v[32:35]
  ds_read_b64_tr_b16 a[144:145], v5 offset:0
  v_mfma_f32_16x16x32_bf16 v[44:47], a[180:183], a[220:223], v[44:47]
  ds_read_b64_tr_b16 a[146:147], v5 offset:1024
  v_mfma_f32_16x16x32_bf16 v[56:59], a[184:187], a[220:223], v[56:59]
  ds_read_b64_tr_b16 a[148:149], v11 offset:0
  v_mfma_f32_16x16x32_bf16 v[68:71], a[188:191], a[220:223], v[68:71]
  ds_read_b64_tr_b16 a[150:151], v11 offset:1024
  v_mfma_f32_16x16x32_bf16 v[36:39], a[176:179], a[224:227], v[36:39]
  ds_read_b64_tr_b16 a[152:153], v5 offset:256
  v_mfma_f32_16x16x32_bf16 v[48:51], a[180:183], a[224:227], v[48:51]
  ds_read_b64_tr_b16 a[154:155], v5 offset:1280
  v_mfma_f32_16x16x32_bf16 v[60:63], a[184:187], a[224:227], v[60:63]
  ds_read_b64_tr_b16 a[156:157], v11 offset:256
  v_mfma_f32_16x16x32_bf16 v[72:75], a[188:191], a[224:227], v[72:75]
  ds_read_b64_tr_b16 a[158:159], v11 offset:1280
  v_mfma_f32_16x16x32_bf16 v[40:43], a[176:179], a[228:231], v[40:43]
  ds_read_b64_tr_b16 a[160:161], v5 offset:512
  v_mfma_f32_16x16x32_bf16 v[52:55], a[180:183], a[228:231], v[52:55]
  ds_read_b64_tr_b16 a[162:163], v5 offset:1536
  v_mfma_f32_16x16x32_bf16 v[64:67], a[184:187], a[228:231], v[64:67]
  ds_read_b64_tr_b16 a[164:165], v11 offset:512
  v_mfma_f32_16x16x32_bf16 v[76:79], a[188:191], a[228:231], v[76:79]
  ds_read_b64_tr_b16 a[166:167], v11 offset:1536
  v_mfma_f32_16x16x32_bf16 v[80:83], a[192:195], a[220:223], v[80:83]
  ds_read_b64_tr_b16 a[168:169], v5 offset:768
  v_mfma_f32_16x16x32_bf16 v[92:95], a[196:199], a[220:223], v[92:95]
  ds_read_b64_tr_b16 a[170:171], v5 offset:1792
  v_mfma_f32_16x16x32_bf16 v[104:107], a[200:203], a[220:223], v[104:107]
  ds_read_b64_tr_b16 a[172:173], v11 offset:768
  v_mfma_f32_16x16x32_bf16 v[116:119], a[204:207], a[220:223], v[116:119]
  ds_read_b64_tr_b16 a[174:175], v11 offset:1792
  v_mfma_f32_16x16x32_bf16 v[84:87], a[192:195], a[224:227], v[84:87]
  v_mfma_f32_16x16x32_bf16 v[96:99], a[196:199], a[224:227], v[96:99]
  v_mfma_f32_16x16x32_bf16 v[108:111], a[200:203], a[224:227], v[108:111]
  v_mfma_f32_16x16x32_bf16 v[120:123], a[204:207], a[224:227], v[120:123]
  v_mfma_f32_16x16x32_bf16 v[88:91], a[192:195], a[228:231], v[88:91]
  v_mfma_f32_16x16x32_bf16 v[100:103], a[196:199], a[228:231], v[100:103]
  v_mfma_f32_16x16x32_bf16 v[112:115], a[200:203], a[228:231], v[112:115]
  v_mfma_f32_16x16x32_bf16 v[124:127], a[204:207], a[228:231], v[124:127]
  s_waitcnt lgkmcnt(8)
  v_mfma_f32_16x16x32_bf16 a[0:3], a[144:147], a[208:211], a[0:3]
  ds_read_b64_tr_b16 a[176:177], v5 offset:8192
  s_mov_b32 s54, 8
  v_mfma_f32_16x16x32_bf16 a[12:15], a[148:151], a[208:211], a[12:15]
  ds_read_b64_tr_b16 a[178:179], v5 offset:9216
  v_mfma_f32_16x16x32_bf16 a[24:27], a[152:155], a[208:211], a[24:27]
  ds_read_b64_tr_b16 a[180:181], v11 offset:8192
  v_mfma_f32_16x16x32_bf16 a[36:39], a[156:159], a[208:211], a[36:39]
  ds_read_b64_tr_b16 a[182:183], v11 offset:9216
  v_mfma_f32_16x16x32_bf16 a[4:7], a[144:147], a[212:215], a[4:7]
  ds_read_b64_tr_b16 a[184:185], v5 offset:8448
  v_mfma_f32_16x16x32_bf16 a[16:19], a[148:151], a[212:215], a[16:19]
  ds_read_b64_tr_b16 a[186:187], v5 offset:9472
  v_mfma_f32_16x16x32_bf16 a[28:31], a[152:155], a[212:215], a[28:31]
  ds_read_b64_tr_b16 a[188:189], v11 offset:8448
  v_mfma_f32_16x16x32_bf16 a[40:43], a[156:159], a[212:215], a[40:43]
  ds_read_b64_tr_b16 a[190:191], v11 offset:9472
  v_mfma_f32_16x16x32_bf16 a[8:11], a[144:147], a[216:219], a[8:11]
  ds_read_b64_tr_b16 a[192:193], v5 offset:8704
  v_mfma_f32_16x16x32_bf16 a[20:23], a[148:151], a[216:219], a[20:23]
  ds_read_b64_tr_b16 a[194:195], v5 offset:9728
  v_mfma_f32_16x16x32_bf16 a[32:35], a[152:155], a[216:219], a[32:35]
  ds_read_b64_tr_b16 a[196:197], v11 offset:8704
  v_mfma_f32_16x16x32_bf16 a[44:47], a[156:159], a[216:219], a[44:47]
  ds_read_b64_tr_b16 a[198:199], v11 offset:9728
  s_waitcnt lgkmcnt(12)
  v_mfma_f32_16x16x32_bf16 a[48:51], a[160:163], a[208:211], a[48:51]
  ds_read_b64_tr_b16 a[200:201], v5 offset:8960
  v_mfma_f32_16x16x32_bf16 a[60:63], a[164:167], a[208:211], a[60:63]
  ds_read_b64_tr_b16 a[202:203], v5 offset:9984
  v_mfma_f32_16x16x32_bf16 a[72:75], a[168:171], a[208:211], a[72:75]
  ds_read_b64_tr_b16 a[204:205], v11 offset:8960
  v_mfma_f32_16x16x32_bf16 a[84:87], a[172:175], a[208:211], a[84:87]
  ds_read_b64_tr_b16 a[206:207], v11 offset:9984
  v_mfma_f32_16x16x32_bf16 a[52:55], a[160:163], a[212:215], a[52:55]
  ds_read_b32 v248, v251 offset:20480
  v_add_u32 v5, 32768, v2
  v_mfma_f32_16x16x32_bf16 a[64:67], a[164:167], a[212:215], a[64:67]
  v_xor_b32 v11, 8, v5
  v_add_u32 v7, 114688, v129
  v_mfma_f32_16x16x32_bf16 a[76:79], a[168:171], a[212:215], a[76:79]
  v_mfma_f32_16x16x32_bf16 a[88:91], a[172:175], a[212:215], a[88:91]
  v_mfma_f32_16x16x32_bf16 a[56:59], a[160:163], a[216:219], a[56:59]
  v_mfma_f32_16x16x32_bf16 a[68:71], a[164:167], a[216:219], a[68:71]
  v_mfma_f32_16x16x32_bf16 a[80:83], a[168:171], a[216:219], a[80:83]
  v_mfma_f32_16x16x32_bf16 a[92:95], a[172:175], a[216:219], a[92:95]
  s_waitcnt lgkmcnt(0)
  ds_write_b32 v249, v250 offset:0
  v_add_u32 v250, 1, v250
  v_readfirstlane_b32 s56, v248
  s_nop 1
  s_cmp_ge_u32 s56, s54
  s_cbranch_scc0 L_spin_p3
L_spun_p3:
  v_mfma_f32_16x16x32_bf16 a[0:3], a[176:179], a[220:223], a[0:3]
  ds_read_b64_tr_b16 a[144:145], v5 offset:0
  v_mfma_f32_16x16x32_bf16 a[12:15], a[180:183], a[220:223], a[12:15]
  ds_read_b64_tr_b16 a[146:147], v5 offset:1024
  v_mfma_f32_16x16x32_bf16 a[24:27], a[184:187], a[220:223], a[24:27]
  ds_read_b64_tr_b16 a[148:149], v11 offset:0
  v_mfma_f32_16x16x32_bf16 a[36:39], a[188:191], a[220:223], a[36:39]
  ds_read_b64_tr_b16 a[150:151], v11 offset:1024
  v_mfma_f32_16x16x32_bf16 a[4:7], a[176:179], a[224:227], a[4:7]
  ds_read_b64_tr_b16 a[152:153], v5 offset:256
  v_mfma_f32_16x16x32_bf16 a[16:19], a[180:183], a[224:227], a[16:19]
  ds_read_b64_tr_b16 a[154:155], v5 offset:1280
  v_mfma_f32_16x16x32_bf16 a[28:31], a[184:187], a[224:227], a[28:31]
  ds_read_b64_tr_b16 a[156:157], v11 offset:256
  v_mfma_f32_16x16x32_bf16 a[40:43], a[188:191], a[224:227], a[40:43]
  ds_read_b64_tr_b16 a[158:159], v11 offset:1280
  v_mfma_f32_16x16x32_bf16 a[8:11], a[176:179], a[228:231], a[8:11]
  ds_read_b128 a[208:211], v7 offset:0
  v_mfma_f32_16x16x32_bf16 a[20:23], a[180:183], a[228:231], a[20:23]
  ds_read_b128 a[212:215], v7 offset:2048
  v_mfma_f32_16x16x32_bf16 a[32:35], a[184:187], a[228:231], a[32:35]
  ds_read_b128 a[216:219], v7 offset:4096
  v_mfma_f32_16x16x32_bf16 a[44:47], a[188:191], a[228:231], a[44:47]
  ds_read_b64_tr_b16 a[160:161], v5 offset:512
  v_mfma_f32_16x16x32_bf16 a[48:51], a[192:195], a[220:223], a[48:51]
  ds_read_b64_tr_b16 a[162:163], v5 offset:1536
  v_mfma_f32_16x16x32_bf16 a[60:63], a[196:199], a[220:223], a[60:63]
  ds_read_b64_tr_b16 a[164:165], v11 offset:512
  v_mfma_f32_16x16x32_bf16 a[72:75], a[200:203], a[220:223], a[72:75]
  ds_read_b64_tr_b16 a[166:167], v11 offset:1536
  v_mfma_f32_16x16x32_bf16 a[84:87], a[204:207], a[220:223], a[84:87]
  ds_read_b64_tr_b16 a[168:169], v5 offset:768
  v_mfma_f32_16x16x32_bf16 a[52:55], a[192:195], a[224:227], a[52:55]
  ds_read_b64_tr_b16 a[170:171], v5 offset:1792
  v_mfma_f32_16x16x32_bf16 a[64:67], a[196:199], a[224:227], a[64:67]
  ds_read_b64_tr_b16 a[172:173], v11 offset:768
  v_mfma_f32_16x16x32_bf16 a[76:79], a[200:203], a[224:227], a[76:79]
  ds_read_b64_tr_b16 a[174:175], v11 offset:1792
  v_mfma_f32_16x16x32_bf16 a[88:91], a[204:207], a[224:227], a[88:91]
  v_mfma_f32_16x16x32_bf16 a[56:59], a[192:195], a[228:231], a[56:59]
  v_mfma_f32_16x16x32_bf16 a[68:71], a[196:199], a[228:231], a[68:71]
  v_mfma_f32_16x16x32_bf16 a[80:83], a[200:203], a[228:231], a[80:83]
  v_mfma_f32_16x16x32_bf16 a[92:95], a[204:207], a[228:231], a[92:95]
  s_waitcnt lgkmcnt(8)
  v_mfma_f32_16x16x32_bf16 v[32:35], a[144:147], a[208:211], v[32:35]
  ds_read_b64_tr_b16 a[176:177], v5 offset:8192
  s_mov_b32 s54, 9
  v_mfma_f32_16x16x32_bf16 v[44:47], a[148:151], a[208:211], v[44:47]
  ds_read_b64_tr_b16 a[178:179], v5 offset:9216
  v_mfma_f32_16x16x32_bf16 v[56:59], a[152:155], a[208:211], v[56:59]
  ds_read_b64_tr_b16 a[180:181], v11 offset:8192
  v_mfma_f32_16x16x32_bf16 v[68:71], a[156:159], a[208:211], v[68:71]
  ds_read_b64_tr_b16 a[182:183], v11 offset:9216
  v_mfma_f32_16x16x32_bf16 v[36:39], a[144:147], a[212:215], v[36:39]
  ds_read_b64_tr_b16 a[184:185], v5 offset:8448
  v_mfma_f32_16x16x32_bf16 v[48:51], a[148:151], a[212:215], v[48:51]
  ds_read_b64_tr_b16 a[186:187], v5 offset:9472
  v_mfma_f32_16x16x32_bf16 v[60:63], a[152:155], a[212:215], v[60:63]
  ds_read_b64_tr_b16 a[188:189], v11 offset:8448
  v_mfma_f32_16x16x32_bf16 v[72:75], a[156:159], a[212:215], v[72:75]
  ds_read_b64_tr_b16 a[190:191], v11 offset:9472
  v_mfma_f32_16x16x32_bf16 v[40:43], a[144:147], a[216:219], v[40:43]
  ds_read_b128 a[220:223], v7 offset:512
  v_mfma_f32_16x16x32_bf16 v[52:55], a[148:151], a[216:219], v[52:55]
  ds_read_b128 a[224:227], v7 offset:2560
  v_mfma_f32_16x16x32_bf16 v[64:67], a[152:155], a[216:219], v[64:67]
  ds_read_b128 a[228:231], v7 offset:4608
  v_mfma_f32_16x16x32_bf16 v[76:79], a[156:159], a[216:219], v[76:79]
  ds_read_b64_tr_b16 a[192:193], v5 offset:8704
  s_waitcnt lgkmcnt(12)
  v_mfma_f32_16x16x32_bf16 v[80:83], a[160:163], a[208:211], v[80:83]
  ds_read_b64_tr_b16 a[194:195], v5 offset:9728
  v_mfma_f32_16x16x32_bf16 v[92:95], a[164:167], a[208:211], v[92:95]
  ds_read_b64_tr_b16 a[196:197], v11 offset:8704
  v_mfma_f32_16x16x32_bf16 v[104:107], a[168:171], a[208:211], v[104:107]
  ds_read_b64_tr_b16 a[198:199], v11 offset:9728
  v_mfma_f32_16x16x32_bf16 v[116:119], a[172:175], a[208:211], v[116:119]
  ds_read_b64_tr_b16 a[200:201], v5 offset:8960
  v_mfma_f32_16x16x32_bf16 v[84:87], a[160:163], a[212:215], v[84:87]
  ds_read_b64_tr_b16 a[202:203], v5 offset:9984
  v_mfma_f32_16x16x32_bf16 v[96:99], a[164:167], a[212:215], v[96:99]
  ds_read_b64_tr_b16 a[204:205], v11 offset:8960
  v_mfma_f32_16x16x32_bf16 v[108:111], a[168:171], a[212:215], v[108:111]
  ds_read_b64_tr_b16 a[206:207], v11 offset:9984
  v_mfma_f32_16x16x32_bf16 v[120:123], a[172:175], a[212:215], v[120:123]
  ds_read_b32 v248, v251 offset:20480
  v_add_u32 v5, 98304, v2
  v_mfma_f32_16x16x32_bf16 v[88:91], a[160:163], a[216:219], v[88:91]
  v_xor_b32 v11, 8, v5
  v_mfma_f32_16x16x32_bf16 v[100:103], a[164:167], a[216:219], v[100:103]
  v_mfma_f32_16x16x32_bf16 v[112:115], a[168:171], a[216:219], v[112:115]
  v_mfma_f32_16x16x32_bf16 v[124:127], a[172:175], a[216:219], v[124:127]
  s_waitcnt lgkmcnt(0)
  ds_write_b32 v249, v250 offset:0
  v_add_u32 v250, 1, v250
  v_readfirstlane_b32 s56, v248
  s_nop 1
  s_cmp_ge_u32 s56, s54
  s_cbranch_scc0 L_spin_p4
L_spun_p4:
  v_mfma_f32_16x16x32_bf16 v[32:35], a[176:179], a[220:223], v[32:35]
  ds_read_b64_tr_b16 a[144:145], v5 offset:0
  v_mfma_f32_16x16x32_bf16 v[44:47], a[180:183], a[220:223], v[44:47]
  ds_read_b64_tr_b16 a[146:147], v5 offset:1024
  v_mfma_f32_16x16x32_bf16 v[56:59], a[184:187], a[220:223], v[56:59]
  ds_read_b64_tr_b16 a[148:149], v11 offset:0
  v_mfma_f32_16x16x32_bf16 v[68:71], a[188:191], a[220:223], v[68:71]
  ds_read_b64_tr_b16 a[150:151], v11 offset:1024
  v_mfma_f32_16x16x32_bf16 v[36:39], a[176:179], a[224:227], v[36:39]
  ds_read_b64_tr_b16 a[152:153], v5 offset:256
  v_mfma_f32_16x16x32_bf16 v[48:51], a[180:183], a[224:227], v[48:51]
  ds_read_b64_tr_b16 a[154:155], v5 offset:1280
  v_mfma_f32_16x16x32_bf16 v[60:63], a[184:187], a[224:227], v[60:63]
  ds_read_b64_tr_b16 a[156:157], v11 offset:256
  v_mfma_f32_16x16x32_bf16 v[72:75], a[188:191], a[224:227], v[72:75]
  ds_read_b64_tr_b16 a[158:159], v11 offset:1280
  v_mfma_f32_16x16x32_bf16 v[40:43], a[176:179], a[228:231], v[40:43]
  ds_read_b64_tr_b16 a[160:161], v5 offset:512
  v_mfma_f32_16x16x32_bf16 v[52:55], a[180:183], a[228:231], v[52:55]
  ds_read_b64_tr_b16 a[162:163], v5 offset:1536
  v_mfma_f32_16x16x32_bf16 v[64:67], a[184:187], a[228:231], v[64:67]
  ds_read_b64_tr_b16 a[164:165], v11 offset:512
  v_mfma_f32_16x16x32_bf16 v[76:79], a[188:191], a[228:231], v[76:79]
  ds_read_b64_tr_b16 a[166:167], v11 offset:1536
  v_mfma_f32_16x16x32_bf16 v[80:83], a[192:195], a[220:223], v[80:83]
  ds_read_b64_tr_b16 a[168:169], v5 offset:768
  v_mfma_f32_16x16x32_bf16 v[92:95], a[196:199], a[220:223], v[92:95]
  ds_read_b64_tr_b16 a[170:171], v5 offset:1792
  v_mfma_f32_16x16x32_bf16 v[104:107], a[200:203], a[220:223], v[104:107]
  ds_read_b64_tr_b16 a[172:173], v11 offset:768
  v_mfma_f32_16x16x32_bf16 v[116:119], a[204:207], a[220:223], v[116:119]
  ds_read_b64_tr_b16 a[174:175], v11 offset:1792
  v_mfma_f32_16x16x32_bf16 v[84:87], a[192:195], a[224:227], v[84:87]
  v_mfma_f32_16x16x32_bf16 v[96:99], a[196:199], a[224:227], v[96:99]
  v_mfma_f32_16x16x32_bf16 v[108:111], a[200:203], a[224:227], v[108:111]
  v_mfma_f32_16x16x32_bf16 v[120:123], a[204:207], a[224:227], v[120:123]
  v_mfma_f32_16x16x32_bf16 v[88:91], a[192:195], a[228:231], v[88:91]
  v_mfma_f32_16x16x32_bf16 v[100:103], a[196:199], a[228:231], v[100:103]
  v_mfma_f32_16x16x32_bf16 v[112:115], a[200:203], a[228:231], v[112:115]
  v_mfma_f32_16x16x32_bf16 v[124:127], a[204:207], a[228:231], v[124:127]
  s_waitcnt lgkmcnt(8)
  v_mfma_f32_16x16x32_bf16 a[0:3], a[144:147], a[208:211], a[0:3]
  ds_read_b64_tr_b16 a[176:177], v5 offset:8192
  s_mov_b32 s54, 12
  v_mfma_f32_16x16x32_bf16 a[12:15], a[148:151], a[208:211], a[12:15]
  ds_read_b64_tr_b16 a[178:179], v5 offset:9216
  v_mfma_f32_16x16x32_bf16 a[24:27], a[152:155], a[208:211], a[24:27]
  ds_read_b64_tr_b16 a[180:181], v11 offset:8192
  v_mfma_f32_16x16x32_bf16 a[36:39], a[156:159], a[208:211], a[36:39]
  ds_read_b64_tr_b16 a[182:183], v11 offset:9216
  v_mfma_f32_16x16x32_bf16 a[4:7], a[144:147], a[212:215], a[4:7]
  ds_read_b64_tr_b16 a[184:185], v5 offset:8448
  v_mfma_f32_16x16x32_bf16 a[16:19], a[148:151], a[212:215], a[16:19]
  ds_read_b64_tr_b16 a[186:187], v5 offset:9472
  v_mfma_f32_16x16x32_bf16 a[28:31], a[152:155], a[212:215], a[28:31]
  ds_read_b64_tr_b16 a[188:189], v11 offset:8448
  v_mfma_f32_16x16x32_bf16 a[40:43], a[156:159], a[212:215], a[40:43]
  ds_read_b64_tr_b16 a[190:191], v11 offset:9472
  v_mfma_f32_16x16x32_bf16 a[8:11], a[144:147], a[216:219], a[8:11]
  ds_read_b64_tr_b16 a[192:193], v5 offset:8704
  v_mfma_f32_16x16x32_bf16 a[20:23], a[148:151], a[216:219], a[20:23]
  ds_read_b64_tr_b16 a[194:195], v5 offset:9728
  v_mfma_f32_16x16x32_bf16 a[32:35], a[152:155], a[216:219], a[32:35]
  ds_read_b64_tr_b16 a[196:197], v11 offset:8704
  v_mfma_f32_16x16x32_bf16 a[44:47], a[156:159], a[216:219], a[44:47]
  ds_read_b64_tr_b16 a[198:199], v11 offset:9728
  s_waitcnt lgkmcnt(12)
  v_mfma_f32_16x16x32_bf16 a[48:51], a[160:163], a[208:211], a[48:51]
  ds_read_b64_tr_b16 a[200:201], v5 offset:8960
  v_mfma_f32_16x16x32_bf16 a[60:63], a[164:167], a[208:211], a[60:63]
  ds_read_b64_tr_b16 a[202:203], v5 offset:9984
  v_mfma_f32_16x16x32_bf16 a[72:75], a[168:171], a[208:211], a[72:75]
  ds_read_b64_tr_b16 a[204:205], v11 offset:8960
  v_mfma_f32_16x16x32_bf16 a[84:87], a[172:175], a[208:211], a[84:87]
  ds_read_b64_tr_b16 a[206:207], v11 offset:9984
  v_mfma_f32_16x16x32_bf16 a[52:55], a[160:163], a[212:215], a[52:55]
  ds_read_b32 v248, v251 offset:20480
  v_add_u32 v5, 49152, v2
  v_mfma_f32_16x16x32_bf16 a[64:67], a[164:167], a[212:215], a[64:67]
  v_xor_b32 v11, 8, v5
  v_add_u32 v7, 133120, v129
  v_mfma_f32_16x16x32_bf16 a[76:79], a[168:171], a[212:215], a[76:79]
  v_mfma_f32_16x16x32_bf16 a[88:91], a[172:175], a[212:215], a[88:91]
  v_mfma_f32_16x16x32_bf16 a[56:59], a[160:163], a[216:219], a[56:59]
  v_mfma_f32_16x16x32_bf16 a[68:71], a[164:167], a[216:219], a[68:71]
  v_mfma_f32_16x16x32_bf16 a[80:83], a[168:171], a[216:219], a[80:83]
  v_mfma_f32_16x16x32_bf16 a[92:95], a[172:175], a[216:219], a[92:95]
  s_waitcnt lgkmcnt(0)
  ds_write_b32 v249, v250 offset:0
  v_add_u32 v250, 1, v250
  v_readfirstlane_b32 s56, v248
  s_nop 1
  s_cmp_ge_u32 s56, s54
  s_cbranch_scc0 L_spin_p5
L_spun_p5:
  v_mfma_f32_16x16x32_bf16 a[0:3], a[176:179], a[220:223], a[0:3]
  ds_read_b64_tr_b16 a[144:145], v5 offset:0
  v_mfma_f32_16x16x32_bf16 a[12:15], a[180:183], a[220:223], a[12:15]
  ds_read_b64_tr_b16 a[146:147], v5 offset:1024
  v_mfma_f32_16x16x32_bf16 a[24:27], a[184:187], a[220:223], a[24:27]
  ds_read_b64_tr_b16 a[148:149], v11 offset:0
  v_mfma_f32_16x16x32_bf16 a[36:39], a[188:191], a[220:223], a[36:39]
  ds_read_b64_tr_b16 a[150:151], v11 offset:1024
  v_mfma_f32_16x16x32_bf16 a[4:7], a[176:179], a[224:227], a[4:7]
  ds_read_b64_tr_b16 a[152:153], v5 offset:256
  v_mfma_f32_16x16x32_bf16 a[16:19], a[180:183], a[224:227], a[16:19]
  ds_read_b64_tr_b16 a[154:155], v5 offset:1280
  v_mfma_f32_16x16x32_bf16 a[28:31], a[184:187], a[224:227], a[28:31]
  ds_read_b64_tr_b16 a[156:157], v11 offset:256
  v_mfma_f32_16x16x32_bf16 a[40:43], a[188:191], a[224:227], a[40:43]
  ds_read_b64_tr_b16 a[158:159], v11 offset:1280
  v_mfma_f32_16x16x32_bf16 a[8:11], a[176:179], a[228:231], a[8:11]
  ds_read_b128 a[208:211], v7 offset:0
  v_mfma_f32_16x16x32_bf16 a[20:23], a[180:183], a[228:231], a[20:23]
  ds_read_b128 a[212:215], v7 offset:2048
  v_mfma_f32_16x16x32_bf16 a[32:35], a[184:187], a[228:231], a[32:35]
  ds_read_b128 a[216:219], v7 offset:4096
  v_mfma_f32_16x16x32_bf16 a[44:47], a[188:191], a[228:231], a[44:47]
  ds_read_b64_tr_b16 a[160:161], v5 offset:512
  v_mfma_f32_16x16x32_bf16 a[48:51], a[192:195], a[220:223], a[48:51]
  ds_read_b64_tr_b16 a[162:163], v5 offset:1536
  v_mfma_f32_16x16x32_bf16 a[60:63], a[196:199], a[220:223], a[60:63]
  ds_read_b64_tr_b16 a[164:165], v11 offset:512
  v_mfma_f32_16x16x32_bf16 a[72:75], a[200:203], a[220:223], a[72:75]
  ds_read_b64_tr_b16 a[166:167], v11 offset:1536
  v_mfma_f32_16x16x32_bf16 a[84:87], a[204:207], a[220:223], a[84:87]
  ds_read_b64_tr_b16 a[168:169], v5 offset:768
  v_mfma_f32_16x16x32_bf16 a[52:55], a[192:195], a[224:227], a[52:55]
  ds_read_b64_tr_b16 a[170:171], v5 offset:1792
  v_mfma_f32_16x16x32_bf16 a[64:67], a[196:199], a[224:227], a[64:67]
  ds_read_b64_tr_b16 a[172:173], v11 offset:768
  v_mfma_f32_16x16x32_bf16 a[76:79], a[200:203], a[224:227], a[76:79]
  ds_read_b64_tr_b16 a[174:175], v11 offset:1792
  v_mfma_f32_16x16x32_bf16 a[88:91], a[204:207], a[224:227], a[88:91]
  v_mfma_f32_16x16x32_bf16 a[56:59], a[192:195], a[228:231], a[56:59]
  v_mfma_f32_16x16x32_bf16 a[68:71], a[196:199], a[228:231], a[68:71]
  v_mfma_f32_16x16x32_bf16 a[80:83], a[200:203], a[228:231], a[80:83]
  v_mfma_f32_16x16x32_bf16 a[92:95], a[204:207], a[228:231], a[92:95]
  s_waitcnt lgkmcnt(8)
  v_mfma_f32_16x16x32_bf16 v[32:35], a[144:147], a[208:211], v[32:35]
  ds_read_b64_tr_b16 a[176:177], v5 offset:8192
  s_mov_b32 s54, 13
  v_mfma_f32_16x16x32_bf16 v[44:47], a[148:151], a[208:211], v[44:47]
  ds_read_b64_tr_b16 a[178:179], v5 offset:9216
  v_mfma_f32_16x16x32_bf16 v[56:59], a[152:155], a[208:211], v[56:59]
  ds_read_b64_tr_b16 a[180:181], v11 offset:8192
  v_mfma_f32_16x16x32_bf16 v[68:71], a[156:159], a[208:211], v[68:71]
  ds_read_b64_tr_b16 a[182:183], v11 offset:9216
  v_mfma_f32_16x16x32_bf16 v[36:39], a[144:147], a[212:215], v[36:39]
  ds_read_b64_tr_b16 a[184:185], v5 offset:8448
  v_mfma_f32_16x16x32_bf16 v[48:51], a[148:151], a[212:215], v[48:51]
  ds_read_b64_tr_b16 a[186:187], v5 offset:9472
  v_mfma_f32_16x16x32_bf16 v[60:63], a[152:155], a[212:215], v[60:63]
  ds_read_b64_tr_b16 a[188:189], v11 offset:8448
  v_mfma_f32_16x16x32_bf16 v[72:75], a[156:159], a[212:215], v[72:75]
  ds_read_b64_tr_b16 a[190:191], v11 offset:9472
  v_mfma_f32_16x16x32_bf16 v[40:43], a[144:147], a[216:219], v[40:43]
  ds_read_b128 a[220:223], v7 offset:512
  v_mfma_f32_16x16x32_bf16 v[52:55], a[148:151], a[216:219], v[52:55]
  ds_read_b128 a[224:227], v7 offset:2560
  v_mfma_f32_16x16x32_bf16 v[64:67], a[152:155], a[216:219], v[64:67]
  ds_read_b128 a[228:231], v7 offset:4608
  v_mfma_f32_16x16x32_bf16 v[76:79], a[156:159], a[216:219], v[76:79]
  ds_read_b64_tr_b16 a[192:193], v5 offset:8704
  s_waitcnt lgkmcnt(12)
  v_mfma_f32_16x16x32_bf16 v[80:83], a[160:163], a[208:211], v[80:83]
  ds_read_b64_tr_b16 a[194:195], v5 offset:9728
  v_mfma_f32_16x16x32_bf16 v[92:95], a[164:167], a[208:211], v[92:95]
  ds_read_b64_tr_b16 a[196:197], v11 offset:8704
  v_mfma_f32_16x16x32_bf16 v[104:107], a[168:171], a[208:211], v[104:107]
  ds_read_b64_tr_b16 a[198:199], v11 offset:9728
  v_mfma_f32_16x16x32_bf16 v[116:119], a[172:175], a[208:211], v[116:119]
  ds_read_b64_tr_b16 a[200:201], v5 offset:8960
  v_mfma_f32_16x16x32_bf16 v[84:87], a[160:163], a[212:215], v[84:87]
  ds_read_b64_tr_b16 a[202:203], v5 offset:9984
  v_mfma_f32_16x16x32_bf16 v[96:99], a[164:167], a[212:215], v[96:99]
  ds_read_b64_tr_b16 a[204:205], v11 offset:8960
  v_mfma_f32_16x16x32_bf16 v[108:111], a[168:171], a[212:215], v[108:111]
  ds_read_b64_tr_b16 a[206:207], v11 offset:9984
  v_mfma_f32_16x16x32_bf16 v[120:123], a[172:175], a[212:215], v[120:123]
  ds_read_b32 v248, v251 offset:20480
  v_add_u32 v5, 65536, v2
  v_mfma_f32_16x16x32_bf16 v[88:91], a[160:163], a[216:219], v[88:91]
  v_xor_b32 v11, 8, v5
  v_mfma_f32_16x16x32_bf16 v[100:103], a[164:167], a[216:219], v[100:103]
  v_mfma_f32_16x16x32_bf16 v[112:115], a[168:171], a[216:219], v[112:115]
  v_mfma_f32_16x16x32_bf16 v[124:127], a[172:175], a[216:219], v[124:127]
  s_waitcnt lgkmcnt(0)
  ds_write_b32 v249, v250 offset:0
  v_add_u32 v250, 1, v250
  v_readfirstlane_b32 s56, v248
  s_nop 1
  s_cmp_ge_u32 s56, s54
  s_cbranch_scc0 L_spin_p6
L_spun_p6:
  v_mfma_f32_16x16x32_bf16 v[32:35], a[176:179], a[220:223], v[32:35]
  ds_read_b64_tr_b16 a[144:145], v5 offset:0
  v_mfma_f32_16x16x32_bf16 v[44:47], a[180:183], a[220:223], v[44:47]
  ds_read_b64_tr_b16 a[146:147], v5 offset:1024
  v_mfma_f32_16x16x32_bf16 v[56:59], a[184:187], a[220:223], v[56:59]
  ds_read_b64_tr_b16 a[148:149], v11 offset:0
  v_mfma_f32_16x16x32_bf16 v[68:71], a[188:191], a[220:223], v[68:71]
  ds_read_b64_tr_b16 a[150:151], v11 offset:1024
  v_mfma_f32_16x16x32_bf16 v[36:39], a[176:179], a[224:227], v[36:39]
  ds_read_b64_tr_b16 a[152:153], v5 offset:256
  v_mfma_f32_16x16x32_bf16 v[48:51], a[180:183], a[224:227], v[48:51]
  ds_read_b64_tr_b16 a[154:155], v5 offset:1280
  v_mfma_f32_16x16x32_bf16 v[60:63], a[184:187], a[224:227], v[60:63]
  ds_read_b64_tr_b16 a[156:157], v11 offset:256
  v_mfma_f32_16x16x32_bf16 v[72:75], a[188:191], a[224:227], v[72:75]
  ds_read_b64_tr_b16 a[158:159], v11 offset:1280
  v_mfma_f32_16x16x32_bf16 v[40:43], a[176:179], a[228:231], v[40:43]
  ds_read_b64_tr_b16 a[160:161], v5 offset:512
  v_mfma_f32_16x16x32_bf16 v[52:55], a[180:183], a[228:231], v[52:55]
  ds_read_b64_tr_b16 a[162:163], v5 offset:1536
  v_mfma_f32_16x16x32_bf16 v[64:67], a[184:187], a[228:231], v[64:67]
  ds_read_b64_tr_b16 a[164:165], v11 offset:512
  v_mfma_f32_16x16x32_bf16 v[76:79], a[188:191], a[228:231], v[76:79]
  ds_read_b64_tr_b16 a[166:167], v11 offset:1536
  v_mfma_f32_16x16x32_bf16 v[80:83], a[192:195], a[220:223], v[80:83]
  ds_read_b64_tr_b16 a[168:169], v5 offset:768
  v_mfma_f32_16x16x32_bf16 v[92:95], a[196:199], a[220:223], v[92:95]
  ds_read_b64_tr_b16 a[170:171], v5 offset:1792
  v_mfma_f32_16x16x32_bf16 v[104:107], a[200:203], a[220:223], v[104:107]
  ds_read_b64_tr_b16 a[172:173], v11 offset:768
  v_mfma_f32_16x16x32_bf16 v[116:119], a[204:207], a[220:223], v[116:119]
  ds_read_b64_tr_b16 a[174:175], v11 offset:1792
  v_mfma_f32_16x16x32_bf16 v[84:87], a[192:195], a[224:227], v[84:87]
  v_mfma_f32_16x16x32_bf16 v[96:99], a[196:199], a[224:227], v[96:99]
  v_mfma_f32_16x16x32_bf16 v[108:111], a[200:203], a[224:227], v[108:111]
  v_mfma_f32_16x16x32_bf16 v[120:123], a[204:207], a[224:227], v[120:123]
  v_mfma_f32_16x16x32_bf16 v[88:91], a[192:195], a[228:231], v[88:91]
  v_mfma_f32_16x16x32_bf16 v[100:103], a[196:199], a[228:231], v[100:103]
  v_mfma_f32_16x16x32_bf16 v[112:115], a[200:203], a[228:231], v[112:115]
  v_mfma_f32_16x16x32_bf16 v[124:127], a[204:207], a[228:231], v[124:127]
  s_waitcnt lgkmcnt(8)
  v_mfma_f32_16x16x32_bf16 a[0:3], a[144:147], a[208:211], a[0:3]
  ds_read_b64_tr_b16 a[176:177], v5 offset:8192
  s_mov_b32 s54, 15
  v_mfma_f32_16x16x32_bf16 a[12:15], a[148:151], a[208:211], a[12:15]
  ds_read_b64_tr_b16 a[178:179], v5 offset:9216
  v_mfma_f32_16x16x32_bf16 a[24:27], a[152:155], a[208:211], a[24:27]
  ds_read_b64_tr_b16 a[180:181], v11 offset:8192
  v_mfma_f32_16x16x32_bf16 a[36:39], a[156:159], a[208:211], a[36:39]
  ds_read_b64_tr_b16 a[182:183], v11 offset:9216
  v_mfma_f32_16x16x32_bf16 a[4:7], a[144:147], a[212:215], a[4:7]
  ds_read_b64_tr_b16 a[184:185], v5 offset:8448
  v_mfma_f32_16x16x32_bf16 a[16:19], a[148:151], a[212:215], a[16:19]
  ds_read_b64_tr_b16 a[186:187], v5 offset:9472
  v_mfma_f32_16x16x32_bf16 a[28:31], a[152:155], a[212:215], a[28:31]
  ds_read_b64_tr_b16 a[188:189], v11 offset:8448
  v_mfma_f32_16x16x32_bf16 a[40:43], a[156:159], a[212:215], a[40:43]
  ds_read_b64_tr_b16 a[190:191], v11 offset:9472
  v_mfma_f32_16x16x32_bf16 a[8:11], a[144:147], a[216:219], a[8:11]
  ds_read_b64_tr_b16 a[192:193], v5 offset:8704
  v_mfma_f32_16x16x32_bf16 a[20:23], a[148:151], a[216:219], a[20:23]
  ds_read_b64_tr_b16 a[194:195], v5 offset:9728
  v_mfma_f32_16x16x32_bf16 a[32:35], a[152:155], a[216:219], a[32:35]
  ds_read_b64_tr_b16 a[196:197], v11 offset:8704
  v_mfma_f32_16x16x32_bf16 a[44:47], a[156:159], a[216:219], a[44:47]
  ds_read_b64_tr_b16 a[198:199], v11 offset:9728
  s_waitcnt lgkmcnt(12)
  v_mfma_f32_16x16x32_bf16 a[48:51], a[160:163], a[208:211], a[48:51]
  ds_read_b64_tr_b16 a[200:201], v5 offset:8960
  v_mfma_f32_16x16x32_bf16 a[60:63], a[164:167], a[208:211], a[60:63]
  ds_read_b64_tr_b16 a[202:203], v5 offset:9984
  v_mfma_f32_16x16x32_bf16 a[72:75], a[168:171], a[208:211], a[72:75]
  ds_read_b64_tr_b16 a[204:205], v11 offset:8960
  v_mfma_f32_16x16x32_bf16 a[84:87], a[172:175], a[208:211], a[84:87]
  ds_read_b64_tr_b16 a[206:207], v11 offset:9984
  v_mfma_f32_16x16x32_bf16 a[52:55], a[160:163], a[212:215], a[52:55]
  ds_read_b32 v248, v251 offset:20480
  v_add_u32 v5, 32768, v2
  v_mfma_f32_16x16x32_bf16 a[64:67], a[164:167], a[212:215], a[64:67]
  v_xor_b32 v11, 8, v5
  v_add_u32 v7, 114688, v129
  v_mfma_f32_16x16x32_bf16 a[76:79], a[168:171], a[212:215], a[76:79]
  v_mfma_f32_16x16x32_bf16 a[88:91], a[172:175], a[212:215], a[88:91]
  v_mfma_f32_16x16x32_bf16 a[56:59], a[160:163], a[216:219], a[56:59]
  v_mfma_f32_16x16x32_bf16 a[68:71], a[164:167], a[216:219], a[68:71]
  v_mfma_f32_16x16x32_bf16 a[80:83], a[168:171], a[216:219], a[80:83]
  v_mfma_f32_16x16x32_bf16 a[92:95], a[172:175], a[216:219], a[92:95]
  s_waitcnt lgkmcnt(0)
  ds_write_b32 v249, v250 offset:0
  v_add_u32 v250, 1, v250
  v_readfirstlane_b32 s56, v248
  s_nop 1
  s_cmp_ge_u32 s56, s54
  s_cbranch_scc0 L_spin_p7
L_spun_p7:
  v_mfma_f32_16x16x32_bf16 a[0:3], a[176:179], a[220:223], a[0:3]
  ds_read_b64_tr_b16 a[144:145], v5 offset:0
  v_mfma_f32_16x16x32_bf16 a[12:15], a[180:183], a[220:223], a[12:15]
  ds_read_b64_tr_b16 a[146:147], v5 offset:1024
  v_mfma_f32_16x16x32_bf16 a[24:27], a[184:187], a[220:223], a[24:27]
  ds_read_b64_tr_b16 a[148:149], v11 offset:0
  v_mfma_f32_16x16x32_bf16 a[36:39], a[188:191], a[220:223], a[36:39]
  ds_read_b64_tr_b16 a[150:151], v11 offset:1024
  v_mfma_f32_16x16x32_bf16 a[4:7], a[176:179], a[224:227], a[4:7]
  ds_read_b64_tr_b16 a[152:153], v5 offset:256
  v_mfma_f32_16x16x32_bf16 a[16:19], a[180:183], a[224:227], a[16:19]
  ds_read_b64_tr_b16 a[154:155], v5 offset:1280
  v_mfma_f32_16x16x32_bf16 a[28:31], a[184:187], a[224:227], a[28:31]
  ds_read_b64_tr_b16 a[156:157], v11 offset:256
  v_mfma_f32_16x16x32_bf16 a[40:43], a[188:191], a[224:227], a[40:43]
  ds_read_b64_tr_b16 a[158:159], v11 offset:1280
  v_mfma_f32_16x16x32_bf16 a[8:11], a[176:179], a[228:231], a[8:11]
  ds_read_b128 a[208:211], v7 offset:0
  v_mfma_f32_16x16x32_bf16 a[20:23], a[180:183], a[228:231], a[20:23]
  ds_read_b128 a[212:215], v7 offset:2048
  v_mfma_f32_16x16x32_bf16 a[32:35], a[184:187], a[228:231], a[32:35]
  ds_read_b128 a[216:219], v7 offset:4096
  v_mfma_f32_16x16x32_bf16 a[44:47], a[188:191], a[228:231], a[44:47]
  ds_read_b64_tr_b16 a[160:161], v5 offset:512
  v_mfma_f32_16x16x32_bf16 a[48:51], a[192:195], a[220:223], a[48:51]
  ds_read_b64_tr_b16 a[162:163], v5 offset:1536
  v_mfma_f32_16x16x32_bf16 a[60:63], a[196:199], a[220:223], a[60:63]
  ds_read_b64_tr_b16 a[164:165], v11 offset:512
  v_mfma_f32_16x16x32_bf16 a[72:75], a[200:203], a[220:223], a[72:75]
  ds_read_b64_tr_b16 a[166:167], v11 offset:1536
  v_mfma_f32_16x16x32_bf16 a[84:87], a[204:207], a[220:223], a[84:87]
  ds_read_b64_tr_b16 a[168:169], v5 offset:768
  v_mfma_f32_16x16x32_bf16 a[52:55], a[192:195], a[224:227], a[52:55]
  ds_read_b64_tr_b16 a[170:171], v5 offset:1792
  v_mfma_f32_16x16x32_bf16 a[64:67], a[196:199], a[224:227], a[64:67]
  ds_read_b64_tr_b16 a[172:173], v11 offset:768
  v_mfma_f32_16x16x32_bf16 a[76:79], a[200:203], a[224:227], a[76:79]
  ds_read_b64_tr_b16 a[174:175], v11 offset:1792
  v_mfma_f32_16x16x32_bf16 a[88:91], a[204:207], a[224:227], a[88:91]
  v_mfma_f32_16x16x32_bf16 a[56:59], a[192:195], a[228:231], a[56:59]
  v_mfma_f32_16x16x32_bf16 a[68:71], a[196:199], a[228:231], a[68:71]
  v_mfma_f32_16x16x32_bf16 a[80:83], a[200:203], a[228:231], a[80:83]
  v_mfma_f32_16x16x32_bf16 a[92:95], a[204:207], a[228:231], a[92:95]
  s_waitcnt lgkmcnt(8)
  v_mfma_f32_16x16x32_bf16 v[32:35], a[144:147], a[208:211], v[32:35]
  ds_read_b64_tr_b16 a[176:177], v5 offset:8192
  s_mov_b32 s54, 17
  v_mfma_f32_16x16x32_bf16 v[44:47], a[148:151], a[208:211], v[44:47]
  ds_read_b64_tr_b16 a[178:179], v5 offset:9216
  v_mfma_f32_16x16x32_bf16 v[56:59], a[152:155], a[208:211], v[56:59]
  ds_read_b64_tr_b16 a[180:181], v11 offset:8192
  v_mfma_f32_16x16x32_bf16 v[68:71], a[156:159], a[208:211], v[68:71]
  ds_read_b64_tr_b16 a[182:183], v11 offset:9216
  v_mfma_f32_16x16x32_bf16 v[36:39], a[144:147], a[212:215], v[36:39]
  ds_read_b64_tr_b16 a[184:185], v5 offset:8448
  v_mfma_f32_16x16x32_bf16 v[48:51], a[148:151], a[212:215], v[48:51]
  ds_read_b64_tr_b16 a[186:187], v5 offset:9472
  v_mfma_f32_16x16x32_bf16 v[60:63], a[152:155], a[212:215], v[60:63]
  ds_read_b64_tr_b16 a[188:189], v11 offset:8448
  v_mfma_f32_16x16x32_bf16 v[72:75], a[156:159], a[212:215], v[72:75]
  ds_read_b64_tr_b16 a[190:191], v11 offset:9472
  v_mfma_f32_16x16x32_bf16 v[40:43], a[144:147], a[216:219], v[40:43]
  ds_read_b128 a[220:223], v7 offset:512
  v_mfma_f32_16x16x32_bf16 v[52:55], a[148:151], a[216:219], v[52:55]
  ds_read_b128 a[224:227], v7 offset:2560
  v_mfma_f32_16x16x32_bf16 v[64:67], a[152:155], a[216:219], v[64:67]
  ds_read_b128 a[228:231], v7 offset:4608
  v_mfma_f32_16x16x32_bf16 v[76:79], a[156:159], a[216:219], v[76:79]
  ds_read_b64_tr_b16 a[192:193], v5 offset:8704
  s_waitcnt lgkmcnt(12)
  v_mfma_f32_16x16x32_bf16 v[80:83], a[160:163], a[208:211], v[80:83]
  ds_read_b64_tr_b16 a[194:195], v5 offset:9728
  v_mfma_f32_16x16x32_bf16 v[92:95], a[164:167], a[208:211], v[92:95]
  ds_read_b64_tr_b16 a[196:197], v11 offset:8704
  v_mfma_f32_16x16x32_bf16 v[104:107], a[168:171], a[208:211], v[104:107]
  ds_read_b64_tr_b16 a[198:199], v11 offset:9728
  v_mfma_f32_16x16x32_bf16 v[116:119], a[172:175], a[208:211], v[116:119]
  ds_read_b64_tr_b16 a[200:201], v5 offset:8960
  v_mfma_f32_16x16x32_bf16 v[84:87], a[160:163], a[212:215], v[84:87]
  ds_read_b64_tr_b16 a[202:203], v5 offset:9984
  v_mfma_f32_16x16x32_bf16 v[96:99], a[164:167], a[212:215], v[96:99]
  ds_read_b64_tr_b16 a[204:205], v11 offset:8960
  v_mfma_f32_16x16x32_bf16 v[108:111], a[168:171], a[212:215], v[108:111]
  ds_read_b64_tr_b16 a[206:207], v11 offset:9984
  v_mfma_f32_16x16x32_bf16 v[120:123], a[172:175], a[212:215], v[120:123]
  ds_read_b32 v248, v251 offset:20480
  v_add_u32 v5, 98304, v2
  v_mfma_f32_16x16x32_bf16 v[88:91], a[160:163], a[216:219], v[88:91]
  v_xor_b32 v11, 8, v5
  v_mfma_f32_16x16x32_bf16 v[100:103], a[164:167], a[216:219], v[100:103]
  v_mfma_f32_16x16x32_bf16 v[112:115], a[168:171], a[216:219], v[112:115]
  v_mfma_f32_16x16x32_bf16 v[124:127], a[172:175], a[216:219], v[124:127]
  s_waitcnt lgkmcnt(0)
  ds_write_b32 v249, v250 offset:0
  v_add_u32 v250, 1, v250
  v_readfirstlane_b32 s56, v248
  s_nop 1
  s_cmp_ge_u32 s56, s54
  s_cbranch_scc0 L_spin_p8
L_spun_p8:
  v_mfma_f32_16x16x32_bf16 v[32:35], a[176:179], a[220:223], v[32:35]
  ds_read_b64_tr_b16 a[144:145], v5 offset:0
  v_mfma_f32_16x16x32_bf16 v[44:47], a[180:183], a[220:223], v[44:47]
  ds_read_b64_tr_b16 a[146:147], v5 offset:1024
  v_mfma_f32_16x16x32_bf16 v[56:59], a[184:187], a[220:223], v[56:59]
  ds_read_b64_tr_b16 a[148:149], v11 offset:0
  v_mfma_f32_16x16x32_bf16 v[68:71], a[188:191], a[220:223], v[68:71]
  ds_read_b64_tr_b16 a[150:151], v11 offset:1024
  v_mfma_f32_16x16x32_bf16 v[36:39], a[176:179], a[224:227], v[36:39]
  ds_read_b64_tr_b16 a[152:153], v5 offset:256
  v_mfma_f32_16x16x32_bf16 v[48:51], a[180:183], a[224:227], v[48:51]
  ds_read_b64_tr_b16 a[154:155], v5 offset:1280
  v_mfma_f32_16x16x32_bf16 v[60:63], a[184:187], a[224:227], v[60:63]
  ds_read_b64_tr_b16 a[156:157], v11 offset:256
  v_mfma_f32_16x16x32_bf16 v[72:75], a[188:191], a[224:227], v[72:75]
  ds_read_b64_tr_b16 a[158:159], v11 offset:1280
  v_mfma_f32_16x16x32_bf16 v[40:43], a[176:179], a[228:231], v[40:43]
  ds_read_b64_tr_b16 a[160:161], v5 offset:512
  v_mfma_f32_16x16x32_bf16 v[52:55], a[180:183], a[228:231], v[52:55]
  ds_read_b64_tr_b16 a[162:163], v5 offset:1536
  v_mfma_f32_16x16x32_bf16 v[64:67], a[184:187], a[228:231], v[64:67]
  ds_read_b64_tr_b16 a[164:165], v11 offset:512
  v_mfma_f32_16x16x32_bf16 v[76:79], a[188:191], a[228:231], v[76:79]
  ds_read_b64_tr_b16 a[166:167], v11 offset:1536
  v_mfma_f32_16x16x32_bf16 v[80:83], a[192:195], a[220:223], v[80:83]
  ds_read_b64_tr_b16 a[168:169], v5 offset:768
  v_mfma_f32_16x16x32_bf16 v[92:95], a[196:199], a[220:223], v[92:95]
  ds_read_b64_tr_b16 a[170:171], v5 offset:1792
  v_mfma_f32_16x16x32_bf16 v[104:107], a[200:203], a[220:223], v[104:107]
  ds_read_b64_tr_b16 a[172:173], v11 offset:768
  v_mfma_f32_16x16x32_bf16 v[116:119], a[204:207], a[220:223], v[116:119]
  ds_read_b64_tr_b16 a[174:175], v11 offset:1792
  v_mfma_f32_16x16x32_bf16 v[84:87], a[192:195], a[224:227], v[84:87]
  v_mfma_f32_16x16x32_bf16 v[96:99], a[196:199], a[224:227], v[96:99]
  v_mfma_f32_16x16x32_bf16 v[108:111], a[200:203], a[224:227], v[108:111]
  v_mfma_f32_16x16x32_bf16 v[120:123], a[204:207], a[224:227], v[120:123]
  v_mfma_f32_16x16x32_bf16 v[88:91], a[192:195], a[228:231], v[88:91]
  v_mfma_f32_16x16x32_bf16 v[100:103], a[196:199], a[228:231], v[100:103]
  v_mfma_f32_16x16x32_bf16 v[112:115], a[200:203], a[228:231], v[112:115]
  v_mfma_f32_16x16x32_bf16 v[124:127], a[204:207], a[228:231], v[124:127]
  s_waitcnt lgkmcnt(8)
  v_mfma_f32_16x16x32_bf16 a[0:3], a[144:147], a[208:211], a[0:3]
  ds_read_b64_tr_b16 a[176:177], v5 offset:8192
  s_mov_b32 s54, 19
  v_mfma_f32_16x16x32_bf16 a[12:15], a[148:151], a[208:211], a[12:15]
  ds_read_b64_tr_b16 a[178:179], v5 offset:9216
  v_mfma_f32_16x16x32_bf16 a[24:27], a[152:155], a[208:211], a[24:27]
  ds_read_b64_tr_b16 a[180:181], v11 offset:8192
  v_mfma_f32_16x16x32_bf16 a[36:39], a[156:159], a[208:211], a[36:39]
  ds_read_b64_tr_b16 a[182:183], v11 offset:9216
  v_mfma_f32_16x16x32_bf16 a[4:7], a[144:147], a[212:215], a[4:7]
  ds_read_b64_tr_b16 a[184:185], v5 offset:8448
  v_mfma_f32_16x16x32_bf16 a[16:19], a[148:151], a[212:215], a[16:19]
  ds_read_b64_tr_b16 a[186:187], v5 offset:9472
  v_mfma_f32_16x16x32_bf16 a[28:31], a[152:155], a[212:215], a[28:31]
  ds_read_b64_tr_b16 a[188:189], v11 offset:8448
  v_mfma_f32_16x16x32_bf16 a[40:43], a[156:159], a[212:215], a[40:43]
  ds_read_b64_tr_b16 a[190:191], v11 offset:9472
  v_mfma_f32_16x16x32_bf16 a[8:11], a[144:147], a[216:219], a[8:11]
  ds_read_b64_tr_b16 a[192:193], v5 offset:8704
  v_mfma_f32_16x16x32_bf16 a[20:23], a[148:151], a[216:219], a[20:23]
  ds_read_b64_tr_b16 a[194:195], v5 offset:9728
  v_mfma_f32_16x16x32_bf16 a[32:35], a[152:155], a[216:219], a[32:35]
  ds_read_b64_tr_b16 a[196:197], v11 offset:8704
  v_mfma_f32_16x16x32_bf16 a[44:47], a[156:159], a[216:219], a[44:47]
  ds_read_b64_tr_b16 a[198:199], v11 offset:9728
  s_waitcnt lgkmcnt(12)
  v_mfma_f32_16x16x32_bf16 a[48:51], a[160:163], a[208:211], a[48:51]
  ds_read_b64_tr_b16 a[200:201], v5 offset:8960
  v_mfma_f32_16x16x32_bf16 a[60:63], a[164:167], a[208:211], a[60:63]
  ds_read_b64_tr_b16 a[202:203], v5 offset:9984
  v_mfma_f32_16x16x32_bf16 a[72:75], a[168:171], a[208:211], a[72:75]
  ds_read_b64_tr_b16 a[204:205], v11 offset:8960
  v_mfma_f32_16x16x32_bf16 a[84:87], a[172:175], a[208:211], a[84:87]
  ds_read_b64_tr_b16 a[206:207], v11 offset:9984
  v_mfma_f32_16x16x32_bf16 a[52:55], a[160:163], a[212:215], a[52:55]
  ds_read_b32 v248, v251 offset:20480
  v_add_u32 v5, 49152, v2
  v_mfma_f32_16x16x32_bf16 a[64:67], a[164:167], a[212:215], a[64:67]
  v_xor_b32 v11, 8, v5
  v_add_u32 v7, 133120, v129
  v_mfma_f32_16x16x32_bf16 a[76:79], a[168:171], a[212:215], a[76:79]
  v_mfma_f32_16x16x32_bf16 a[88:91], a[172:175], a[212:215], a[88:91]
  v_mfma_f32_16x16x32_bf16 a[56:59], a[160:163], a[216:219], a[56:59]
  v_mfma_f32_16x16x32_bf16 a[68:71], a[164:167], a[216:219], a[68:71]
  v_mfma_f32_16x16x32_bf16 a[80:83], a[168:171], a[216:219], a[80:83]
  v_mfma_f32_16x16x32_bf16 a[92:95], a[172:175], a[216:219], a[92:95]
  s_waitcnt lgkmcnt(0)
  ds_write_b32 v249, v250 offset:0
  v_add_u32 v250, 1, v250
  v_readfirstlane_b32 s56, v248
  s_nop 1
  s_cmp_ge_u32 s56, s54
  s_cbranch_scc0 L_spin_p9
L_spun_p9:
  v_mfma_f32_16x16x32_bf16 a[0:3], a[176:179], a[220:223], a[0:3]
  ds_read_b64_tr_b16 a[144:145], v5 offset:0
  v_mfma_f32_16x16x32_bf16 a[12:15], a[180:183], a[220:223], a[12:15]
  ds_read_b64_tr_b16 a[146:147], v5 offset:1024
  v_mfma_f32_16x16x32_bf16 a[24:27], a[184:187], a[220:223], a[24:27]
  ds_read_b64_tr_b16 a[148:149], v11 offset:0
  v_mfma_f32_16x16x32_bf16 a[36:39], a[188:191], a[220:223], a[36:39]
  ds_read_b64_tr_b16 a[150:151], v11 offset:1024
  v_mfma_f32_16x16x32_bf16 a[4:7], a[176:179], a[224:227], a[4:7]
  ds_read_b64_tr_b16 a[152:153], v5 offset:256
  v_mfma_f32_16x16x32_bf16 a[16:19], a[180:183], a[224:227], a[16:19]
  ds_read_b64_tr_b16 a[154:155], v5 offset:1280
  v_mfma_f32_16x16x32_bf16 a[28:31], a[184:187], a[224:227], a[28:31]
  ds_read_b64_tr_b16 a[156:157], v11 offset:256
  v_mfma_f32_16x16x32_bf16 a[40:43], a[188:191], a[224:227], a[40:43]
  ds_read_b64_tr_b16 a[158:159], v11 offset:1280
  v_mfma_f32_16x16x32_bf16 a[8:11], a[176:179], a[228:231], a[8:11]
  ds_read_b128 a[208:211], v7 offset:0
  v_mfma_f32_16x16x32_bf16 a[20:23], a[180:183], a[228:231], a[20:23]
  ds_read_b128 a[212:215], v7 offset:2048
  v_mfma_f32_16x16x32_bf16 a[32:35], a[184:187], a[228:231], a[32:35]
  ds_read_b128 a[216:219], v7 offset:4096
  v_mfma_f32_16x16x32_bf16 a[44:47], a[188:191], a[228:231], a[44:47]
  ds_read_b64_tr_b16 a[160:161], v5 offset:512
  v_mfma_f32_16x16x32_bf16 a[48:51], a[192:195], a[220:223], a[48:51]
  ds_read_b64_tr_b16 a[162:163], v5 offset:1536
  v_mfma_f32_16x16x32_bf16 a[60:63], a[196:199], a[220:223], a[60:63]
  ds_read_b64_tr_b16 a[164:165], v11 offset:512
  v_mfma_f32_16x16x32_bf16 a[72:75], a[200:203], a[220:223], a[72:75]
  ds_read_b64_tr_b16 a[166:167], v11 offset:1536
  v_mfma_f32_16x16x32_bf16 a[84:87], a[204:207], a[220:223], a[84:87]
  ds_read_b64_tr_b16 a[168:169], v5 offset:768
  v_mfma_f32_16x16x32_bf16 a[52:55], a[192:195], a[224:227], a[52:55]
  ds_read_b64_tr_b16 a[170:171], v5 offset:1792
  v_mfma_f32_16x16x32_bf16 a[64:67], a[196:199], a[224:227], a[64:67]
  ds_read_b64_tr_b16 a[172:173], v11 offset:768
  v_mfma_f32_16x16x32_bf16 a[76:79], a[200:203], a[224:227], a[76:79]
  ds_read_b64_tr_b16 a[174:175], v11 offset:1792
  v_mfma_f32_16x16x32_bf16 a[88:91], a[204:207], a[224:227], a[88:91]
  v_mfma_f32_16x16x32_bf16 a[56:59], a[192:195], a[228:231], a[56:59]
  v_mfma_f32_16x16x32_bf16 a[68:71], a[196:199], a[228:231], a[68:71]
  v_mfma_f32_16x16x32_bf16 a[80:83], a[200:203], a[228:231], a[80:83]
  v_mfma_f32_16x16x32_bf16 a[92:95], a[204:207], a[228:231], a[92:95]
  s_waitcnt lgkmcnt(8)
  v_mfma_f32_16x16x32_bf16 v[32:35], a[144:147], a[208:211], v[32:35]
  ds_read_b64_tr_b16 a[176:177], v5 offset:8192
  s_mov_b32 s54, 20
  v_mfma_f32_16x16x32_bf16 v[44:47], a[148:151], a[208:211], v[44:47]
  ds_read_b64_tr_b16 a[178:179], v5 offset:9216
  v_mfma_f32_16x16x32_bf16 v[56:59], a[152:155], a[208:211], v[56:59]
  ds_read_b64_tr_b16 a[180:181], v11 offset:8192
  v_mfma_f32_16x16x32_bf16 v[68:71], a[156:159], a[208:211], v[68:71]
  ds_read_b64_tr_b16 a[182:183], v11 offset:9216
  v_mfma_f32_16x16x32_bf16 v[36:39], a[144:147], a[212:215], v[36:39]
  ds_read_b64_tr_b16 a[184:185], v5 offset:8448
  v_mfma_f32_16x16x32_bf16 v[48:51], a[148:151], a[212:215], v[48:51]
  ds_read_b64_tr_b16 a[186:187], v5 offset:9472
  v_mfma_f32_16x16x32_bf16 v[60:63], a[152:155], a[212:215], v[60:63]
  ds_read_b64_tr_b16 a[188:189], v11 offset:8448
  v_mfma_f32_16x16x32_bf16 v[72:75], a[156:159], a[212:215], v[72:75]
  ds_read_b64_tr_b16 a[190:191], v11 offset:9472
  v_mfma_f32_16x16x32_bf16 v[40:43], a[144:147], a[216:219], v[40:43]
  ds_read_b128 a[220:223], v7 offset:512
  v_mfma_f32_16x16x32_bf16 v[52:55], a[148:151], a[216:219], v[52:55]
  ds_read_b128 a[224:227], v7 offset:2560
  v_mfma_f32_16x16x32_bf16 v[64:67], a[152:155], a[216:219], v[64:67]
  ds_read_b128 a[228:231], v7 offset:4608
  v_mfma_f32_16x16x32_bf16 v[76:79], a[156:159], a[216:219], v[76:79]
  ds_read_b64_tr_b16 a[192:193], v5 offset:8704
  s_waitcnt lgkmcnt(12)
  v_mfma_f32_16x16x32_bf16 v[80:83], a[160:163], a[208:211], v[80:83]
  ds_read_b64_tr_b16 a[194:195], v5 offset:9728
  v_mfma_f32_16x16x32_bf16 v[92:95], a[164:167], a[208:211], v[92:95]
  ds_read_b64_tr_b16 a[196:197], v11 offset:8704
  v_mfma_f32_16x16x32_bf16 v[104:107], a[168:171], a[208:211], v[104:107]
  ds_read_b64_tr_b16 a[198:199], v11 offset:9728
  v_mfma_f32_16x16x32_bf16 v[116:119], a[172:175], a[208:211], v[116:119]
  ds_read_b64_tr_b16 a[200:201], v5 offset:8960
  v_mfma_f32_16x16x32_bf16 v[84:87], a[160:163], a[212:215], v[84:87]
  ds_read_b64_tr_b16 a[202:203], v5 offset:9984
  v_mfma_f32_16x16x32_bf16 v[96:99], a[164:167], a[212:215], v[96:99]
  ds_read_b64_tr_b16 a[204:205], v11 offset:8960
  v_mfma_f32_16x16x32_bf16 v[108:111], a[168:171], a[212:215], v[108:111]
  ds_read_b64_tr_b16 a[206:207], v11 offset:9984
  v_mfma_f32_16x16x32_bf16 v[120:123], a[172:175], a[212:215], v[120:123]
  ds_read_b32 v248, v251 offset:20480
  v_add_u32 v5, 65536, v2
  v_mfma_f32_16x16x32_bf16 v[88:91], a[160:163], a[216:219], v[88:91]
  v_xor_b32 v11, 8, v5
  v_mfma_f32_16x16x32_bf16 v[100:103], a[164:167], a[216:219], v[100:103]
  v_mfma_f32_16x16x32_bf16 v[112:115], a[168:171], a[216:219], v[112:115]
  v_mfma_f32_16x16x32_bf16 v[124:127], a[172:175], a[216:219], v[124:127]
  s_waitcnt lgkmcnt(0)
  ds_write_b32 v249, v250 offset:0
  v_add_u32 v250, 1, v250
  v_readfirstlane_b32 s56, v248
  s_nop 1
  s_cmp_ge_u32 s56, s54
  s_cbranch_scc0 L_spin_p10
L_spun_p10:
  v_mfma_f32_16x16x32_bf16 v[32:35], a[176:179], a[220:223], v[32:35]
  ds_read_b64_tr_b16 a[144:145], v5 offset:0
  v_mfma_f32_16x16x32_bf16 v[44:47], a[180:183], a[220:223], v[44:47]
  ds_read_b64_tr_b16 a[146:147], v5 offset:1024
  v_mfma_f32_16x16x32_bf16 v[56:59], a[184:187], a[220:223], v[56:59]
  ds_read_b64_tr_b16 a[148:149], v11 offset:0
  v_mfma_f32_16x16x32_bf16 v[68:71], a[188:191], a[220:223], v[68:71]
  ds_read_b64_tr_b16 a[150:151], v11 offset:1024
  v_mfma_f32_16x16x32_bf16 v[36:39], a[176:179], a[224:227], v[36:39]
  ds_read_b64_tr_b16 a[152:153], v5 offset:256
  v_mfma_f32_16x16x32_bf16 v[48:51], a[180:183], a[224:227], v[48:51]
  ds_read_b64_tr_b16 a[154:155], v5 offset:1280
  v_mfma_f32_16x16x32_bf16 v[60:63], a[184:187], a[224:227], v[60:63]
  ds_read_b64_tr_b16 a[156:157], v11 offset:256
  v_mfma_f32_16x16x32_bf16 v[72:75], a[188:191], a[224:227], v[72:75]
  ds_read_b64_tr_b16 a[158:159], v11 offset:1280
  v_mfma_f32_16x16x32_bf16 v[40:43], a[176:179], a[228:231], v[40:43]
  ds_read_b64_tr_b16 a[160:161], v5 offset:512
  v_mfma_f32_16x16x32_bf16 v[52:55], a[180:183], a[228:231], v[52:55]
  ds_read_b64_tr_b16 a[162:163], v5 offset:1536
  v_mfma_f32_16x16x32_bf16 v[64:67], a[184:187], a[228:231], v[64:67]
  ds_read_b64_tr_b16 a[164:165], v11 offset:512
  v_mfma_f32_16x16x32_bf16 v[76:79], a[188:191], a[228:231], v[76:79]
  ds_read_b64_tr_b16 a[166:167], v11 offset:1536
  v_mfma_f32_16x16x32_bf16 v[80:83], a[192:195], a[220:223], v[80:83]
  ds_read_b64_tr_b16 a[168:169], v5 offset:768
  v_mfma_f32_16x16x32_bf16 v[92:95], a[196:199], a[220:223], v[92:95]
  ds_read_b64_tr_b16 a[170:171], v5 offset:1792
  v_mfma_f32_16x16x32_bf16 v[104:107], a[200:203], a[220:223], v[104:107]
  ds_read_b64_tr_b16 a[172:173], v11 offset:768
  v_mfma_f32_16x16x32_bf16 v[116:119], a[204:207], a[220:223], v[116:119]
  ds_read_b64_tr_b16 a[174:175], v11 offset:1792
  v_mfma_f32_16x16x32_bf16 v[84:87], a[192:195], a[224:227], v[84:87]
  v_mfma_f32_16x16x32_bf16 v[96:99], a[196:199], a[224:227], v[96:99]
  v_mfma_f32_16x16x32_bf16 v[108:111], a[200:203], a[224:227], v[108:111]
  v_mfma_f32_16x16x32_bf16 v[120:123], a[204:207], a[224:227], v[120:123]
  v_mfma_f32_16x16x32_bf16 v[88:91], a[192:195], a[228:231], v[88:91]
  v_mfma_f32_16x16x32_bf16 v[100:103], a[196:199], a[228:231], v[100:103]
  v_mfma_f32_16x16x32_bf16 v[112:115], a[200:203], a[228:231], v[112:115]
  v_mfma_f32_16x16x32_bf16 v[124:127], a[204:207], a[228:231], v[124:127]
  s_waitcnt lgkmcnt(8)
  v_mfma_f32_16x16x32_bf16 a[0:3], a[144:147], a[208:211], a[0:3]
  ds_read_b64_tr_b16 a[176:177], v5 offset:8192
  s_mov_b32 s54, 23
  v_mfma_f32_16x16x32_bf16 a[12:15], a[148:151], a[208:211], a[12:15]
  ds_read_b64_tr_b16 a[178:179], v5 offset:9216
  v_mfma_f32_16x16x32_bf16 a[24:27], a[152:155], a[208:211], a[24:27]
  ds_read_b64_tr_b16 a[180:181], v11 offset:8192
  v_mfma_f32_16x16x32_bf16 a[36:39], a[156:159], a[208:211], a[36:39]
  ds_read_b64_tr_b16 a[182:183], v11 offset:9216
  v_mfma_f32_16x16x32_bf16 a[4:7], a[144:147], a[212:215], a[4:7]
  ds_read_b64_tr_b16 a[184:185], v5 offset:8448
  v_mfma_f32_16x16x32_bf16 a[16:19], a[148:151], a[212:215], a[16:19]
  ds_read_b64_tr_b16 a[186:187], v5 offset:9472
  v_mfma_f32_16x16x32_bf16 a[28:31], a[152:155], a[212:215], a[28:31]
  ds_read_b64_tr_b16 a[188:189], v11 offset:8448
  v_mfma_f32_16x16x32_bf16 a[40:43], a[156:159], a[212:215], a[40:43]
  ds_read_b64_tr_b16 a[190:191], v11 offset:9472
  v_mfma_f32_16x16x32_bf16 a[8:11], a[144:147], a[216:219], a[8:11]
  ds_read_b64_tr_b16 a[192:193], v5 offset:8704
  v_mfma_f32_16x16x32_bf16 a[20:23], a[148:151], a[216:219], a[20:23]
  ds_read_b64_tr_b16 a[194:195], v5 offset:9728
  v_mfma_f32_16x16x32_bf16 a[32:35], a[152:155], a[216:219], a[32:35]
  ds_read_b64_tr_b16 a[196:197], v11 offset:8704
  v_mfma_f32_16x16x32_bf16 a[44:47], a[156:159], a[216:219], a[44:47]
  ds_read_b64_tr_b16 a[198:199], v11 offset:9728
  s_waitcnt lgkmcnt(12)
  v_mfma_f32_16x16x32_bf16 a[48:51], a[160:163], a[208:211], a[48:51]
  ds_read_b64_tr_b16 a[200:201], v5 offset:8960
  v_mfma_f32_16x16x32_bf16 a[60:63], a[164:167], a[208:211], a[60:63]
  ds_read_b64_tr_b16 a[202:203], v5 offset:9984
  v_mfma_f32_16x16x32_bf16 a[72:75], a[168:171], a[208:211], a[72:75]
  ds_read_b64_tr_b16 a[204:205], v11 offset:8960
  v_mfma_f32_16x16x32_bf16 a[84:87], a[172:175], a[208:211], a[84:87]
  ds_read_b64_tr_b16 a[206:207], v11 offset:9984
  v_mfma_f32_16x16x32_bf16 a[52:55], a[160:163], a[212:215], a[52:55]
  ds_read_b32 v248, v251 offset:20480
  v_add_u32 v5, 32768, v2
  v_mfma_f32_16x16x32_bf16 a[64:67], a[164:167], a[212:215], a[64:67]
  v_xor_b32 v11, 8, v5
  v_add_u32 v7, 114688, v129
  v_mfma_f32_16x16x32_bf16 a[76:79], a[168:171], a[212:215], a[76:79]
  v_mfma_f32_16x16x32_bf16 a[88:91], a[172:175], a[212:215], a[88:91]
  v_mfma_f32_16x16x32_bf16 a[56:59], a[160:163], a[216:219], a[56:59]
  v_mfma_f32_16x16x32_bf16 a[68:71], a[164:167], a[216:219], a[68:71]
  v_mfma_f32_16x16x32_bf16 a[80:83], a[168:171], a[216:219], a[80:83]
  v_mfma_f32_16x16x32_bf16 a[92:95], a[172:175], a[216:219], a[92:95]
  s_waitcnt lgkmcnt(0)
  ds_write_b32 v249, v250 offset:0
  v_add_u32 v250, 1, v250
  v_readfirstlane_b32 s56, v248
  s_nop 1
  s_cmp_ge_u32 s56, s54
  s_cbranch_scc0 L_spin_p11
L_spun_p11:
  v_mfma_f32_16x16x32_bf16 a[0:3], a[176:179], a[220:223], a[0:3]
  ds_read_b64_tr_b16 a[144:145], v5 offset:0
  v_mfma_f32_16x16x32_bf16 a[12:15], a[180:183], a[220:223], a[12:15]
  ds_read_b64_tr_b16 a[146:147], v5 offset:1024
  v_mfma_f32_16x16x32_bf16 a[24:27], a[184:187], a[220:223], a[24:27]
  ds_read_b64_tr_b16 a[148:149], v11 offset:0
  v_mfma_f32_16x16x32_bf16 a[36:39], a[188:191], a[220:223], a[36:39]
  ds_read_b64_tr_b16 a[150:151], v11 offset:1024
  v_mfma_f32_16x16x32_bf16 a[4:7], a[176:179], a[224:227], a[4:7]
  ds_read_b64_tr_b16 a[152:153], v5 offset:256
  v_mfma_f32_16x16x32_bf16 a[16:19], a[180:183], a[224:227], a[16:19]
  ds_read_b64_tr_b16 a[154:155], v5 offset:1280
  v_mfma_f32_16x16x32_bf16 a[28:31], a[184:187], a[224:227], a[28:31]
  ds_read_b64_tr_b16 a[156:157], v11 offset:256
  v_mfma_f32_16x16x32_bf16 a[40:43], a[188:191], a[224:227], a[40:43]
  ds_read_b64_tr_b16 a[158:159], v11 offset:1280
  v_mfma_f32_16x16x32_bf16 a[8:11], a[176:179], a[228:231], a[8:11]
  ds_read_b128 a[208:211], v7 offset:0
  v_mfma_f32_16x16x32_bf16 a[20:23], a[180:183], a[228:231], a[20:23]
  ds_read_b128 a[212:215], v7 offset:2048
  v_mfma_f32_16x16x32_bf16 a[32:35], a[184:187], a[228:231], a[32:35]
  ds_read_b128 a[216:219], v7 offset:4096
  v_mfma_f32_16x16x32_bf16 a[44:47], a[188:191], a[228:231], a[44:47]
  ds_read_b64_tr_b16 a[160:161], v5 offset:512
  v_mfma_f32_16x16x32_bf16 a[48:51], a[192:195], a[220:223], a[48:51]
  ds_read_b64_tr_b16 a[162:163], v5 offset:1536
  v_mfma_f32_16x16x32_bf16 a[60:63], a[196:199], a[220:223], a[60:63]
  ds_read_b64_tr_b16 a[164:165], v11 offset:512
  v_mfma_f32_16x16x32_bf16 a[72:75], a[200:203], a[220:223], a[72:75]
  ds_read_b64_tr_b16 a[166:167], v11 offset:1536
  v_mfma_f32_16x16x32_bf16 a[84:87], a[204:207], a[220:223], a[84:87]
  ds_read_b64_tr_b16 a[168:169], v5 offset:768
  v_mfma_f32_16x16x32_bf16 a[52:55], a[192:195], a[224:227], a[52:55]
  ds_read_b64_tr_b16 a[170:171], v5 offset:1792
  v_mfma_f32_16x16x32_bf16 a[64:67], a[196:199], a[224:227], a[64:67]
  ds_read_b64_tr_b16 a[172:173], v11 offset:768
  v_mfma_f32_16x16x32_bf16 a[76:79], a[200:203], a[224:227], a[76:79]
  ds_read_b64_tr_b16 a[174:175], v11 offset:1792
  v_mfma_f32_16x16x32_bf16 a[88:91], a[204:207], a[224:227], a[88:91]
  v_mfma_f32_16x16x32_bf16 a[56:59], a[192:195], a[228:231], a[56:59]
  v_mfma_f32_16x16x32_bf16 a[68:71], a[196:199], a[228:231], a[68:71]
  v_mfma_f32_16x16x32_bf16 a[80:83], a[200:203], a[228:231], a[80:83]
  v_mfma_f32_16x16x32_bf16 a[92:95], a[204:207], a[228:231], a[92:95]
  s_waitcnt lgkmcnt(8)
  v_mfma_f32_16x16x32_bf16 v[32:35], a[144:147], a[208:211], v[32:35]
  ds_read_b64_tr_b16 a[176:177], v5 offset:8192
  s_mov_b32 s54, 24
  v_mfma_f32_16x16x32_bf16 v[44:47], a[148:151], a[208:211], v[44:47]
  ds_read_b64_tr_b16 a[178:179], v5 offset:9216
  v_mfma_f32_16x16x32_bf16 v[56:59], a[152:155], a[208:211], v[56:59]
  ds_read_b64_tr_b16 a[180:181], v11 offset:8192
  v_mfma_f32_16x16x32_bf16 v[68:71], a[156:159], a[208:211], v[68:71]
  ds_read_b64_tr_b16 a[182:183], v11 offset:9216
  v_mfma_f32_16x16x32_bf16 v[36:39], a[144:147], a[212:215], v[36:39]
  ds_read_b64_tr_b16 a[184:185], v5 offset:8448
  v_mfma_f32_16x16x32_bf16 v[48:51], a[148:151], a[212:215], v[48:51]
  ds_read_b64_tr_b16 a[186:187], v5 offset:9472
  v_mfma_f32_16x16x32_bf16 v[60:63], a[152:155], a[212:215], v[60:63]
  ds_read_b64_tr_b16 a[188:189], v11 offset:8448
  v_mfma_f32_16x16x32_bf16 v[72:75], a[156:159], a[212:215], v[72:75]
  ds_read_b64_tr_b16 a[190:191], v11 offset:9472
  v_mfma_f32_16x16x32_bf16 v[40:43], a[144:147], a[216:219], v[40:43]
  ds_read_b128 a[220:223], v7 offset:512
  v_mfma_f32_16x16x32_bf16 v[52:55], a[148:151], a[216:219], v[52:55]
  ds_read_b128 a[224:227], v7 offset:2560
  v_mfma_f32_16x16x32_bf16 v[64:67], a[152:155], a[216:219], v[64:67]
  ds_read_b128 a[228:231], v7 offset:4608
  v_mfma_f32_16x16x32_bf16 v[76:79], a[156:159], a[216:219], v[76:79]
  ds_read_b64_tr_b16 a[192:193], v5 offset:8704
  s_waitcnt lgkmcnt(12)
  v_mfma_f32_16x16x32_bf16 v[80:83], a[160:163], a[208:211], v[80:83]
  ds_read_b64_tr_b16 a[194:195], v5 offset:9728
  v_mfma_f32_16x16x32_bf16 v[92:95], a[164:167], a[208:211], v[92:95]
  ds_read_b64_tr_b16 a[196:197], v11 offset:8704
  v_mfma_f32_16x16x32_bf16 v[104:107], a[168:171], a[208:211], v[104:107]
  ds_read_b64_tr_b16 a[198:199], v11 offset:9728
  v_mfma_f32_16x16x32_bf16 v[116:119], a[172:175], a[208:211], v[116:119]
  ds_read_b64_tr_b16 a[200:201], v5 offset:8960
  v_mfma_f32_16x16x32_bf16 v[84:87], a[160:163], a[212:215], v[84:87]
  ds_read_b64_tr_b16 a[202:203], v5 offset:9984
  v_mfma_f32_16x16x32_bf16 v[96:99], a[164:167], a[212:215], v[96:99]
  ds_read_b64_tr_b16 a[204:205], v11 offset:8960
  v_mfma_f32_16x16x32_bf16 v[108:111], a[168:171], a[212:215], v[108:111]
  ds_read_b64_tr_b16 a[206:207], v11 offset:9984
  v_mfma_f32_16x16x32_bf16 v[120:123], a[172:175], a[212:215], v[120:123]
  ds_read_b32 v248, v251 offset:20480
  v_add_u32 v5, 98304, v2
  v_mfma_f32_16x16x32_bf16 v[88:91], a[160:163], a[216:219], v[88:91]
  v_xor_b32 v11, 8, v5
  v_mfma_f32_16x16x32_bf16 v[100:103], a[164:167], a[216:219], v[100:103]
  v_mfma_f32_16x16x32_bf16 v[112:115], a[168:171], a[216:219], v[112:115]
  v_mfma_f32_16x16x32_bf16 v[124:127], a[172:175], a[216:219], v[124:127]
  s_waitcnt lgkmcnt(0)
  ds_write_b32 v249, v250 offset:0
  v_add_u32 v250, 1, v250
  v_readfirstlane_b32 s56, v248
  s_nop 1
  s_cmp_ge_u32 s56, s54
  s_cbranch_scc0 L_spin_p12
L_spun_p12:
  v_mfma_f32_16x16x32_bf16 v[32:35], a[176:179], a[220:223], v[32:35]
  ds_read_b64_tr_b16 a[144:145], v5 offset:0
  v_mfma_f32_16x16x32_bf16 v[44:47], a[180:183], a[220:223], v[44:47]
  ds_read_b64_tr_b16 a[146:147], v5 offset:1024
  v_mfma_f32_16x16x32_bf16 v[56:59], a[184:187], a[220:223], v[56:59]
  ds_read_b64_tr_b16 a[148:149], v11 offset:0
  v_mfma_f32_16x16x32_bf16 v[68:71], a[188:191], a[220:223], v[68:71]
  ds_read_b64_tr_b16 a[150:151], v11 offset:1024
  v_mfma_f32_16x16x32_bf16 v[36:39], a[176:179], a[224:227], v[36:39]
  ds_read_b64_tr_b16 a[152:153], v5 offset:256
  v_mfma_f32_16x16x32_bf16 v[48:51], a[180:183], a[224:227], v[48:51]
  ds_read_b64_tr_b16 a[154:155], v5 offset:1280
  v_mfma_f32_16x16x32_bf16 v[60:63], a[184:187], a[224:227], v[60:63]
  ds_read_b64_tr_b16 a[156:157], v11 offset:256
  v_mfma_f32_16x16x32_bf16 v[72:75], a[188:191], a[224:227], v[72:75]
  ds_read_b64_tr_b16 a[158:159], v11 offset:1280
  v_mfma_f32_16x16x32_bf16 v[40:43], a[176:179], a[228:231], v[40:43]
  ds_read_b64_tr_b16 a[160:161], v5 offset:512
  v_mfma_f32_16x16x32_bf16 v[52:55], a[180:183], a[228:231], v[52:55]
  ds_read_b64_tr_b16 a[162:163], v5 offset:1536
  v_mfma_f32_16x16x32_bf16 v[64:67], a[184:187], a[228:231], v[64:67]
  ds_read_b64_tr_b16 a[164:165], v11 offset:512
  v_mfma_f32_16x16x32_bf16 v[76:79], a[188:191], a[228:231], v[76:79]
  ds_read_b64_tr_b16 a[166:167], v11 offset:1536
  v_mfma_f32_16x16x32_bf16 v[80:83], a[192:195], a[220:223], v[80:83]
  ds_read_b64_tr_b16 a[168:169], v5 offset:768
  v_mfma_f32_16x16x32_bf16 v[92:95], a[196:199], a[220:223], v[92:95]
  ds_read_b64_tr_b16 a[170:171], v5 offset:1792
  v_mfma_f32_16x16x32_bf16 v[104:107], a[200:203], a[220:223], v[104:107]
  ds_read_b64_tr_b16 a[172:173], v11 offset:768
  v_mfma_f32_16x16x32_bf16 v[116:119], a[204:207], a[220:223], v[116:119]
  ds_read_b64_tr_b16 a[174:175], v11 offset:1792
  v_mfma_f32_16x16x32_bf16 v[84:87], a[192:195], a[224:227], v[84:87]
  v_mfma_f32_16x16x32_bf16 v[96:99], a[196:199], a[224:227], v[96:99]
  v_mfma_f32_16x16x32_bf16 v[108:111], a[200:203], a[224:227], v[108:111]
  v_mfma_f32_16x16x32_bf16 v[120:123], a[204:207], a[224:227], v[120:123]
  v_mfma_f32_16x16x32_bf16 v[88:91], a[192:195], a[228:231], v[88:91]
  v_mfma_f32_16x16x32_bf16 v[100:103], a[196:199], a[228:231], v[100:103]
  v_mfma_f32_16x16x32_bf16 v[112:115], a[200:203], a[228:231], v[112:115]
  v_mfma_f32_16x16x32_bf16 v[124:127], a[204:207], a[228:231], v[124:127]
  s_waitcnt lgkmcnt(8)
  v_mfma_f32_16x16x32_bf16 a[0:3], a[144:147], a[208:211], a[0:3]
  ds_read_b64_tr_b16 a[176:177], v5 offset:8192
  s_mov_b32 s54, 26
  v_mfma_f32_16x16x32_bf16 a[12:15], a[148:151], a[208:211], a[12:15]
  ds_read_b64_tr_b16 a[178:179], v5 offset:9216
  v_mfma_f32_16x16x32_bf16 a[24:27], a[152:155], a[208:211], a[24:27]
  ds_read_b64_tr_b16 a[180:181], v11 offset:8192
  v_mfma_f32_16x16x32_bf16 a[36:39], a[156:159], a[208:211], a[36:39]
  ds_read_b64_tr_b16 a[182:183], v11 offset:9216
  v_mfma_f32_16x16x32_bf16 a[4:7], a[144:147], a[212:215], a[4:7]
  ds_read_b64_tr_b16 a[184:185], v5 offset:8448
  v_mfma_f32_16x16x32_bf16 a[16:19], a[148:151], a[212:215], a[16:19]
  ds_read_b64_tr_b16 a[186:187], v5 offset:9472
  v_mfma_f32_16x16x32_bf16 a[28:31], a[152:155], a[212:215], a[28:31]
  ds_read_b64_tr_b16 a[188:189], v11 offset:8448
  v_mfma_f32_16x16x32_bf16 a[40:43], a[156:159], a[212:215], a[40:43]
  ds_read_b64_tr_b16 a[190:191], v11 offset:9472
  v_mfma_f32_16x16x32_bf16 a[8:11], a[144:147], a[216:219], a[8:11]
  ds_read_b64_tr_b16 a[192:193], v5 offset:8704
  v_mfma_f32_16x16x32_bf16 a[20:23], a[148:151], a[216:219], a[20:23]
  ds_read_b64_tr_b16 a[194:195], v5 offset:9728
  v_mfma_f32_16x16x32_bf16 a[32:35], a[152:155], a[216:219], a[32:35]
  ds_read_b64_tr_b16 a[196:197], v11 offset:8704
  v_mfma_f32_16x16x32_bf16 a[44:47], a[156:159], a[216:219], a[44:47]
  ds_read_b64_tr_b16 a[198:199], v11 offset:9728
  s_waitcnt lgkmcnt(12)
  v_mfma_f32_16x16x32_bf16 a[48:51], a[160:163], a[208:211], a[48:51]
  ds_read_b64_tr_b16 a[200:201], v5 offset:8960
  v_mfma_f32_16x16x32_bf16 a[60:63], a[164:167], a[208:211], a[60:63]
  ds_read_b64_tr_b16 a[202:203], v5 offset:9984
  v_mfma_f32_16x16x32_bf16 a[72:75], a[168:171], a[208:211], a[72:75]
  ds_read_b64_tr_b16 a[204:205], v11 offset:8960
  v_mfma_f32_16x16x32_bf16 a[84:87], a[172:175], a[208:211], a[84:87]
  ds_read_b64_tr_b16 a[206:207], v11 offset:9984
  v_mfma_f32_16x16x32_bf16 a[52:55], a[160:163], a[212:215], a[52:55]
  ds_read_b32 v248, v251 offset:20480
  v_add_u32 v5, 49152, v2
  v_mfma_f32_16x16x32_bf16 a[64:67], a[164:167], a[212:215], a[64:67]
  v_xor_b32 v11, 8, v5
  v_add_u32 v7, 133120, v129
  v_mfma_f32_16x16x32_bf16 a[76:79], a[168:171], a[212:215], a[76:79]
  v_mfma_f32_16x16x32_bf16 a[88:91], a[172:175], a[212:215], a[88:91]
  v_mfma_f32_16x16x32_bf16 a[56:59], a[160:163], a[216:219], a[56:59]
  v_mfma_f32_16x16x32_bf16 a[68:71], a[164:167], a[216:219], a[68:71]
  v_mfma_f32_16x16x32_bf16 a[80:83], a[168:171], a[216:219], a[80:83]
  v_mfma_f32_16x16x32_bf16 a[92:95], a[172:175], a[216:219], a[92:95]
  s_waitcnt lgkmcnt(0)
  ds_write_b32 v249, v250 offset:0
  v_add_u32 v250, 1, v250
  v_readfirstlane_b32 s56, v248
  s_nop 1
  s_cmp_ge_u32 s56, s54
  s_cbranch_scc0 L_spin_p13
L_spun_p13:
  v_mfma_f32_16x16x32_bf16 a[0:3], a[176:179], a[220:223], a[0:3]
  ds_read_b64_tr_b16 a[144:145], v5 offset:0
  v_mfma_f32_16x16x32_bf16 a[12:15], a[180:183], a[220:223], a[12:15]
  ds_read_b64_tr_b16 a[146:147], v5 offset:1024
  v_mfma_f32_16x16x32_bf16 a[24:27], a[184:187], a[220:223], a[24:27]
  ds_read_b64_tr_b16 a[148:149], v11 offset:0
  v_mfma_f32_16x16x32_bf16 a[36:39], a[188:191], a[220:223], a[36:39]
  ds_read_b64_tr_b16 a[150:151], v11 offset:1024
  v_mfma_f32_16x16x32_bf16 a[4:7], a[176:179], a[224:227], a[4:7]
  ds_read_b64_tr_b16 a[152:153], v5 offset:256
  v_mfma_f32_16x16x32_bf16 a[16:19], a[180:183], a[224:227], a[16:19]
  ds_read_b64_tr_b16 a[154:155], v5 offset:1280
  v_mfma_f32_16x16x32_bf16 a[28:31], a[184:187], a[224:227], a[28:31]
  ds_read_b64_tr_b16 a[156:157], v11 offset:256
  v_mfma_f32_16x16x32_bf16 a[40:43], a[188:191], a[224:227], a[40:43]
  ds_read_b64_tr_b16 a[158:159], v11 offset:1280
  v_mfma_f32_16x16x32_bf16 a[8:11], a[176:179], a[228:231], a[8:11]
  ds_read_b128 a[208:211], v7 offset:0
  v_mfma_f32_16x16x32_bf16 a[20:23], a[180:183], a[228:231], a[20:23]
  ds_read_b128 a[212:215], v7 offset:2048
  v_mfma_f32_16x16x32_bf16 a[32:35], a[184:187], a[228:231], a[32:35]
  ds_read_b128 a[216:219], v7 offset:4096
  v_mfma_f32_16x16x32_bf16 a[44:47], a[188:191], a[228:231], a[44:47]
  ds_read_b64_tr_b16 a[160:161], v5 offset:512
  v_mfma_f32_16x16x32_bf16 a[48:51], a[192:195], a[220:223], a[48:51]
  ds_read_b64_tr_b16 a[162:163], v5 offset:1536
  v_mfma_f32_16x16x32_bf16 a[60:63], a[196:199], a[220:223], a[60:63]
  ds_read_b64_tr_b16 a[164:165], v11 offset:512
  v_mfma_f32_16x16x32_bf16 a[72:75], a[200:203], a[220:223], a[72:75]
  ds_read_b64_tr_b16 a[166:167], v11 offset:1536
  v_mfma_f32_16x16x32_bf16 a[84:87], a[204:207], a[220:223], a[84:87]
  ds_read_b64_tr_b16 a[168:169], v5 offset:768
  v_mfma_f32_16x16x32_bf16 a[52:55], a[192:195], a[224:227], a[52:55]
  ds_read_b64_tr_b16 a[170:171], v5 offset:1792
  v_mfma_f32_16x16x32_bf16 a[64:67], a[196:199], a[224:227], a[64:67]
  ds_read_b64_tr_b16 a[172:173], v11 offset:768
  v_mfma_f32_16x16x32_bf16 a[76:79], a[200:203], a[224:227], a[76:79]
  ds_read_b64_tr_b16 a[174:175], v11 offset:1792
  v_mfma_f32_16x16x32_bf16 a[88:91], a[204:207], a[224:227], a[88:91]
  v_mfma_f32_16x16x32_bf16 a[56:59], a[192:195], a[228:231], a[56:59]
  v_mfma_f32_16x16x32_bf16 a[68:71], a[196:199], a[228:231], a[68:71]
  v_mfma_f32_16x16x32_bf16 a[80:83], a[200:203], a[228:231], a[80:83]
  v_mfma_f32_16x16x32_bf16 a[92:95], a[204:207], a[228:231], a[92:95]
  s_waitcnt lgkmcnt(8)
  v_mfma_f32_16x16x32_bf16 v[32:35], a[144:147], a[208:211], v[32:35]
  ds_read_b64_tr_b16 a[176:177], v5 offset:8192
  s_mov_b32 s54, 27
  v_mfma_f32_16x16x32_bf16 v[44:47], a[148:151], a[208:211], v[44:47]
  ds_read_b64_tr_b16 a[178:179], v5 offset:9216
  v_mfma_f32_16x16x32_bf16 v[56:59], a[152:155], a[208:211], v[56:59]
  ds_read_b64_tr_b16 a[180:181], v11 offset:8192
  v_mfma_f32_16x16x32_bf16 v[68:71], a[156:159], a[208:211], v[68:71]
  ds_read_b64_tr_b16 a[182:183], v11 offset:9216
  v_mfma_f32_16x16x32_bf16 v[36:39], a[144:147], a[212:215], v[36:39]
  ds_read_b64_tr_b16 a[184:185], v5 offset:8448
  v_mfma_f32_16x16x32_bf16 v[48:51], a[148:151], a[212:215], v[48:51]
  ds_read_b64_tr_b16 a[186:187], v5 offset:9472
  v_mfma_f32_16x16x32_bf16 v[60:63], a[152:155], a[212:215], v[60:63]
  ds_read_b64_tr_b16 a[188:189], v11 offset:8448
  v_mfma_f32_16x16x32_bf16 v[72:75], a[156:159], a[212:215], v[72:75]
  ds_read_b64_tr_b16 a[190:191], v11 offset:9472
  v_mfma_f32_16x16x32_bf16 v[40:43], a[144:147], a[216:219], v[40:43]
  ds_read_b128 a[220:223], v7 offset:512
  v_mfma_f32_16x16x32_bf16 v[52:55], a[148:151], a[216:219], v[52:55]
  ds_read_b128 a[224:227], v7 offset:2560
  v_mfma_f32_16x16x32_bf16 v[64:67], a[152:155], a[216:219], v[64:67]
  ds_read_b128 a[228:231], v7 offset:4608
  v_mfma_f32_16x16x32_bf16 v[76:79], a[156:159], a[216:219], v[76:79]
  ds_read_b64_tr_b16 a[192:193], v5 offset:8704
  s_waitcnt lgkmcnt(12)
  v_mfma_f32_16x16x32_bf16 v[80:83], a[160:163], a[208:211], v[80:83]
  ds_read_b64_tr_b16 a[194:195], v5 offset:9728
  v_mfma_f32_16x16x32_bf16 v[92:95], a[164:167], a[208:211], v[92:95]
  ds_read_b64_tr_b16 a[196:197], v11 offset:8704
  v_mfma_f32_16x16x32_bf16 v[104:107], a[168:171], a[208:211], v[104:107]
  ds_read_b64_tr_b16 a[198:199], v11 offset:9728
  v_mfma_f32_16x16x32_bf16 v[116:119], a[172:175], a[208:211], v[116:119]
  ds_read_b64_tr_b16 a[200:201], v5 offset:8960
  v_mfma_f32_16x16x32_bf16 v[84:87], a[160:163], a[212:215], v[84:87]
  ds_read_b64_tr_b16 a[202:203], v5 offset:9984
  v_mfma_f32_16x16x32_bf16 v[96:99], a[164:167], a[212:215], v[96:99]
  ds_read_b64_tr_b16 a[204:205], v11 offset:8960
  v_mfma_f32_16x16x32_bf16 v[108:111], a[168:171], a[212:215], v[108:111]
  ds_read_b64_tr_b16 a[206:207], v11 offset:9984
  v_mfma_f32_16x16x32_bf16 v[120:123], a[172:175], a[212:215], v[120:123]
  ds_read_b32 v248, v251 offset:20480
  v_add_u32 v5, 65536, v2
  v_mfma_f32_16x16x32_bf16 v[88:91], a[160:163], a[216:219], v[88:91]
  v_xor_b32 v11, 8, v5
  v_mfma_f32_16x16x32_bf16 v[100:103], a[164:167], a[216:219], v[100:103]
  v_mfma_f32_16x16x32_bf16 v[112:115], a[168:171], a[216:219], v[112:115]
  v_mfma_f32_16x16x32_bf16 v[124:127], a[172:175], a[216:219], v[124:127]
  s_waitcnt lgkmcnt(0)
  ds_write_b32 v249, v250 offset:0
  v_add_u32 v250, 1, v250
  v_readfirstlane_b32 s56, v248
  s_nop 1
  s_cmp_ge_u32 s56, s54
  s_cbranch_scc0 L_spin_p14
L_spun_p14:
  v_mfma_f32_16x16x32_bf16 v[32:35], a[176:179], a[220:223], v[32:35]
  ds_read_b64_tr_b16 a[144:145], v5 offset:0
  v_mfma_f32_16x16x32_bf16 v[44:47], a[180:183], a[220:223], v[44:47]
  ds_read_b64_tr_b16 a[146:147], v5 offset:1024
  v_mfma_f32_16x16x32_bf16 v[56:59], a[184:187], a[220:223], v[56:59]
  ds_read_b64_tr_b16 a[148:149], v11 offset:0
  v_mfma_f32_16x16x32_bf16 v[68:71], a[188:191], a[220:223], v[68:71]
  ds_read_b64_tr_b16 a[150:151], v11 offset:1024
  v_mfma_f32_16x16x32_bf16 v[36:39], a[176:179], a[224:227], v[36:39]
  ds_read_b64_tr_b16 a[152:153], v5 offset:256
  v_mfma_f32_16x16x32_bf16 v[48:51], a[180:183], a[224:227], v[48:51]
  ds_read_b64_tr_b16 a[154:155], v5 offset:1280
  v_mfma_f32_16x16x32_bf16 v[60:63], a[184:187], a[224:227], v[60:63]
  ds_read_b64_tr_b16 a[156:157], v11 offset:256
  v_mfma_f32_16x16x32_bf16 v[72:75], a[188:191], a[224:227], v[72:75]
  ds_read_b64_tr_b16 a[158:159], v11 offset:1280
  v_mfma_f32_16x16x32_bf16 v[40:43], a[176:179], a[228:231], v[40:43]
  ds_read_b64_tr_b16 a[160:161], v5 offset:512
  v_mfma_f32_16x16x32_bf16 v[52:55], a[180:183], a[228:231], v[52:55]
  ds_read_b64_tr_b16 a[162:163], v5 offset:1536
  v_mfma_f32_16x16x32_bf16 v[64:67], a[184:187], a[228:231], v[64:67]
  ds_read_b64_tr_b16 a[164:165], v11 offset:512
  v_mfma_f32_16x16x32_bf16 v[76:79], a[188:191], a[228:231], v[76:79]
  ds_read_b64_tr_b16 a[166:167], v11 offset:1536
  v_mfma_f32_16x16x32_bf16 v[80:83], a[192:195], a[220:223], v[80:83]
  ds_read_b64_tr_b16 a[168:169], v5 offset:768
  v_mfma_f32_16x16x32_bf16 v[92:95], a[196:199], a[220:223], v[92:95]
  ds_read_b64_tr_b16 a[170:171], v5 offset:1792
  v_mfma_f32_16x16x32_bf16 v[104:107], a[200:203], a[220:223], v[104:107]
  ds_read_b64_tr_b16 a[172:173], v11 offset:768
  v_mfma_f32_16x16x32_bf16 v[116:119], a[204:207], a[220:223], v[116:119]
  ds_read_b64_tr_b16 a[174:175], v11 offset:1792
  v_mfma_f32_16x16x32_bf16 v[84:87], a[192:195], a[224:227], v[84:87]
  v_mfma_f32_16x16x32_bf16 v[96:99], a[196:199], a[224:227], v[96:99]
  v_mfma_f32_16x16x32_bf16 v[108:111], a[200:203], a[224:227], v[108:111]
  v_mfma_f32_16x16x32_bf16 v[120:123], a[204:207], a[224:227], v[120:123]
  v_mfma_f32_16x16x32_bf16 v[88:91], a[192:195], a[228:231], v[88:91]
  v_mfma_f32_16x16x32_bf16 v[100:103], a[196:199], a[228:231], v[100:103]
  v_mfma_f32_16x16x32_bf16 v[112:115], a[200:203], a[228:231], v[112:115]
  v_mfma_f32_16x16x32_bf16 v[124:127], a[204:207], a[228:231], v[124:127]
  s_waitcnt lgkmcnt(8)
  v_mfma_f32_16x16x32_bf16 a[0:3], a[144:147], a[208:211], a[0:3]
  ds_read_b64_tr_b16 a[176:177], v5 offset:8192
  s_mov_b32 s54, 10
  v_mfma_f32_16x16x32_bf16 a[12:15], a[148:151], a[208:211], a[12:15]
  ds_read_b64_tr_b16 a[178:179], v5 offset:9216
  v_mfma_f32_16x16x32_bf16 a[24:27], a[152:155], a[208:211], a[24:27]
  ds_read_b64_tr_b16 a[180:181], v11 offset:8192
  v_pk_mul_f32 v[32:33], v[32:33], s[58:59]
  v_mfma_f32_16x16x32_bf16 a[36:39], a[156:159], a[208:211], a[36:39]
  ds_read_b64_tr_b16 a[182:183], v11 offset:9216
  v_pk_mul_f32 v[34:35], v[34:35], s[58:59]
  v_mfma_f32_16x16x32_bf16 a[4:7], a[144:147], a[212:215], a[4:7]
  ds_read_b64_tr_b16 a[184:185], v5 offset:8448
  v_pk_mul_f32 v[44:45], v[44:45], s[58:59]
  v_mfma_f32_16x16x32_bf16 a[16:19], a[148:151], a[212:215], a[16:19]
  ds_read_b64_tr_b16 a[186:187], v5 offset:9472
  v_pk_mul_f32 v[46:47], v[46:47], s[58:59]
  v_mfma_f32_16x16x32_bf16 a[28:31], a[152:155], a[212:215], a[28:31]
  ds_read_b64_tr_b16 a[188:189], v11 offset:8448
  v_cvt_pk_bf16_f32 v32, v32, v33
  v_mfma_f32_16x16x32_bf16 a[40:43], a[156:159], a[212:215], a[40:43]
  ds_read_b64_tr_b16 a[190:191], v11 offset:9472
  v_cvt_pk_bf16_f32 v34, v34, v35
  v_mfma_f32_16x16x32_bf16 a[8:11], a[144:147], a[216:219], a[8:11]
  ds_read_b64_tr_b16 a[192:193], v5 offset:8704
  v_cvt_pk_bf16_f32 v44, v44, v45
  v_mfma_f32_16x16x32_bf16 a[20:23], a[148:151], a[216:219], a[20:23]
  ds_read_b64_tr_b16 a[194:195], v5 offset:9728
  v_cvt_pk_bf16_f32 v46, v46, v47
  v_mfma_f32_16x16x32_bf16 a[32:35], a[152:155], a[216:219], a[32:35]
  ds_read_b64_tr_b16 a[196:197], v11 offset:8704
  v_cndmask_b32 v33, v32, v44, s[46:47]
  v_mfma_f32_16x16x32_bf16 a[44:47], a[156:159], a[216:219], a[44:47]
  ds_read_b64_tr_b16 a[198:199], v11 offset:9728
  s_waitcnt lgkmcnt(12)
  v_mfma_f32_16x16x32_bf16 a[48:51], a[160:163], a[208:211], a[48:51]
  ds_read_b64_tr_b16 a[200:201], v5 offset:8960
  v_cndmask_b32 v45, v44, v32, s[46:47]
  v_mfma_f32_16x16x32_bf16 a[60:63], a[164:167], a[208:211], a[60:63]
  ds_read_b64_tr_b16 a[202:203], v5 offset:9984
  v_cndmask_b32 v35, v34, v46, s[46:47]
  v_mfma_f32_16x16x32_bf16 a[72:75], a[168:171], a[208:211], a[72:75]
  ds_read_b64_tr_b16 a[204:205], v11 offset:8960
  v_cndmask_b32 v47, v46, v34, s[46:47]
  v_mfma_f32_16x16x32_bf16 a[84:87], a[172:175], a[208:211], a[84:87]
  ds_read_b64_tr_b16 a[206:207], v11 offset:9984
  v_accvgpr_write_b32 a96, v33
  v_mfma_f32_16x16x32_bf16 a[52:55], a[160:163], a[212:215], a[52:55]
  ds_read_b32 v248, v251 offset:20480
  v_accvgpr_write_b32 a97, v35
  v_mfma_f32_16x16x32_bf16 a[64:67], a[164:167], a[212:215], a[64:67]
  v_accvgpr_write_b32 a98, v45
  v_accvgpr_write_b32 a99, v47
  v_mfma_f32_16x16x32_bf16 a[76:79], a[168:171], a[212:215], a[76:79]
  v_pk_mul_f32 v[56:57], v[56:57], s[58:59]
  v_pk_mul_f32 v[58:59], v[58:59], s[58:59]
  v_mfma_f32_16x16x32_bf16 a[88:91], a[172:175], a[212:215], a[88:91]
  v_pk_mul_f32 v[68:69], v[68:69], s[58:59]
  v_pk_mul_f32 v[70:71], v[70:71], s[58:59]
  v_mfma_f32_16x16x32_bf16 a[56:59], a[160:163], a[216:219], a[56:59]
  v_cvt_pk_bf16_f32 v56, v56, v57
  v_cvt_pk_bf16_f32 v58, v58, v59
  v_mfma_f32_16x16x32_bf16 a[68:71], a[164:167], a[216:219], a[68:71]
  v_cvt_pk_bf16_f32 v68, v68, v69
  v_cvt_pk_bf16_f32 v70, v70, v71
  v_mfma_f32_16x16x32_bf16 a[80:83], a[168:171], a[216:219], a[80:83]
  v_cndmask_b32 v57, v56, v68, s[46:47]
  v_cndmask_b32 v69, v68, v56, s[46:47]
  v_mfma_f32_16x16x32_bf16 a[92:95], a[172:175], a[216:219], a[92:95]
  s_waitcnt lgkmcnt(0)
  ds_write_b32 v249, v250 offset:0
  v_add_u32 v250, 1, v250
  v_readfirstlane_b32 s56, v248
  s_nop 1
  s_cmp_ge_u32 s56, s54
  s_cbranch_scc0 L_spin_p15
L_spun_p15:
  v_mfma_f32_16x16x32_bf16 a[0:3], a[176:179], a[220:223], a[0:3]
  ds_read_b128 a[144:147], v3 offset:0
  v_cndmask_b32 v59, v58, v70, s[46:47]
  v_mfma_f32_16x16x32_bf16 a[12:15], a[180:183], a[220:223], a[12:15]
  v_cndmask_b32 v71, v70, v58, s[46:47]
  v_accvgpr_write_b32 a100, v57
  v_mfma_f32_16x16x32_bf16 a[24:27], a[184:187], a[220:223], a[24:27]
  ds_read_b128 a[148:151], v3 offset:256
  v_accvgpr_write_b32 a101, v59
  v_mfma_f32_16x16x32_bf16 a[36:39], a[188:191], a[220:223], a[36:39]
  v_accvgpr_write_b32 a102, v69
  v_accvgpr_write_b32 a103, v71
  v_mfma_f32_16x16x32_bf16 a[4:7], a[176:179], a[224:227], a[4:7]
  ds_read_b128 a[152:155], v3 offset:512
  v_pk_mul_f32 v[80:81], v[80:81], s[58:59]
  v_mfma_f32_16x16x32_bf16 a[16:19], a[180:183], a[224:227], a[16:19]
  v_pk_mul_f32 v[82:83], v[82:83], s[58:59]
  v_pk_mul_f32 v[92:93], v[92:93], s[58:59]
  v_mfma_f32_16x16x32_bf16 a[28:31], a[184:187], a[224:227], a[28:31]
  ds_read_b128 a[156:159], v3 offset:768
  v_pk_mul_f32 v[94:95], v[94:95], s[58:59]
  v_mfma_f32_16x16x32_bf16 a[40:43], a[188:191], a[224:227], a[40:43]
  v_cvt_pk_bf16_f32 v80, v80, v81
  v_cvt_pk_bf16_f32 v82, v82, v83
  v_mfma_f32_16x16x32_bf16 a[8:11], a[176:179], a[228:231], a[8:11]
  ds_read_b128 a[160:163], v3 offset:1024
  v_cvt_pk_bf16_f32 v92, v92, v93
  v_mfma_f32_16x16x32_bf16 a[20:23], a[180:183], a[228:231], a[20:23]
  v_cvt_pk_bf16_f32 v94, v94, v95
  v_cndmask_b32 v81, v80, v92, s[46:47]
  v_mfma_f32_16x16x32_bf16 a[32:35], a[184:187], a[228:231], a[32:35]
  ds_read_b128 a[164:167], v3 offset:1280
  v_cndmask_b32 v93, v92, v80, s[46:47]
  v_mfma_f32_16x16x32_bf16 a[44:47], a[188:191], a[228:231], a[44:47]
  v_cndmask_b32 v83, v82, v94, s[46:47]
  v_cndmask_b32 v95, v94, v82, s[46:47]
  v_mfma_f32_16x16x32_bf16 a[48:51], a[192:195], a[220:223], a[48:51]
  ds_read_b128 a[168:171], v3 offset:1536
  v_accvgpr_write_b32 a104, v81
  v_mfma_f32_16x16x32_bf16 a[60:63], a[196:199], a[220:223], a[60:63]
  v_accvgpr_write_b32 a105, v83
  v_accvgpr_write_b32 a106, v93
  v_mfma_f32_16x16x32_bf16 a[72:75], a[200:203], a[220:223], a[72:75]
  ds_read_b128 a[172:175], v3 offset:1792
  v_accvgpr_write_b32 a107, v95
  v_mfma_f32_16x16x32_bf16 a[84:87], a[204:207], a[220:223], a[84:87]
  v_pk_mul_f32 v[104:105], v[104:105], s[58:59]
  v_pk_mul_f32 v[106:107], v[106:107], s[58:59]
  v_mfma_f32_16x16x32_bf16 a[52:55], a[192:195], a[224:227], a[52:55]
  v_pk_mul_f32 v[116:117], v[116:117], s[58:59]
  v_pk_mul_f32 v[118:119], v[118:119], s[58:59]
  v_mfma_f32_16x16x32_bf16 a[64:67], a[196:199], a[224:227], a[64:67]
  v_cvt_pk_bf16_f32 v104, v104, v105
  v_cvt_pk_bf16_f32 v106, v106, v107
  v_mfma_f32_16x16x32_bf16 a[76:79], a[200:203], a[224:227], a[76:79]
  v_cvt_pk_bf16_f32 v116, v116, v117
  v_cvt_pk_bf16_f32 v118, v118, v119
  v_mfma_f32_16x16x32_bf16 a[88:91], a[204:207], a[224:227], a[88:91]
  v_cndmask_b32 v105, v104, v116, s[46:47]
  v_cndmask_b32 v117, v116, v104, s[46:47]
  v_mfma_f32_16x16x32_bf16 a[56:59], a[192:195], a[228:231], a[56:59]
  v_cndmask_b32 v107, v106, v118, s[46:47]
  v_cndmask_b32 v119, v118, v106, s[46:47]
  v_mfma_f32_16x16x32_bf16 a[68:71], a[196:199], a[228:231], a[68:71]
  v_accvgpr_write_b32 a108, v105
  v_accvgpr_write_b32 a109, v107
  v_mfma_f32_16x16x32_bf16 a[80:83], a[200:203], a[228:231], a[80:83]
  v_accvgpr_write_b32 a110, v117
  v_accvgpr_write_b32 a111, v119
  v_mfma_f32_16x16x32_bf16 a[92:95], a[204:207], a[228:231], a[92:95]
  v_pk_mul_f32 v[36:37], v[36:37], s[58:59]
  v_pk_mul_f32 v[38:39], v[38:39], s[58:59]
  v_pk_mul_f32 v[48:49], v[48:49], s[58:59]
  v_pk_mul_f32 v[50:51], v[50:51], s[58:59]
  v_cvt_pk_bf16_f32 v36, v36, v37
  v_cvt_pk_bf16_f32 v38, v38, v39
  v_cvt_pk_bf16_f32 v48, v48, v49
  v_cvt_pk_bf16_f32 v50, v50, v51
  v_cndmask_b32 v37, v36, v48, s[46:47]
  v_cndmask_b32 v49, v48, v36, s[46:47]
  v_cndmask_b32 v39, v38, v50, s[46:47]
  v_cndmask_b32 v51, v50, v38, s[46:47]
  v_accvgpr_write_b32 a112, v37
  v_accvgpr_write_b32 a113, v39
  v_accvgpr_write_b32 a114, v49
  v_accvgpr_write_b32 a115, v51
  v_pk_mul_f32 v[60:61], v[60:61], s[58:59]
  v_pk_mul_f32 v[62:63], v[62:63], s[58:59]
  v_pk_mul_f32 v[72:73], v[72:73], s[58:59]
  v_pk_mul_f32 v[74:75], v[74:75], s[58:59]
  v_cvt_pk_bf16_f32 v60, v60, v61
  v_cvt_pk_bf16_f32 v62, v62, v63
  v_cvt_pk_bf16_f32 v72, v72, v73
  v_cvt_pk_bf16_f32 v74, v74, v75
  v_cndmask_b32 v61, v60, v72, s[46:47]
  v_cndmask_b32 v73, v72, v60, s[46:47]
  v_cndmask_b32 v63, v62, v74, s[46:47]
  v_cndmask_b32 v75, v74, v62, s[46:47]
  v_accvgpr_write_b32 a116, v61
  v_accvgpr_write_b32 a117, v63
  v_accvgpr_write_b32 a118, v73
  v_accvgpr_write_b32 a119, v75
  v_pk_mul_f32 v[84:85], v[84:85], s[58:59]
  v_pk_mul_f32 v[86:87], v[86:87], s[58:59]
  v_pk_mul_f32 v[96:97], v[96:97], s[58:59]
  v_pk_mul_f32 v[98:99], v[98:99], s[58:59]
  v_cvt_pk_bf16_f32 v84, v84, v85
  v_cvt_pk_bf16_f32 v86, v86, v87
  v_cvt_pk_bf16_f32 v96, v96, v97
  v_cvt_pk_bf16_f32 v98, v98, v99
  v_cndmask_b32 v85, v84, v96, s[46:47]
  v_cndmask_b32 v97, v96, v84, s[46:47]
  v_cndmask_b32 v87, v86, v98, s[46:47]
  v_cndmask_b32 v99, v98, v86, s[46:47]
  v_accvgpr_write_b32 a120, v85
  v_accvgpr_write_b32 a121, v87
  v_accvgpr_write_b32 a122, v97
  v_accvgpr_write_b32 a123, v99
  v_pk_mul_f32 v[108:109], v[108:109], s[58:59]
  v_pk_mul_f32 v[110:111], v[110:111], s[58:59]
  v_pk_mul_f32 v[120:121], v[120:121], s[58:59]
  v_pk_mul_f32 v[122:123], v[122:123], s[58:59]
  v_cvt_pk_bf16_f32 v108, v108, v109
  v_cvt_pk_bf16_f32 v110, v110, v111
  v_cvt_pk_bf16_f32 v120, v120, v121
  v_cvt_pk_bf16_f32 v122, v122, v123
  v_cndmask_b32 v109, v108, v120, s[46:47]
  v_cndmask_b32 v121, v120, v108, s[46:47]
  v_cndmask_b32 v111, v110, v122, s[46:47]
  v_cndmask_b32 v123, v122, v110, s[46:47]
  v_accvgpr_write_b32 a124, v109
  v_accvgpr_write_b32 a125, v111
  v_accvgpr_write_b32 a126, v121
  v_accvgpr_write_b32 a127, v123
  v_pk_mul_f32 v[40:41], v[40:41], s[58:59]
  v_pk_mul_f32 v[42:43], v[42:43], s[58:59]
  v_pk_mul_f32 v[52:53], v[52:53], s[58:59]
  v_pk_mul_f32 v[54:55], v[54:55], s[58:59]
  v_cvt_pk_bf16_f32 v40, v40, v41
  v_cvt_pk_bf16_f32 v42, v42, v43
  v_cvt_pk_bf16_f32 v52, v52, v53
  v_cvt_pk_bf16_f32 v54, v54, v55
  v_cndmask_b32 v41, v40, v52, s[46:47]
  v_cndmask_b32 v53, v52, v40, s[46:47]
  v_cndmask_b32 v43, v42, v54, s[46:47]
  v_cndmask_b32 v55, v54, v42, s[46:47]
  v_accvgpr_write_b32 a128, v41
  v_accvgpr_write_b32 a129, v43
  v_accvgpr_write_b32 a130, v53
  v_accvgpr_write_b32 a131, v55
  v_pk_mul_f32 v[64:65], v[64:65], s[58:59]
  v_pk_mul_f32 v[66:67], v[66:67], s[58:59]
  v_pk_mul_f32 v[76:77], v[76:77], s[58:59]
  v_pk_mul_f32 v[78:79], v[78:79], s[58:59]
  v_cvt_pk_bf16_f32 v64, v64, v65
  v_cvt_pk_bf16_f32 v66, v66, v67
  v_cvt_pk_bf16_f32 v76, v76, v77
  v_cvt_pk_bf16_f32 v78, v78, v79
  v_cndmask_b32 v65, v64, v76, s[46:47]
  v_cndmask_b32 v77, v76, v64, s[46:47]
  v_cndmask_b32 v67, v66, v78, s[46:47]
  v_cndmask_b32 v79, v78, v66, s[46:47]
  v_accvgpr_write_b32 a132, v65
  v_accvgpr_write_b32 a133, v67
  v_accvgpr_write_b32 a134, v77
  v_accvgpr_write_b32 a135, v79
  v_pk_mul_f32 v[88:89], v[88:89], s[58:59]
  v_pk_mul_f32 v[90:91], v[90:91], s[58:59]
  v_pk_mul_f32 v[100:101], v[100:101], s[58:59]
  v_pk_mul_f32 v[102:103], v[102:103], s[58:59]
  v_cvt_pk_bf16_f32 v88, v88, v89
  v_cvt_pk_bf16_f32 v90, v90, v91
  v_cvt_pk_bf16_f32 v100, v100, v101
  v_cvt_pk_bf16_f32 v102, v102, v103
  v_cndmask_b32 v89, v88, v100, s[46:47]
  v_cndmask_b32 v101, v100, v88, s[46:47]
  v_cndmask_b32 v91, v90, v102, s[46:47]
  v_cndmask_b32 v103, v102, v90, s[46:47]
  v_accvgpr_write_b32 a136, v89
  v_accvgpr_write_b32 a137, v91
  v_accvgpr_write_b32 a138, v101
  v_accvgpr_write_b32 a139, v103
  v_pk_mul_f32 v[112:113], v[112:113], s[58:59]
  v_pk_mul_f32 v[114:115], v[114:115], s[58:59]
  v_pk_mul_f32 v[124:125], v[124:125], s[58:59]
  v_pk_mul_f32 v[126:127], v[126:127], s[58:59]
  v_cvt_pk_bf16_f32 v112, v112, v113
  v_cvt_pk_bf16_f32 v114, v114, v115
  v_cvt_pk_bf16_f32 v124, v124, v125
  v_cvt_pk_bf16_f32 v126, v126, v127
  v_cndmask_b32 v113, v112, v124, s[46:47]
  v_cndmask_b32 v125, v124, v112, s[46:47]
  v_cndmask_b32 v115, v114, v126, s[46:47]
  v_cndmask_b32 v127, v126, v114, s[46:47]
  v_accvgpr_write_b32 a140, v113
  v_accvgpr_write_b32 a141, v115
  v_accvgpr_write_b32 a142, v125
  v_accvgpr_write_b32 a143, v127
  s_waitcnt vmcnt(0)
  s_lshr_b32 s63, s2, 3
  s_mul_i32 s63, s63, 3
  s_add_u32 s63, s63, s3
  s_lshl_b32 s63, s63, 10
  v_add_u32 v128, s63, v9
  v_min_u32 v128, L_k1_end-concat_heads__gqa_block_cached__gqa_block_cached__near_ridge_kernel-16, v128
  global_load_dwordx4 a[252:255], v128, s[96:97]
  s_mov_b32 s101, 0
L_task:
  s_waitcnt lgkmcnt(4)
  v_mfma_f32_16x16x32_bf16 v[32:35], a[144:147], a[96:99], 0
  ds_read_b128 a[176:179], v3 offset:8192
  s_mul_i32 s54, s101, 38
  s_add_u32 s54, s54, 21
  v_mfma_f32_16x16x32_bf16 v[36:39], a[144:147], a[112:115], 0
  ds_read_b128 a[180:183], v3 offset:8448
  s_add_u32 s52, s52, 16384
  v_mfma_f32_16x16x32_bf16 v[40:43], a[144:147], a[128:131], 0
  s_cmp_eq_u32 s52, 81920
  s_cselect_b32 s52, 0, s52
  v_mov_b32 v152, 0
  v_mfma_f32_16x16x32_bf16 v[32:35], a[148:151], a[100:103], v[32:35]
  ds_read_b128 a[184:187], v3 offset:8704
  v_mov_b32 v153, 0
  v_mfma_f32_16x16x32_bf16 v[36:39], a[148:151], a[116:119], v[36:39]
  ds_read_b128 a[188:191], v3 offset:8960
  v_mov_b32 v154, 0
  v_mfma_f32_16x16x32_bf16 v[40:43], a[148:151], a[132:135], v[40:43]
  v_mov_b32 v155, 0
  v_mov_b32 v156, 0
  v_mfma_f32_16x16x32_bf16 v[32:35], a[152:155], a[104:107], v[32:35]
  ds_read_b128 a[192:195], v3 offset:9216
  v_mov_b32 v157, 0
  v_mfma_f32_16x16x32_bf16 v[36:39], a[152:155], a[120:123], v[36:39]
  ds_read_b128 a[196:199], v3 offset:9472
  v_mov_b32 v158, 0
  v_mfma_f32_16x16x32_bf16 v[40:43], a[152:155], a[136:139], v[40:43]
  v_mov_b32 v159, 0
  v_mov_b32 v160, 0
  v_mfma_f32_16x16x32_bf16 v[32:35], a[156:159], a[108:111], v[32:35]
  ds_read_b128 a[200:203], v3 offset:9728
  v_mov_b32 v161, 0
  v_mfma_f32_16x16x32_bf16 v[36:39], a[156:159], a[124:127], v[36:39]
  ds_read_b128 a[204:207], v3 offset:9984
  v_mov_b32 v162, 0
  v_mfma_f32_16x16x32_bf16 v[40:43], a[156:159], a[140:143], v[40:43]
  v_add_u32 v3, s52, v1
  s_waitcnt lgkmcnt(8)
  v_mfma_f32_16x16x32_bf16 v[44:47], a[160:163], a[96:99], 0
  v_mov_b32 v163, 0
  v_mov_b32 v164, 0
  v_mfma_f32_16x16x32_bf16 v[48:51], a[160:163], a[112:115], 0
  v_mov_b32 v165, 0
  v_mov_b32 v166, 0
  v_mfma_f32_16x16x32_bf16 v[52:55], a[160:163], a[128:131], 0
  ds_read_b32 v248, v251 offset:20480
  v_mov_b32 v167, 0
  v_mfma_f32_16x16x32_bf16 v[44:47], a[164:167], a[100:103], v[44:47]
  v_mov_b32 v168, 0
  v_mov_b32 v169, 0
  v_mfma_f32_16x16x32_bf16 v[48:51], a[164:167], a[116:119], v[48:51]
  v_mov_b32 v170, 0
  v_mov_b32 v171, 0
  v_mfma_f32_16x16x32_bf16 v[52:55], a[164:167], a[132:135], v[52:55]
  v_mov_b32 v172, 0
  v_mov_b32 v173, 0
  v_mfma_f32_16x16x32_bf16 v[44:47], a[168:171], a[104:107], v[44:47]
  v_mov_b32 v174, 0
  v_mov_b32 v175, 0
  v_mfma_f32_16x16x32_bf16 v[48:51], a[168:171], a[120:123], v[48:51]
  v_mov_b32 v176, 0
  v_mov_b32 v177, 0
  v_mfma_f32_16x16x32_bf16 v[52:55], a[168:171], a[136:139], v[52:55]
  v_mov_b32 v178, 0
  v_mov_b32 v179, 0
  v_mfma_f32_16x16x32_bf16 v[44:47], a[172:175], a[108:111], v[44:47]
  v_mov_b32 v180, 0
  v_mov_b32 v181, 0
  v_mfma_f32_16x16x32_bf16 v[48:51], a[172:175], a[124:127], v[48:51]
  v_mov_b32 v182, 0
  v_mov_b32 v183, 0
  v_mfma_f32_16x16x32_bf16 v[52:55], a[172:175], a[140:143], v[52:55]
  s_waitcnt lgkmcnt(0)
  v_readfirstlane_b32 s56, v248
  s_nop 1
  s_cmp_ge_u32 s56, s54
  s_cbranch_scc0 L_spin_pro0
L_spun_pro0:
  v_mfma_f32_16x16x32_bf16 v[56:59], a[176:179], a[96:99], 0
  ds_read_b128 a[144:147], v3 offset:0
  v_mov_b32 v184, 0
  v_mfma_f32_16x16x32_bf16 v[60:63], a[176:179], a[112:115], 0
  v_mov_b32 v185, 0
  v_mov_b32 v186, 0
  v_mfma_f32_16x16x32_bf16 v[64:67], a[176:179], a[128:131], 0
  ds_read_b128 a[148:151], v3 offset:256
  v_mov_b32 v187, 0
  v_mfma_f32_16x16x32_bf16 v[56:59], a[180:183], a[100:103], v[56:59]
  v_mov_b32 v188, 0
  v_mov_b32 v189, 0
  v_mfma_f32_16x16x32_bf16 v[60:63], a[180:183], a[116:119], v[60:63]
  ds_read_b128 a[152:155], v3 offset:512
  v_mov_b32 v190, 0
  v_mfma_f32_16x16x32_bf16 v[64:67], a[180:183], a[132:135], v[64:67]
  v_mov_b32 v191, 0
  v_mov_b32 v192, 0
  v_mfma_f32_16x16x32_bf16 v[56:59], a[184:187], a[104:107], v[56:59]
  ds_read_b128 a[156:159], v3 offset:768
  v_mov_b32 v193, 0
  v_mfma_f32_16x16x32_bf16 v[60:63], a[184:187], a[120:123], v[60:63]
  v_mov_b32 v194, 0
  v_mov_b32 v195, 0
  v_mfma_f32_16x16x32_bf16 v[64:67], a[184:187], a[136:139], v[64:67]
  ds_read_b128 a[160:163], v3 offset:1024
  v_mov_b32 v196, 0
  v_mfma_f32_16x16x32_bf16 v[56:59], a[188:191], a[108:111], v[56:59]
  v_mov_b32 v197, 0
  v_mov_b32 v198, 0
  v_mfma_f32_16x16x32_bf16 v[60:63], a[188:191], a[124:127], v[60:63]
  ds_read_b128 a[164:167], v3 offset:1280
  v_mov_b32 v199, 0
  v_mfma_f32_16x16x32_bf16 v[64:67], a[188:191], a[140:143], v[64:67]
  v_mov_b32 v200, 0
  v_mov_b32 v201, 0
  v_mfma_f32_16x16x32_bf16 v[68:71], a[192:195], a[96:99], 0
  ds_read_b128 a[168:171], v3 offset:1536
  v_mov_b32 v202, 0
  v_mfma_f32_16x16x32_bf16 v[72:75], a[192:195], a[112:115], 0
  v_mov_b32 v203, 0
  v_mov_b32 v204, 0
  v_mfma_f32_16x16x32_bf16 v[76:79], a[192:195], a[128:131], 0
  ds_read_b128 a[172:175], v3 offset:1792
  v_mov_b32 v205, 0
  v_mfma_f32_16x16x32_bf16 v[68:71], a[196:199], a[100:103], v[68:71]
  v_mov_b32 v206, 0
  v_mov_b32 v207, 0
  v_mfma_f32_16x16x32_bf16 v[72:75], a[196:199], a[116:119], v[72:75]
  v_mov_b32 v208, 0
  v_mov_b32 v209, 0
  v_mfma_f32_16x16x32_bf16 v[76:79], a[196:199], a[132:135], v[76:79]
  v_mov_b32 v210, 0
  v_mov_b32 v211, 0
  v_mfma_f32_16x16x32_bf16 v[68:71], a[200:203], a[104:107], v[68:71]
  v_mov_b32 v212, 0
  v_mov_b32 v213, 0
  v_mfma_f32_16x16x32_bf16 v[72:75], a[200:203], a[120:123], v[72:75]
  v_mov_b32 v214, 0
  v_mov_b32 v215, 0
  v_mfma_f32_16x16x32_bf16 v[76:79], a[200:203], a[136:139], v[76:79]
  v_mov_b32 v216, 0
  v_mov_b32 v217, 0
  v_mfma_f32_16x16x32_bf16 v[68:71], a[204:207], a[108:111], v[68:71]
  v_mov_b32 v218, 0
  v_mov_b32 v219, 0
  v_mfma_f32_16x16x32_bf16 v[72:75], a[204:207], a[124:127], v[72:75]
  v_mov_b32 v220, 0
  v_mov_b32 v221, 0
  v_mfma_f32_16x16x32_bf16 v[76:79], a[204:207], a[140:143], v[76:79]
  v_mov_b32 v222, 0
  v_mov_b32 v223, 0
  v_mov_b32 v224, 0
  v_mov_b32 v225, 0
  v_mov_b32 v226, 0
  v_mov_b32 v227, 0
  v_mov_b32 v228, 0
  v_mov_b32 v229, 0
  v_mov_b32 v230, 0
  v_mov_b32 v231, 0
  v_mov_b32 v232, 0
  v_mov_b32 v233, 0
  v_mov_b32 v234, 0
  v_mov_b32 v235, 0
  v_mov_b32 v236, 0
  v_mov_b32 v237, 0
  v_mov_b32 v238, 0
  v_mov_b32 v239, 0
  v_mov_b32 v240, 0
  v_mov_b32 v241, 0
  v_mov_b32 v242, 0
  v_mov_b32 v243, 0
  v_mov_b32 v244, 0
  v_mov_b32 v245, 0
  v_mov_b32 v246, 0
  v_mov_b32 v247, 0
  v_mov_b32 v12, 0
  v_mov_b32 v13, 0
  v_mov_b32 v14, 0
  v_mov_b32 v15, 0
  v_mov_b32 v16, 0
  v_mov_b32 v17, 0
  v_max3_f32 v128, v32, v33, v34
  v_max3_f32 v128, v128, v35, v44
  v_max3_f32 v128, v128, v45, v46
  v_max3_f32 v128, v128, v47, v56
  v_max3_f32 v128, v128, v57, v58
  v_max3_f32 v128, v128, v59, v68
  v_max3_f32 v128, v128, v69, v70
  v_max_f32 v128, v128, v71
  v_max3_f32 v129, v36, v37, v38
  v_max3_f32 v129, v129, v39, v48
  v_max3_f32 v129, v129, v49, v50
  v_max3_f32 v129, v129, v51, v60
  v_max3_f32 v129, v129, v61, v62
  v_max3_f32 v129, v129, v63, v72
  v_max3_f32 v129, v129, v73, v74
  v_max_f32 v129, v129, v75
  v_max3_f32 v130, v40, v41, v42
  v_max3_f32 v130, v130, v43, v52
  v_max3_f32 v130, v130, v53, v54
  v_max3_f32 v130, v130, v55, v64
  v_max3_f32 v130, v130, v65, v66
  v_max3_f32 v130, v130, v67, v76
  v_max3_f32 v130, v130, v77, v78
  v_max_f32 v130, v130, v79
  v_mov_b32 v131, v128
  s_nop 1
  v_permlane32_swap_b32 v128, v131
  v_max_f32 v128, v128, v131
  v_mov_b32 v131, v129
  s_nop 1
  v_permlane32_swap_b32 v129, v131
  v_max_f32 v129, v129, v131
  v_mov_b32 v131, v130
  s_nop 1
  v_permlane32_swap_b32 v130, v131
  v_max_f32 v130, v130, v131
  v_mov_b32 v131, v128
  s_nop 1
  v_permlane16_swap_b32 v128, v131
  v_max_f32 v128, v128, v131
  v_mov_b32 v131, v129
  s_nop 1
  v_permlane16_swap_b32 v129, v131
  v_max_f32 v129, v129, v131
  v_mov_b32 v131, v130
  s_nop 1
  v_permlane16_swap_b32 v130, v131
  v_max_f32 v130, v130, v131
  v_sub_f32 v20, 0, v128
  v_sub_f32 v21, 0, v128
  v_sub_f32 v22, 0, v128
  v_sub_f32 v23, 0, v128
  v_sub_f32 v32, v32, v128
  v_sub_f32 v33, v33, v128
  v_sub_f32 v34, v34, v128
  v_sub_f32 v35, v35, v128
  v_sub_f32 v44, v44, v128
  v_sub_f32 v45, v45, v128
  v_sub_f32 v46, v46, v128
  v_sub_f32 v47, v47, v128
  v_sub_f32 v56, v56, v128
  v_sub_f32 v57, v57, v128
  v_sub_f32 v58, v58, v128
  v_sub_f32 v59, v59, v128
  v_sub_f32 v68, v68, v128
  v_sub_f32 v69, v69, v128
  v_sub_f32 v70, v70, v128
  v_sub_f32 v71, v71, v128
  v_sub_f32 v24, 0, v129
  v_sub_f32 v25, 0, v129
  v_sub_f32 v26, 0, v129
  v_sub_f32 v27, 0, v129
  v_sub_f32 v36, v36, v129
  v_sub_f32 v37, v37, v129
  v_sub_f32 v38, v38, v129
  v_sub_f32 v39, v39, v129
  v_sub_f32 v48, v48, v129
  v_sub_f32 v49, v49, v129
  v_sub_f32 v50, v50, v129
  v_sub_f32 v51, v51, v129
  v_sub_f32 v60, v60, v129
  v_sub_f32 v61, v61, v129
  v_sub_f32 v62, v62, v129
  v_sub_f32 v63, v63, v129
  v_sub_f32 v72, v72, v129
  v_sub_f32 v73, v73, v129
  v_sub_f32 v74, v74, v129
  v_sub_f32 v75, v75, v129
  v_sub_f32 v28, 0, v130
  v_sub_f32 v29, 0, v130
  v_sub_f32 v30, 0, v130
  v_sub_f32 v31, 0, v130
  v_sub_f32 v40, v40, v130
  v_sub_f32 v41, v41, v130
  v_sub_f32 v42, v42, v130
  v_sub_f32 v43, v43, v130
  v_sub_f32 v52, v52, v130
  v_sub_f32 v53, v53, v130
  v_sub_f32 v54, v54, v130
  v_sub_f32 v55, v55, v130
  v_sub_f32 v64, v64, v130
  v_sub_f32 v65, v65, v130
  v_sub_f32 v66, v66, v130
  v_sub_f32 v67, v67, v130
  v_sub_f32 v76, v76, v130
  v_sub_f32 v77, v77, v130
  v_sub_f32 v78, v78, v130
  v_sub_f32 v79, v79, v130
  s_mov_b32 s55, 0
  s_lshl_b32 s54, s101, 5
  s_add_u32 s54, s54, 27
  s_lshl_b32 s100, s101, 3
.p2align 6
L_loop:
  s_nop 1
  s_waitcnt lgkmcnt(4)
  v_mfma_f32_16x16x32_bf16 v[80:83], a[144:147], a[96:99], v[20:23]
  v_exp_f32 v32, v32
  v_mfma_f32_16x16x32_bf16 v[84:87], a[144:147], a[112:115], v[24:27]
  v_exp_f32 v33, v33
  v_mfma_f32_16x16x32_bf16 v[88:91], a[144:147], a[128:131], v[28:31]
  v_exp_f32 v34, v34
  v_mfma_f32_16x16x32_bf16 v[80:83], a[148:151], a[100:103], v[80:83]
  ds_read_b128 a[176:179], v3 offset:8192
  v_cvt_pk_bf16_f32 v128, v32, v33
  v_mfma_f32_16x16x32_bf16 v[84:87], a[148:151], a[116:119], v[84:87]
  ds_read_b128 a[180:183], v3 offset:8448
  v_add_f32 v12, v12, v32
  v_mfma_f32_16x16x32_bf16 v[88:91], a[148:151], a[132:135], v[88:91]
  ds_read_b128 a[184:187], v3 offset:8704
  v_add_f32 v13, v13, v33
  v_mfma_f32_16x16x32_bf16 v[80:83], a[152:155], a[104:107], v[80:83]
  v_exp_f32 v35, v35
  v_mfma_f32_16x16x32_bf16 v[84:87], a[152:155], a[120:123], v[84:87]
  ds_read_b128 a[188:191], v3 offset:8960
  v_cvt_pk_bf16_f32 v129, v34, v35
  v_mfma_f32_16x16x32_bf16 v[88:91], a[152:155], a[136:139], v[88:91]
  v_exp_f32 v44, v44
  v_mfma_f32_16x16x32_bf16 v[80:83], a[156:159], a[108:111], v[80:83]
  v_exp_f32 v45, v45
  v_mfma_f32_16x16x32_bf16 v[84:87], a[156:159], a[124:127], v[84:87]
  v_exp_f32 v46, v46
  v_mfma_f32_16x16x32_bf16 v[88:91], a[156:159], a[140:143], v[88:91]
  v_add_f32 v12, v12, v34
  s_waitcnt lgkmcnt(4)
  v_mfma_f32_16x16x32_bf16 v[92:95], a[160:163], a[96:99], v[20:23]
  v_add_f32 v13, v13, v35
  v_cvt_pk_bf16_f32 v130, v44, v45
  v_mfma_f32_16x16x32_bf16 v[96:99], a[160:163], a[112:115], v[24:27]
  v_exp_f32 v47, v47
  v_mfma_f32_16x16x32_bf16 v[100:103], a[160:163], a[128:131], v[28:31]
  v_cvt_pk_bf16_f32 v131, v46, v47
  v_add_f32 v12, v12, v44
  v_mfma_f32_16x16x32_bf16 v[92:95], a[164:167], a[100:103], v[92:95]
  v_exp_f32 v36, v36
  v_mfma_f32_16x16x32_bf16 v[96:99], a[164:167], a[116:119], v[96:99]
  v_exp_f32 v37, v37
  v_mfma_f32_16x16x32_bf16 v[100:103], a[164:167], a[132:135], v[100:103]
  v_exp_f32 v38, v38
  v_mfma_f32_16x16x32_bf16 v[92:95], a[168:171], a[104:107], v[92:95]
  v_add_f32 v13, v13, v45
  v_add_f32 v12, v12, v46
  v_mfma_f32_16x16x32_bf16 v[96:99], a[168:171], a[120:123], v[96:99]
  v_add_f32 v13, v13, v47
  v_cvt_pk_bf16_f32 v132, v36, v37
  v_mfma_f32_16x16x32_bf16 v[100:103], a[168:171], a[136:139], v[100:103]
  v_exp_f32 v39, v39
  v_mfma_f32_16x16x32_bf16 v[92:95], a[172:175], a[108:111], v[92:95]
  v_cvt_pk_bf16_f32 v133, v38, v39
  v_add_f32 v14, v14, v36
  v_mfma_f32_16x16x32_bf16 v[96:99], a[172:175], a[124:127], v[96:99]
  v_exp_f32 v48, v48
  v_mfma_f32_16x16x32_bf16 v[100:103], a[172:175], a[140:143], v[100:103]
  v_add_f32 v15, v15, v37
  s_waitcnt lgkmcnt(0)
  v_mfma_f32_16x16x32_bf16 v[104:107], a[176:179], a[96:99], v[20:23]
  v_exp_f32 v49, v49
  v_mfma_f32_16x16x32_bf16 v[108:111], a[176:179], a[112:115], v[24:27]
  v_exp_f32 v50, v50
  v_mfma_f32_16x16x32_bf16 v[112:115], a[176:179], a[128:131], v[28:31]
  ds_read_b128 a[192:195], v3 offset:9216
  v_add_f32 v14, v14, v38
  v_mfma_f32_16x16x32_bf16 v[104:107], a[180:183], a[100:103], v[104:107]
  ds_read_b128 a[196:199], v3 offset:9472
  v_add_f32 v15, v15, v39
  v_mfma_f32_16x16x32_bf16 v[108:111], a[180:183], a[116:119], v[108:111]
  ds_read_b128 a[200:203], v3 offset:9728
  v_cvt_pk_bf16_f32 v134, v48, v49
  v_mfma_f32_16x16x32_bf16 v[112:115], a[180:183], a[132:135], v[112:115]
  ds_read_b128 a[204:207], v3 offset:9984
  v_max3_f32 v10, v80, v81, v82
  v_mfma_f32_16x16x32_bf16 v[104:107], a[184:187], a[104:107], v[104:107]
  ds_read_b64_tr_b16 a[144:145], v4 offset:0
  v_add_f32 v14, v14, v48
  v_mfma_f32_16x16x32_bf16 v[108:111], a[184:187], a[120:123], v[108:111]
  ds_read_b64_tr_b16 a[146:147], v4 offset:1024
  v_add_f32 v15, v15, v49
  v_mfma_f32_16x16x32_bf16 v[112:115], a[184:187], a[136:139], v[112:115]
  ds_read_b64_tr_b16 a[148:149], v6 offset:0
  v_add_f32 v14, v14, v50
  v_mfma_f32_16x16x32_bf16 v[104:107], a[188:191], a[108:111], v[104:107]
  ds_read_b64_tr_b16 a[150:151], v6 offset:1024
  v_max3_f32 v10, v10, v83, v84
  v_mfma_f32_16x16x32_bf16 v[108:111], a[188:191], a[124:127], v[108:111]
  ds_read_b64_tr_b16 a[152:153], v4 offset:256
  v_max3_f32 v10, v10, v85, v86
  v_mfma_f32_16x16x32_bf16 v[112:115], a[188:191], a[140:143], v[112:115]
  ds_read_b64_tr_b16 a[154:155], v4 offset:1280
  s_waitcnt lgkmcnt(6)
  v_mfma_f32_16x16x32_bf16 v[116:119], a[192:195], a[96:99], v[20:23]
  ds_read_b64_tr_b16 a[156:157], v6 offset:256
  s_add_u32 s52, s52, 16384
  v_mfma_f32_16x16x32_bf16 v[120:123], a[192:195], a[112:115], v[24:27]
  ds_read_b64_tr_b16 a[158:159], v6 offset:1280
  v_max3_f32 v10, v10, v87, v88
  v_mfma_f32_16x16x32_bf16 v[124:127], a[192:195], a[128:131], v[28:31]
  ds_read_b64_tr_b16 a[160:161], v4 offset:512
  v_max3_f32 v10, v10, v89, v90
  v_mfma_f32_16x16x32_bf16 v[116:119], a[196:199], a[100:103], v[116:119]
  ds_read_b64_tr_b16 a[162:163], v4 offset:1536
  v_max3_f32 v10, v10, v91, v92
  v_mfma_f32_16x16x32_bf16 v[120:123], a[196:199], a[116:119], v[120:123]
  ds_read_b64_tr_b16 a[164:165], v6 offset:512
  v_max3_f32 v10, v10, v93, v94
  v_mfma_f32_16x16x32_bf16 v[124:127], a[196:199], a[132:135], v[124:127]
  ds_read_b64_tr_b16 a[166:167], v6 offset:1536
  v_max3_f32 v10, v10, v95, v96
  v_mfma_f32_16x16x32_bf16 v[116:119], a[200:203], a[104:107], v[116:119]
  ds_read_b64_tr_b16 a[168:169], v4 offset:768
  s_cmp_eq_u32 s52, 81920
  s_cselect_b32 s52, 0, s52
  v_mfma_f32_16x16x32_bf16 v[120:123], a[200:203], a[120:123], v[120:123]
  ds_read_b64_tr_b16 a[170:171], v4 offset:1792
  v_max3_f32 v10, v10, v97, v98
  v_mfma_f32_16x16x32_bf16 v[124:127], a[200:203], a[136:139], v[124:127]
  ds_read_b64_tr_b16 a[172:173], v6 offset:768
  v_max3_f32 v10, v10, v99, v100
  v_mfma_f32_16x16x32_bf16 v[116:119], a[204:207], a[108:111], v[116:119]
  ds_read_b64_tr_b16 a[174:175], v6 offset:1792
  v_max3_f32 v10, v10, v101, v102
  v_mfma_f32_16x16x32_bf16 v[120:123], a[204:207], a[124:127], v[120:123]
  v_exp_f32 v51, v51
  v_mfma_f32_16x16x32_bf16 v[124:127], a[204:207], a[140:143], v[124:127]
  v_cvt_pk_bf16_f32 v135, v50, v51
  s_waitcnt lgkmcnt(8)
  v_mfma_f32_16x16x32_bf16 v[152:155], a[144:147], v[128:131], v[152:155]
  v_exp_f32 v40, v40
  v_mfma_f32_16x16x32_bf16 v[164:167], a[148:151], v[128:131], v[164:167]
  ds_read_b64_tr_b16 a[176:177], v4 offset:8192
  v_add_f32 v15, v15, v51
  v_mfma_f32_16x16x32_bf16 v[176:179], a[152:155], v[128:131], v[176:179]
  ds_read_b64_tr_b16 a[178:179], v4 offset:9216
  v_add_f32 v16, v16, v40
  v_mfma_f32_16x16x32_bf16 v[188:191], a[156:159], v[128:131], v[188:191]
  ds_read_b64_tr_b16 a[180:181], v6 offset:8192
  s_waitcnt lgkmcnt(3)
  v_mfma_f32_16x16x32_bf16 v[200:203], a[160:163], v[128:131], v[200:203]
  ds_read_b64_tr_b16 a[182:183], v6 offset:9216
  s_add_u32 s53, s53, 16384
  v_mfma_f32_16x16x32_bf16 v[212:215], a[164:167], v[128:131], v[212:215]
  ds_read_b64_tr_b16 a[184:185], v4 offset:8448
  s_cmp_eq_u32 s53, 147456
  s_cselect_b32 s53, 81920, s53
  v_mfma_f32_16x16x32_bf16 v[224:227], a[168:171], v[128:131], v[224:227]
  ds_read_b64_tr_b16 a[186:187], v4 offset:9472
  v_max3_f32 v10, v10, v103, v104
  v_mfma_f32_16x16x32_bf16 v[236:239], a[172:175], v[128:131], v[236:239]
  ds_read_b64_tr_b16 a[188:189], v6 offset:8448
  v_max3_f32 v10, v10, v105, v106
  v_mfma_f32_16x16x32_bf16 v[156:159], a[144:147], v[132:135], v[156:159]
  ds_read_b64_tr_b16 a[190:191], v6 offset:9472
  v_max3_f32 v10, v10, v107, v108
  v_mfma_f32_16x16x32_bf16 v[168:171], a[148:151], v[132:135], v[168:171]
  ds_read_b64_tr_b16 a[192:193], v4 offset:8704
  v_add_u32 v3, s52, v1
  v_mfma_f32_16x16x32_bf16 v[180:183], a[152:155], v[132:135], v[180:183]
  ds_read_b64_tr_b16 a[194:195], v4 offset:9728
  s_add_u32 s54, s54, 2
  v_mfma_f32_16x16x32_bf16 v[192:195], a[156:159], v[132:135], v[192:195]
  ds_read_b64_tr_b16 a[196:197], v6 offset:8704
  v_max3_f32 v10, v10, v109, v110
  v_mfma_f32_16x16x32_bf16 v[204:207], a[160:163], v[132:135], v[204:207]
  ds_read_b64_tr_b16 a[198:199], v6 offset:9728
  v_max3_f32 v10, v10, v111, v112
  v_mfma_f32_16x16x32_bf16 v[216:219], a[164:167], v[132:135], v[216:219]
  ds_read_b64_tr_b16 a[200:201], v4 offset:8960
  v_max3_f32 v10, v10, v113, v114
  v_mfma_f32_16x16x32_bf16 v[228:231], a[168:171], v[132:135], v[228:231]
  ds_read_b64_tr_b16 a[202:203], v4 offset:9984
  v_max3_f32 v10, v10, v115, v116
  v_mfma_f32_16x16x32_bf16 v[240:243], a[172:175], v[132:135], v[240:243]
  ds_read_b64_tr_b16 a[204:205], v6 offset:8960
  v_max3_f32 v10, v10, v117, v118
  v_exp_f32 v41, v41
  v_exp_f32 v42, v42
  v_exp_f32 v43, v43
  v_cvt_pk_bf16_f32 v136, v40, v41
  v_cvt_pk_bf16_f32 v137, v42, v43
  v_exp_f32 v52, v52
  v_exp_f32 v53, v53
  v_exp_f32 v54, v54
  v_exp_f32 v55, v55
  v_cvt_pk_bf16_f32 v138, v52, v53
  v_cvt_pk_bf16_f32 v139, v54, v55
  s_nop 1
  v_mfma_f32_16x16x32_bf16 v[160:163], a[144:147], v[136:139], v[160:163]
  ds_read_b64_tr_b16 a[206:207], v6 offset:9984
  v_add_f32 v17, v17, v41
  v_mfma_f32_16x16x32_bf16 v[172:175], a[148:151], v[136:139], v[172:175]
  ds_read_b32 v248, v251 offset:20480
  v_add_f32 v16, v16, v42
  v_mfma_f32_16x16x32_bf16 v[184:187], a[152:155], v[136:139], v[184:187]
  v_add_f32 v17, v17, v43
  v_add_f32 v16, v16, v52
  v_mfma_f32_16x16x32_bf16 v[196:199], a[156:159], v[136:139], v[196:199]
  v_exp_f32 v56, v56
  v_mfma_f32_16x16x32_bf16 v[208:211], a[160:163], v[136:139], v[208:211]
  v_exp_f32 v57, v57
  v_mfma_f32_16x16x32_bf16 v[220:223], a[164:167], v[136:139], v[220:223]
  v_exp_f32 v58, v58
  v_mfma_f32_16x16x32_bf16 v[232:235], a[168:171], v[136:139], v[232:235]
  v_add_f32 v17, v17, v53
  v_add_f32 v16, v16, v54
  v_mfma_f32_16x16x32_bf16 v[244:247], a[172:175], v[136:139], v[244:247]
  v_exp_f32 v59, v59
  v_cvt_pk_bf16_f32 v140, v56, v57
  v_cvt_pk_bf16_f32 v141, v58, v59
  v_exp_f32 v68, v68
  v_exp_f32 v69, v69
  v_exp_f32 v70, v70
  v_exp_f32 v71, v71
  v_cvt_pk_bf16_f32 v142, v68, v69
  v_cvt_pk_bf16_f32 v143, v70, v71
  v_add_u32 v4, s53, v8
  v_xor_b32 v6, 32, v4
  s_waitcnt lgkmcnt(0)
  ds_write_b32 v249, v250 offset:0
  v_add_u32 v250, 1, v250
  v_readfirstlane_b32 s56, v248
  s_nop 1
  s_cmp_ge_u32 s56, s54
  s_cbranch_scc0 L_spin_te
L_spun_te:
  v_mfma_f32_16x16x32_bf16 v[152:155], a[176:179], v[140:143], v[152:155]
  v_add_f32 v17, v17, v55
  v_add_f32 v12, v12, v56
  v_mfma_f32_16x16x32_bf16 v[164:167], a[180:183], v[140:143], v[164:167]
  v_add_f32 v13, v13, v57
  v_add_f32 v12, v12, v58
  v_mfma_f32_16x16x32_bf16 v[176:179], a[184:187], v[140:143], v[176:179]
  v_add_f32 v13, v13, v59
  v_add_f32 v12, v12, v68
  v_mfma_f32_16x16x32_bf16 v[188:191], a[188:191], v[140:143], v[188:191]
  v_exp_f32 v60, v60
  v_mfma_f32_16x16x32_bf16 v[200:203], a[192:195], v[140:143], v[200:203]
  ds_read_b128 a[144:147], v3 offset:0
  v_add_f32 v13, v13, v69
  v_mfma_f32_16x16x32_bf16 v[212:215], a[196:199], v[140:143], v[212:215]
  v_exp_f32 v61, v61
  v_mfma_f32_16x16x32_bf16 v[224:227], a[200:203], v[140:143], v[224:227]
  v_exp_f32 v62, v62
  v_mfma_f32_16x16x32_bf16 v[236:239], a[204:207], v[140:143], v[236:239]
  v_add_f32 v12, v12, v70
  v_add_f32 v13, v13, v71
  v_exp_f32 v63, v63
  v_cvt_pk_bf16_f32 v144, v60, v61
  v_cvt_pk_bf16_f32 v145, v62, v63
  v_exp_f32 v72, v72
  v_exp_f32 v73, v73
  v_exp_f32 v74, v74
  v_exp_f32 v75, v75
  v_cvt_pk_bf16_f32 v146, v72, v73
  v_cvt_pk_bf16_f32 v147, v74, v75
  s_nop 1
  v_mfma_f32_16x16x32_bf16 v[156:159], a[176:179], v[144:147], v[156:159]
  v_add_f32 v14, v14, v60
  v_add_f32 v15, v15, v61
  v_mfma_f32_16x16x32_bf16 v[168:171], a[180:183], v[144:147], v[168:171]
  v_add_f32 v14, v14, v62
  v_add_f32 v15, v15, v63
  v_mfma_f32_16x16x32_bf16 v[180:183], a[184:187], v[144:147], v[180:183]
  v_exp_f32 v64, v64
  v_mfma_f32_16x16x32_bf16 v[192:195], a[188:191], v[144:147], v[192:195]
  v_exp_f32 v65, v65
  v_mfma_f32_16x16x32_bf16 v[204:207], a[192:195], v[144:147], v[204:207]
  v_exp_f32 v66, v66
  v_mfma_f32_16x16x32_bf16 v[216:219], a[196:199], v[144:147], v[216:219]
  v_add_f32 v14, v14, v72
  v_add_f32 v15, v15, v73
  v_mfma_f32_16x16x32_bf16 v[228:231], a[200:203], v[144:147], v[228:231]
  v_add_f32 v14, v14, v74
  v_add_f32 v15, v15, v75
  v_mfma_f32_16x16x32_bf16 v[240:243], a[204:207], v[144:147], v[240:243]
  ds_read_b128 a[148:151], v3 offset:256
  v_cvt_pk_bf16_f32 v148, v64, v65
  v_exp_f32 v67, v67
  s_nop 0
  v_cvt_pk_bf16_f32 v149, v66, v67
  v_exp_f32 v76, v76
  v_exp_f32 v77, v77
  v_exp_f32 v78, v78
  v_exp_f32 v79, v79
  v_cvt_pk_bf16_f32 v150, v76, v77
  v_cvt_pk_bf16_f32 v151, v78, v79
  s_nop 1
  v_mfma_f32_16x16x32_bf16 v[160:163], a[176:179], v[148:151], v[160:163]
  ds_read_b128 a[152:155], v3 offset:512
  v_add_f32 v16, v16, v64
  v_mfma_f32_16x16x32_bf16 v[172:175], a[180:183], v[148:151], v[172:175]
  ds_read_b128 a[156:159], v3 offset:768
  v_add_f32 v17, v17, v65
  v_mfma_f32_16x16x32_bf16 v[184:187], a[184:187], v[148:151], v[184:187]
  ds_read_b128 a[160:163], v3 offset:1024
  v_add_f32 v16, v16, v66
  v_mfma_f32_16x16x32_bf16 v[196:199], a[188:191], v[148:151], v[196:199]
  ds_read_b128 a[164:167], v3 offset:1280
  v_add_f32 v17, v17, v67
  v_mfma_f32_16x16x32_bf16 v[208:211], a[192:195], v[148:151], v[208:211]
  ds_read_b128 a[168:171], v3 offset:1536
  v_max3_f32 v10, v10, v119, v120
  v_mfma_f32_16x16x32_bf16 v[220:223], a[196:199], v[148:151], v[220:223]
  ds_read_b128 a[172:175], v3 offset:1792
  v_max3_f32 v10, v10, v121, v122
  v_mfma_f32_16x16x32_bf16 v[232:235], a[200:203], v[148:151], v[232:235]
  v_add_f32 v16, v16, v76
  v_add_f32 v17, v17, v77
  v_mfma_f32_16x16x32_bf16 v[244:247], a[204:207], v[148:151], v[244:247]
  v_add_f32 v16, v16, v78
  v_add_f32 v17, v17, v79
  v_max3_f32 v10, v10, v123, v124
  v_max3_f32 v10, v10, v125, v126
  v_max_f32 v10, v10, v127
  v_cmp_lt_f32 vcc, s57, v10
  s_nop 1
  s_cbranch_vccnz L_stub_te
L_back_te:
  s_waitcnt lgkmcnt(4)
  v_mfma_f32_16x16x32_bf16 v[32:35], a[144:147], a[96:99], v[20:23]
  v_exp_f32 v80, v80
  v_mfma_f32_16x16x32_bf16 v[36:39], a[144:147], a[112:115], v[24:27]
  v_exp_f32 v81, v81
  v_mfma_f32_16x16x32_bf16 v[40:43], a[144:147], a[128:131], v[28:31]
  v_exp_f32 v82, v82
  v_mfma_f32_16x16x32_bf16 v[32:35], a[148:151], a[100:103], v[32:35]
  ds_read_b128 a[176:179], v3 offset:8192
  v_cvt_pk_bf16_f32 v128, v80, v81
  v_mfma_f32_16x16x32_bf16 v[36:39], a[148:151], a[116:119], v[36:39]
  ds_read_b128 a[180:183], v3 offset:8448
  v_add_f32 v12, v12, v80
  v_mfma_f32_16x16x32_bf16 v[40:43], a[148:151], a[132:135], v[40:43]
  ds_read_b128 a[184:187], v3 offset:8704
  v_add_f32 v13, v13, v81
  v_mfma_f32_16x16x32_bf16 v[32:35], a[152:155], a[104:107], v[32:35]
  v_exp_f32 v83, v83
  v_mfma_f32_16x16x32_bf16 v[36:39], a[152:155], a[120:123], v[36:39]
  ds_read_b128 a[188:191], v3 offset:8960
  v_cvt_pk_bf16_f32 v129, v82, v83
  v_mfma_f32_16x16x32_bf16 v[40:43], a[152:155], a[136:139], v[40:43]
  v_exp_f32 v92, v92
  v_mfma_f32_16x16x32_bf16 v[32:35], a[156:159], a[108:111], v[32:35]
  v_exp_f32 v93, v93
  v_mfma_f32_16x16x32_bf16 v[36:39], a[156:159], a[124:127], v[36:39]
  v_exp_f32 v94, v94
  v_mfma_f32_16x16x32_bf16 v[40:43], a[156:159], a[140:143], v[40:43]
  v_add_f32 v12, v12, v82
  s_waitcnt lgkmcnt(4)
  v_mfma_f32_16x16x32_bf16 v[44:47], a[160:163], a[96:99], v[20:23]
  v_add_f32 v13, v13, v83
  v_cvt_pk_bf16_f32 v130, v92, v93
  v_mfma_f32_16x16x32_bf16 v[48:51], a[160:163], a[112:115], v[24:27]
  v_exp_f32 v95, v95
  v_mfma_f32_16x16x32_bf16 v[52:55], a[160:163], a[128:131], v[28:31]
  v_cvt_pk_bf16_f32 v131, v94, v95
  v_add_f32 v12, v12, v92
  v_mfma_f32_16x16x32_bf16 v[44:47], a[164:167], a[100:103], v[44:47]
  v_exp_f32 v84, v84
  v_mfma_f32_16x16x32_bf16 v[48:51], a[164:167], a[116:119], v[48:51]
  v_exp_f32 v85, v85
  v_mfma_f32_16x16x32_bf16 v[52:55], a[164:167], a[132:135], v[52:55]
  v_exp_f32 v86, v86
  v_mfma_f32_16x16x32_bf16 v[44:47], a[168:171], a[104:107], v[44:47]
  v_add_f32 v13, v13, v93
  v_add_f32 v12, v12, v94
  v_mfma_f32_16x16x32_bf16 v[48:51], a[168:171], a[120:123], v[48:51]
  v_add_f32 v13, v13, v95
  v_cvt_pk_bf16_f32 v132, v84, v85
  v_mfma_f32_16x16x32_bf16 v[52:55], a[168:171], a[136:139], v[52:55]
  v_exp_f32 v87, v87
  v_mfma_f32_16x16x32_bf16 v[44:47], a[172:175], a[108:111], v[44:47]
  v_cvt_pk_bf16_f32 v133, v86, v87
  v_add_f32 v14, v14, v84
  v_mfma_f32_16x16x32_bf16 v[48:51], a[172:175], a[124:127], v[48:51]
  v_exp_f32 v96, v96
  v_mfma_f32_16x16x32_bf16 v[52:55], a[172:175], a[140:143], v[52:55]
  v_add_f32 v15, v15, v85
  s_waitcnt lgkmcnt(0)
  v_mfma_f32_16x16x32_bf16 v[56:59], a[176:179], a[96:99], v[20:23]
  v_exp_f32 v97, v97
  v_mfma_f32_16x16x32_bf16 v[60:63], a[176:179], a[112:115], v[24:27]
  v_exp_f32 v98, v98
  v_mfma_f32_16x16x32_bf16 v[64:67], a[176:179], a[128:131], v[28:31]
  ds_read_b128 a[192:195], v3 offset:9216
  v_add_f32 v14, v14, v86
  v_mfma_f32_16x16x32_bf16 v[56:59], a[180:183], a[100:103], v[56:59]
  ds_read_b128 a[196:199], v3 offset:9472
  v_add_f32 v15, v15, v87
  v_mfma_f32_16x16x32_bf16 v[60:63], a[180:183], a[116:119], v[60:63]
  ds_read_b128 a[200:203], v3 offset:9728
  v_cvt_pk_bf16_f32 v134, v96, v97
  v_mfma_f32_16x16x32_bf16 v[64:67], a[180:183], a[132:135], v[64:67]
  ds_read_b128 a[204:207], v3 offset:9984
  v_max3_f32 v10, v32, v33, v34
  v_mfma_f32_16x16x32_bf16 v[56:59], a[184:187], a[104:107], v[56:59]
  ds_read_b64_tr_b16 a[144:145], v4 offset:0
  v_add_f32 v14, v14, v96
  v_mfma_f32_16x16x32_bf16 v[60:63], a[184:187], a[120:123], v[60:63]
  ds_read_b64_tr_b16 a[146:147], v4 offset:1024
  v_add_f32 v15, v15, v97
  v_mfma_f32_16x16x32_bf16 v[64:67], a[184:187], a[136:139], v[64:67]
  ds_read_b64_tr_b16 a[148:149], v6 offset:0
  v_add_f32 v14, v14, v98
  v_mfma_f32_16x16x32_bf16 v[56:59], a[188:191], a[108:111], v[56:59]
  ds_read_b64_tr_b16 a[150:151], v6 offset:1024
  v_max3_f32 v10, v10, v35, v36
  v_mfma_f32_16x16x32_bf16 v[60:63], a[188:191], a[124:127], v[60:63]
  ds_read_b64_tr_b16 a[152:153], v4 offset:256
  v_max3_f32 v10, v10, v37, v38
  v_mfma_f32_16x16x32_bf16 v[64:67], a[188:191], a[140:143], v[64:67]
  ds_read_b64_tr_b16 a[154:155], v4 offset:1280
  s_waitcnt lgkmcnt(6)
  v_mfma_f32_16x16x32_bf16 v[68:71], a[192:195], a[96:99], v[20:23]
  ds_read_b64_tr_b16 a[156:157], v6 offset:256
  s_add_u32 s52, s52, 16384
  v_mfma_f32_16x16x32_bf16 v[72:75], a[192:195], a[112:115], v[24:27]
  ds_read_b64_tr_b16 a[158:159], v6 offset:1280
  v_max3_f32 v10, v10, v39, v40
  v_mfma_f32_16x16x32_bf16 v[76:79], a[192:195], a[128:131], v[28:31]
  ds_read_b64_tr_b16 a[160:161], v4 offset:512
  v_max3_f32 v10, v10, v41, v42
  v_mfma_f32_16x16x32_bf16 v[68:71], a[196:199], a[100:103], v[68:71]
  ds_read_b64_tr_b16 a[162:163], v4 offset:1536
  v_max3_f32 v10, v10, v43, v44
  v_mfma_f32_16x16x32_bf16 v[72:75], a[196:199], a[116:119], v[72:75]
  ds_read_b64_tr_b16 a[164:165], v6 offset:512
  v_max3_f32 v10, v10, v45, v46
  v_mfma_f32_16x16x32_bf16 v[76:79], a[196:199], a[132:135], v[76:79]
  ds_read_b64_tr_b16 a[166:167], v6 offset:1536
  v_max3_f32 v10, v10, v47, v48
  v_mfma_f32_16x16x32_bf16 v[68:71], a[200:203], a[104:107], v[68:71]
  ds_read_b64_tr_b16 a[168:169], v4 offset:768
  s_cmp_eq_u32 s52, 81920
  s_cselect_b32 s52, 0, s52
  v_mfma_f32_16x16x32_bf16 v[72:75], a[200:203], a[120:123], v[72:75]
  ds_read_b64_tr_b16 a[170:171], v4 offset:1792
  v_max3_f32 v10, v10, v49, v50
  v_mfma_f32_16x16x32_bf16 v[76:79], a[200:203], a[136:139], v[76:79]
  ds_read_b64_tr_b16 a[172:173], v6 offset:768
  v_max3_f32 v10, v10, v51, v52
  v_mfma_f32_16x16x32_bf16 v[68:71], a[204:207], a[108:111], v[68:71]
  ds_read_b64_tr_b16 a[174:175], v6 offset:1792
  v_max3_f32 v10, v10, v53, v54
  v_mfma_f32_16x16x32_bf16 v[72:75], a[204:207], a[124:127], v[72:75]
  v_exp_f32 v99, v99
  v_mfma_f32_16x16x32_bf16 v[76:79], a[204:207], a[140:143], v[76:79]
  v_cvt_pk_bf16_f32 v135, v98, v99
  s_waitcnt lgkmcnt(8)
  v_mfma_f32_16x16x32_bf16 v[152:155], a[144:147], v[128:131], v[152:155]
  v_exp_f32 v88, v88
  v_mfma_f32_16x16x32_bf16 v[164:167], a[148:151], v[128:131], v[164:167]
  ds_read_b64_tr_b16 a[176:177], v4 offset:8192
  v_add_f32 v15, v15, v99
  v_mfma_f32_16x16x32_bf16 v[176:179], a[152:155], v[128:131], v[176:179]
  ds_read_b64_tr_b16 a[178:179], v4 offset:9216
  v_add_f32 v16, v16, v88
  v_mfma_f32_16x16x32_bf16 v[188:191], a[156:159], v[128:131], v[188:191]
  ds_read_b64_tr_b16 a[180:181], v6 offset:8192
  s_waitcnt lgkmcnt(3)
  v_mfma_f32_16x16x32_bf16 v[200:203], a[160:163], v[128:131], v[200:203]
  ds_read_b64_tr_b16 a[182:183], v6 offset:9216
  s_add_u32 s53, s53, 16384
  v_mfma_f32_16x16x32_bf16 v[212:215], a[164:167], v[128:131], v[212:215]
  ds_read_b64_tr_b16 a[184:185], v4 offset:8448
  s_cmp_eq_u32 s53, 147456
  s_cselect_b32 s53, 81920, s53
  v_mfma_f32_16x16x32_bf16 v[224:227], a[168:171], v[128:131], v[224:227]
  ds_read_b64_tr_b16 a[186:187], v4 offset:9472
  v_max3_f32 v10, v10, v55, v56
  v_mfma_f32_16x16x32_bf16 v[236:239], a[172:175], v[128:131], v[236:239]
  ds_read_b64_tr_b16 a[188:189], v6 offset:8448
  v_max3_f32 v10, v10, v57, v58
  v_mfma_f32_16x16x32_bf16 v[156:159], a[144:147], v[132:135], v[156:159]
  ds_read_b64_tr_b16 a[190:191], v6 offset:9472
  v_max3_f32 v10, v10, v59, v60
  v_mfma_f32_16x16x32_bf16 v[168:171], a[148:151], v[132:135], v[168:171]
  ds_read_b64_tr_b16 a[192:193], v4 offset:8704
  v_add_u32 v3, s52, v1
  v_mfma_f32_16x16x32_bf16 v[180:183], a[152:155], v[132:135], v[180:183]
  ds_read_b64_tr_b16 a[194:195], v4 offset:9728
  s_add_u32 s54, s54, 2
  v_mfma_f32_16x16x32_bf16 v[192:195], a[156:159], v[132:135], v[192:195]
  ds_read_b64_tr_b16 a[196:197], v6 offset:8704
  v_max3_f32 v10, v10, v61, v62
  v_mfma_f32_16x16x32_bf16 v[204:207], a[160:163], v[132:135], v[204:207]
  ds_read_b64_tr_b16 a[198:199], v6 offset:9728
  v_max3_f32 v10, v10, v63, v64
  v_mfma_f32_16x16x32_bf16 v[216:219], a[164:167], v[132:135], v[216:219]
  ds_read_b64_tr_b16 a[200:201], v4 offset:8960
  v_max3_f32 v10, v10, v65, v66
  v_mfma_f32_16x16x32_bf16 v[228:231], a[168:171], v[132:135], v[228:231]
  ds_read_b64_tr_b16 a[202:203], v4 offset:9984
  v_max3_f32 v10, v10, v67, v68
  v_mfma_f32_16x16x32_bf16 v[240:243], a[172:175], v[132:135], v[240:243]
  ds_read_b64_tr_b16 a[204:205], v6 offset:8960
  v_max3_f32 v10, v10, v69, v70
  v_exp_f32 v89, v89
  v_exp_f32 v90, v90
  v_exp_f32 v91, v91
  v_cvt_pk_bf16_f32 v136, v88, v89
  v_cvt_pk_bf16_f32 v137, v90, v91
  v_exp_f32 v100, v100
  v_exp_f32 v101, v101
  v_exp_f32 v102, v102
  v_exp_f32 v103, v103
  v_cvt_pk_bf16_f32 v138, v100, v101
  v_cvt_pk_bf16_f32 v139, v102, v103
  s_nop 1
  v_mfma_f32_16x16x32_bf16 v[160:163], a[144:147], v[136:139], v[160:163]
  ds_read_b64_tr_b16 a[206:207], v6 offset:9984
  v_add_f32 v17, v17, v89
  v_mfma_f32_16x16x32_bf16 v[172:175], a[148:151], v[136:139], v[172:175]
  ds_read_b32 v248, v251 offset:20480
  v_add_f32 v16, v16, v90
  v_mfma_f32_16x16x32_bf16 v[184:187], a[152:155], v[136:139], v[184:187]
  v_add_f32 v17, v17, v91
  v_add_f32 v16, v16, v100
  v_mfma_f32_16x16x32_bf16 v[196:199], a[156:159], v[136:139], v[196:199]
  v_exp_f32 v104, v104
  v_mfma_f32_16x16x32_bf16 v[208:211], a[160:163], v[136:139], v[208:211]
  v_exp_f32 v105, v105
  v_mfma_f32_16x16x32_bf16 v[220:223], a[164:167], v[136:139], v[220:223]
  v_exp_f32 v106, v106
  v_mfma_f32_16x16x32_bf16 v[232:235], a[168:171], v[136:139], v[232:235]
  v_add_f32 v17, v17, v101
  v_add_f32 v16, v16, v102
  v_mfma_f32_16x16x32_bf16 v[244:247], a[172:175], v[136:139], v[244:247]
  v_exp_f32 v107, v107
  v_cvt_pk_bf16_f32 v140, v104, v105
  v_cvt_pk_bf16_f32 v141, v106, v107
  v_exp_f32 v116, v116
  v_exp_f32 v117, v117
  v_exp_f32 v118, v118
  v_exp_f32 v119, v119
  v_cvt_pk_bf16_f32 v142, v116, v117
  v_cvt_pk_bf16_f32 v143, v118, v119
  v_add_u32 v4, s53, v8
  v_xor_b32 v6, 32, v4
  s_waitcnt lgkmcnt(0)
  ds_write_b32 v249, v250 offset:0
  v_add_u32 v250, 1, v250
  v_readfirstlane_b32 s56, v248
  s_nop 1
  s_cmp_ge_u32 s56, s54
  s_cbranch_scc0 L_spin_to
L_spun_to:
  v_mfma_f32_16x16x32_bf16 v[152:155], a[176:179], v[140:143], v[152:155]
  v_add_f32 v17, v17, v103
  v_add_f32 v12, v12, v104
  v_mfma_f32_16x16x32_bf16 v[164:167], a[180:183], v[140:143], v[164:167]
  v_add_f32 v13, v13, v105
  v_add_f32 v12, v12, v106
  v_mfma_f32_16x16x32_bf16 v[176:179], a[184:187], v[140:143], v[176:179]
  v_add_f32 v13, v13, v107
  v_add_f32 v12, v12, v116
  v_mfma_f32_16x16x32_bf16 v[188:191], a[188:191], v[140:143], v[188:191]
  v_exp_f32 v108, v108
  v_mfma_f32_16x16x32_bf16 v[200:203], a[192:195], v[140:143], v[200:203]
  ds_read_b128 a[144:147], v3 offset:0
  v_add_f32 v13, v13, v117
  v_mfma_f32_16x16x32_bf16 v[212:215], a[196:199], v[140:143], v[212:215]
  v_exp_f32 v109, v109
  v_mfma_f32_16x16x32_bf16 v[224:227], a[200:203], v[140:143], v[224:227]
  v_exp_f32 v110, v110
  v_mfma_f32_16x16x32_bf16 v[236:239], a[204:207], v[140:143], v[236:239]
  v_add_f32 v12, v12, v118
  v_add_f32 v13, v13, v119
  v_exp_f32 v111, v111
  v_cvt_pk_bf16_f32 v144, v108, v109
  v_cvt_pk_bf16_f32 v145, v110, v111
  v_exp_f32 v120, v120
  v_exp_f32 v121, v121
  v_exp_f32 v122, v122
  v_exp_f32 v123, v123
  v_cvt_pk_bf16_f32 v146, v120, v121
  v_cvt_pk_bf16_f32 v147, v122, v123
  s_nop 1
  v_mfma_f32_16x16x32_bf16 v[156:159], a[176:179], v[144:147], v[156:159]
  v_add_f32 v14, v14, v108
  v_add_f32 v15, v15, v109
  v_mfma_f32_16x16x32_bf16 v[168:171], a[180:183], v[144:147], v[168:171]
  v_add_f32 v14, v14, v110
  v_add_f32 v15, v15, v111
  v_mfma_f32_16x16x32_bf16 v[180:183], a[184:187], v[144:147], v[180:183]
  v_exp_f32 v112, v112
  v_mfma_f32_16x16x32_bf16 v[192:195], a[188:191], v[144:147], v[192:195]
  v_exp_f32 v113, v113
  v_mfma_f32_16x16x32_bf16 v[204:207], a[192:195], v[144:147], v[204:207]
  v_exp_f32 v114, v114
  v_mfma_f32_16x16x32_bf16 v[216:219], a[196:199], v[144:147], v[216:219]
  v_add_f32 v14, v14, v120
  v_add_f32 v15, v15, v121
  v_mfma_f32_16x16x32_bf16 v[228:231], a[200:203], v[144:147], v[228:231]
  v_add_f32 v14, v14, v122
  v_add_f32 v15, v15, v123
  v_mfma_f32_16x16x32_bf16 v[240:243], a[204:207], v[144:147], v[240:243]
  ds_read_b128 a[148:151], v3 offset:256
  v_cvt_pk_bf16_f32 v148, v112, v113
  v_exp_f32 v115, v115
  s_nop 0
  v_cvt_pk_bf16_f32 v149, v114, v115
  v_exp_f32 v124, v124
  v_exp_f32 v125, v125
  v_exp_f32 v126, v126
  v_exp_f32 v127, v127
  v_cvt_pk_bf16_f32 v150, v124, v125
  v_cvt_pk_bf16_f32 v151, v126, v127
  s_nop 1
  v_mfma_f32_16x16x32_bf16 v[160:163], a[176:179], v[148:151], v[160:163]
  ds_read_b128 a[152:155], v3 offset:512
  v_add_f32 v16, v16, v112
  v_mfma_f32_16x16x32_bf16 v[172:175], a[180:183], v[148:151], v[172:175]
  ds_read_b128 a[156:159], v3 offset:768
  v_add_f32 v17, v17, v113
  v_mfma_f32_16x16x32_bf16 v[184:187], a[184:187], v[148:151], v[184:187]
  ds_read_b128 a[160:163], v3 offset:1024
  v_add_f32 v16, v16, v114
  v_mfma_f32_16x16x32_bf16 v[196:199], a[188:191], v[148:151], v[196:199]
  ds_read_b128 a[164:167], v3 offset:1280
  v_add_f32 v17, v17, v115
  v_mfma_f32_16x16x32_bf16 v[208:211], a[192:195], v[148:151], v[208:211]
  ds_read_b128 a[168:171], v3 offset:1536
  v_max3_f32 v10, v10, v71, v72
  v_mfma_f32_16x16x32_bf16 v[220:223], a[196:199], v[148:151], v[220:223]
  ds_read_b128 a[172:175], v3 offset:1792
  v_max3_f32 v10, v10, v73, v74
  v_mfma_f32_16x16x32_bf16 v[232:235], a[200:203], v[148:151], v[232:235]
  v_add_f32 v16, v16, v124
  v_add_f32 v17, v17, v125
  v_mfma_f32_16x16x32_bf16 v[244:247], a[204:207], v[148:151], v[244:247]
  v_add_f32 v16, v16, v126
  v_add_f32 v17, v17, v127
  v_max3_f32 v10, v10, v75, v76
  v_max3_f32 v10, v10, v77, v78
  v_max_f32 v10, v10, v79
  v_cmp_lt_f32 vcc, s57, v10
  s_nop 1
  s_cbranch_vccnz L_stub_to
L_back_to:
  s_add_u32 s55, s55, 1
  s_add_u32 s100, s100, 1
  s_cmp_eq_u32 s100, 5
  s_cbranch_scc1 L_qconv2
  s_cmp_eq_u32 s100, 9
  s_cbranch_scc1 L_str1_0
  s_cmp_eq_u32 s100, 10
  s_cbranch_scc1 L_str1_1
  s_cmp_eq_u32 s100, 14
  s_cbranch_scc1 L_dosig0
L_qconv2_back:
L_str1_back:
  s_cmp_lt_u32 s55, 7
  s_cbranch_scc1 L_loop
  s_mov_b64 exec, 1
  buffer_load_dwordx4 v[252:255], v9, s[40:43], s10 offen offset:0 sc1
  s_mov_b64 exec, -1
  v_add_u32 v5, 32768, v2
  v_xor_b32 v11, 8, v5
  v_add_u32 v7, 131072, v9
  v_add_u32 v19, 262144, v9
  s_waitcnt lgkmcnt(4)
  v_mfma_f32_16x16x32_bf16 v[80:83], a[144:147], a[96:99], v[20:23]
  ds_read_b128 a[176:179], v3 offset:8192
  s_mul_i32 s54, s101, 33
  s_add_u32 s54, s54, 56
  v_mfma_f32_16x16x32_bf16 v[84:87], a[144:147], a[112:115], v[24:27]
  v_exp_f32 v32, v32
  v_mfma_f32_16x16x32_bf16 v[88:91], a[144:147], a[128:131], v[28:31]
  ds_read_b128 a[180:183], v3 offset:8448
  v_add_f32 v12, v12, v32
  v_mfma_f32_16x16x32_bf16 v[80:83], a[148:151], a[100:103], v[80:83]
  v_exp_f32 v33, v33
  v_mfma_f32_16x16x32_bf16 v[84:87], a[148:151], a[116:119], v[84:87]
  v_exp_f32 v34, v34
  v_mfma_f32_16x16x32_bf16 v[88:91], a[148:151], a[132:135], v[88:91]
  v_exp_f32 v35, v35
  v_mfma_f32_16x16x32_bf16 v[80:83], a[152:155], a[104:107], v[80:83]
  v_cvt_pk_bf16_f32 v128, v32, v33
  v_cvt_pk_bf16_f32 v129, v34, v35
  v_mfma_f32_16x16x32_bf16 v[84:87], a[152:155], a[120:123], v[84:87]
  v_exp_f32 v44, v44
  v_mfma_f32_16x16x32_bf16 v[88:91], a[152:155], a[136:139], v[88:91]
  v_exp_f32 v45, v45
  v_mfma_f32_16x16x32_bf16 v[80:83], a[156:159], a[108:111], v[80:83]
  v_exp_f32 v46, v46
  v_mfma_f32_16x16x32_bf16 v[84:87], a[156:159], a[124:127], v[84:87]
  v_add_f32 v13, v13, v33
  v_add_f32 v12, v12, v34
  v_mfma_f32_16x16x32_bf16 v[88:91], a[156:159], a[140:143], v[88:91]
  v_add_f32 v13, v13, v35
  s_waitcnt lgkmcnt(2)
  v_mfma_f32_16x16x32_bf16 v[92:95], a[160:163], a[96:99], v[20:23]
  v_exp_f32 v47, v47
  v_mfma_f32_16x16x32_bf16 v[96:99], a[160:163], a[112:115], v[24:27]
  v_cvt_pk_bf16_f32 v130, v44, v45
  v_cvt_pk_bf16_f32 v131, v46, v47
  v_mfma_f32_16x16x32_bf16 v[100:103], a[160:163], a[128:131], v[28:31]
  ds_read_b128 a[184:187], v3 offset:8704
  v_add_f32 v12, v12, v44
  v_mfma_f32_16x16x32_bf16 v[92:95], a[164:167], a[100:103], v[92:95]
  ds_read_b128 a[188:191], v3 offset:8960
  v_add_f32 v13, v13, v45
  v_mfma_f32_16x16x32_bf16 v[96:99], a[164:167], a[116:119], v[96:99]
  v_exp_f32 v36, v36
  v_mfma_f32_16x16x32_bf16 v[100:103], a[164:167], a[132:135], v[100:103]
  v_exp_f32 v37, v37
  v_mfma_f32_16x16x32_bf16 v[92:95], a[168:171], a[104:107], v[92:95]
  v_exp_f32 v38, v38
  v_mfma_f32_16x16x32_bf16 v[96:99], a[168:171], a[120:123], v[96:99]
  v_add_f32 v12, v12, v46
  v_add_f32 v13, v13, v47
  v_mfma_f32_16x16x32_bf16 v[100:103], a[168:171], a[136:139], v[100:103]
  v_exp_f32 v39, v39
  v_mfma_f32_16x16x32_bf16 v[92:95], a[172:175], a[108:111], v[92:95]
  v_cvt_pk_bf16_f32 v132, v36, v37
  v_cvt_pk_bf16_f32 v133, v38, v39
  v_mfma_f32_16x16x32_bf16 v[96:99], a[172:175], a[124:127], v[96:99]
  v_exp_f32 v48, v48
  v_mfma_f32_16x16x32_bf16 v[100:103], a[172:175], a[140:143], v[100:103]
  v_add_f32 v14, v14, v36
  s_waitcnt lgkmcnt(0)
  v_mfma_f32_16x16x32_bf16 v[104:107], a[176:179], a[96:99], v[20:23]
  ds_read_b128 a[192:195], v3 offset:9216
  v_add_f32 v15, v15, v37
  v_mfma_f32_16x16x32_bf16 v[108:111], a[176:179], a[112:115], v[24:27]
  ds_read_b128 a[196:199], v3 offset:9472
  v_add_f32 v14, v14, v38
  v_mfma_f32_16x16x32_bf16 v[112:115], a[176:179], a[128:131], v[28:31]
  ds_read_b128 a[200:203], v3 offset:9728
  v_add_f32 v15, v15, v39
  v_mfma_f32_16x16x32_bf16 v[104:107], a[180:183], a[100:103], v[104:107]
  ds_read_b128 a[204:207], v3 offset:9984
  v_max3_f32 v10, v80, v81, v82
  v_mfma_f32_16x16x32_bf16 v[108:111], a[180:183], a[116:119], v[108:111]
  ds_read_b64_tr_b16 a[144:145], v4 offset:0
  v_add_f32 v14, v14, v48
  v_mfma_f32_16x16x32_bf16 v[112:115], a[180:183], a[132:135], v[112:115]
  ds_read_b64_tr_b16 a[146:147], v4 offset:1024
  v_max3_f32 v10, v10, v83, v84
  v_mfma_f32_16x16x32_bf16 v[104:107], a[184:187], a[104:107], v[104:107]
  ds_read_b64_tr_b16 a[148:149], v6 offset:0
  v_max3_f32 v10, v10, v85, v86
  v_mfma_f32_16x16x32_bf16 v[108:111], a[184:187], a[120:123], v[108:111]
  ds_read_b64_tr_b16 a[150:151], v6 offset:1024
  s_add_u32 s52, s52, 16384
  v_mfma_f32_16x16x32_bf16 v[112:115], a[184:187], a[136:139], v[112:115]
  ds_read_b64_tr_b16 a[152:153], v4 offset:256
  v_max3_f32 v10, v10, v87, v88
  v_mfma_f32_16x16x32_bf16 v[104:107], a[188:191], a[108:111], v[104:107]
  ds_read_b64_tr_b16 a[154:155], v4 offset:1280
  v_max3_f32 v10, v10, v89, v90
  v_mfma_f32_16x16x32_bf16 v[108:111], a[188:191], a[124:127], v[108:111]
  ds_read_b64_tr_b16 a[156:157], v6 offset:256
  v_max3_f32 v10, v10, v91, v92
  v_mfma_f32_16x16x32_bf16 v[112:115], a[188:191], a[140:143], v[112:115]
  ds_read_b64_tr_b16 a[158:159], v6 offset:1280
  s_waitcnt lgkmcnt(8)
  v_mfma_f32_16x16x32_bf16 v[116:119], a[192:195], a[96:99], v[20:23]
  ds_read_b64_tr_b16 a[160:161], v4 offset:512
  v_max3_f32 v10, v10, v93, v94
  v_mfma_f32_16x16x32_bf16 v[120:123], a[192:195], a[112:115], v[24:27]
  ds_read_b64_tr_b16 a[162:163], v4 offset:1536
  v_max3_f32 v10, v10, v95, v96
  v_mfma_f32_16x16x32_bf16 v[124:127], a[192:195], a[128:131], v[28:31]
  ds_read_b64_tr_b16 a[164:165], v6 offset:512
  s_cmp_eq_u32 s52, 81920
  s_cselect_b32 s52, 0, s52
  v_mfma_f32_16x16x32_bf16 v[116:119], a[196:199], a[100:103], v[116:119]
  ds_read_b64_tr_b16 a[166:167], v6 offset:1536
  v_max3_f32 v10, v10, v97, v98
  v_mfma_f32_16x16x32_bf16 v[120:123], a[196:199], a[116:119], v[120:123]
  ds_read_b64_tr_b16 a[168:169], v4 offset:768
  v_max3_f32 v10, v10, v99, v100
  v_mfma_f32_16x16x32_bf16 v[124:127], a[196:199], a[132:135], v[124:127]
  ds_read_b64_tr_b16 a[170:171], v4 offset:1792
  v_max3_f32 v10, v10, v101, v102
  v_mfma_f32_16x16x32_bf16 v[116:119], a[200:203], a[104:107], v[116:119]
  ds_read_b64_tr_b16 a[172:173], v6 offset:768
  v_max3_f32 v10, v10, v103, v104
  v_mfma_f32_16x16x32_bf16 v[120:123], a[200:203], a[120:123], v[120:123]
  ds_read_b64_tr_b16 a[174:175], v6 offset:1792
  v_max3_f32 v10, v10, v105, v106
  v_mfma_f32_16x16x32_bf16 v[124:127], a[200:203], a[136:139], v[124:127]
  ds_read_b64_tr_b16 a[176:177], v4 offset:8192
  v_max3_f32 v10, v10, v107, v108
  v_mfma_f32_16x16x32_bf16 v[116:119], a[204:207], a[108:111], v[116:119]
  ds_read_b64_tr_b16 a[178:179], v4 offset:9216
  v_add_u32 v3, s52, v1
  v_mfma_f32_16x16x32_bf16 v[120:123], a[204:207], a[124:127], v[120:123]
  ds_read_b64_tr_b16 a[180:181], v6 offset:8192
  v_max3_f32 v10, v10, v109, v110
  v_mfma_f32_16x16x32_bf16 v[124:127], a[204:207], a[140:143], v[124:127]
  ds_read_b64_tr_b16 a[182:183], v6 offset:9216
  s_waitcnt lgkmcnt(12)
  v_mfma_f32_16x16x32_bf16 v[152:155], a[144:147], v[128:131], v[152:155]
  ds_read_b64_tr_b16 a[184:185], v4 offset:8448
  s_add_u32 s53, s53, 16384
  v_mfma_f32_16x16x32_bf16 v[164:167], a[148:151], v[128:131], v[164:167]
  ds_read_b64_tr_b16 a[186:187], v4 offset:9472
  s_cmp_eq_u32 s53, 147456
  s_cselect_b32 s53, 81920, s53
  v_mfma_f32_16x16x32_bf16 v[176:179], a[152:155], v[128:131], v[176:179]
  ds_read_b64_tr_b16 a[188:189], v6 offset:8448
  v_max3_f32 v10, v10, v111, v112
  v_mfma_f32_16x16x32_bf16 v[188:191], a[156:159], v[128:131], v[188:191]
  ds_read_b64_tr_b16 a[190:191], v6 offset:9472
  s_waitcnt lgkmcnt(8)
  v_mfma_f32_16x16x32_bf16 v[200:203], a[160:163], v[128:131], v[200:203]
  v_exp_f32 v49, v49
  v_mfma_f32_16x16x32_bf16 v[212:215], a[164:167], v[128:131], v[212:215]
  v_exp_f32 v50, v50
  v_mfma_f32_16x16x32_bf16 v[224:227], a[168:171], v[128:131], v[224:227]
  v_exp_f32 v51, v51
  v_mfma_f32_16x16x32_bf16 v[236:239], a[172:175], v[128:131], v[236:239]
  v_cvt_pk_bf16_f32 v134, v48, v49
  v_cvt_pk_bf16_f32 v135, v50, v51
  s_nop 1
  v_mfma_f32_16x16x32_bf16 v[156:159], a[144:147], v[132:135], v[156:159]
  ds_read_b64_tr_b16 a[192:193], v4 offset:8704
  v_add_f32 v15, v15, v49
  v_mfma_f32_16x16x32_bf16 v[168:171], a[148:151], v[132:135], v[168:171]
  ds_read_b64_tr_b16 a[194:195], v4 offset:9728
  v_add_f32 v14, v14, v50
  v_mfma_f32_16x16x32_bf16 v[180:183], a[152:155], v[132:135], v[180:183]
  ds_read_b64_tr_b16 a[196:197], v6 offset:8704
  v_add_f32 v15, v15, v51
  v_mfma_f32_16x16x32_bf16 v[192:195], a[156:159], v[132:135], v[192:195]
  ds_read_b64_tr_b16 a[198:199], v6 offset:9728
  v_max3_f32 v10, v10, v113, v114
  v_mfma_f32_16x16x32_bf16 v[204:207], a[160:163], v[132:135], v[204:207]
  ds_read_b64_tr_b16 a[200:201], v4 offset:8960
  v_max3_f32 v10, v10, v115, v116
  v_mfma_f32_16x16x32_bf16 v[216:219], a[164:167], v[132:135], v[216:219]
  ds_read_b64_tr_b16 a[202:203], v4 offset:9984
  v_max3_f32 v10, v10, v117, v118
  v_mfma_f32_16x16x32_bf16 v[228:231], a[168:171], v[132:135], v[228:231]
  ds_read_b64_tr_b16 a[204:205], v6 offset:8960
  v_max3_f32 v10, v10, v119, v120
  v_mfma_f32_16x16x32_bf16 v[240:243], a[172:175], v[132:135], v[240:243]
  ds_read_b64_tr_b16 a[206:207], v6 offset:9984
  v_max3_f32 v10, v10, v121, v122
  v_exp_f32 v40, v40
  v_exp_f32 v41, v41
  v_exp_f32 v42, v42
  v_exp_f32 v43, v43
  v_cvt_pk_bf16_f32 v136, v40, v41
  v_cvt_pk_bf16_f32 v137, v42, v43
  v_exp_f32 v52, v52
  v_exp_f32 v53, v53
  v_exp_f32 v54, v54
  v_exp_f32 v55, v55
  v_cvt_pk_bf16_f32 v138, v52, v53
  v_cvt_pk_bf16_f32 v139, v54, v55
  s_nop 1
  v_mfma_f32_16x16x32_bf16 v[160:163], a[144:147], v[136:139], v[160:163]
  ds_read_b32 v248, v251 offset:20480
  v_add_f32 v16, v16, v40
  v_mfma_f32_16x16x32_bf16 v[172:175], a[148:151], v[136:139], v[172:175]
  v_add_f32 v17, v17, v41
  v_add_f32 v16, v16, v42
  v_mfma_f32_16x16x32_bf16 v[184:187], a[152:155], v[136:139], v[184:187]
  v_add_f32 v17, v17, v43
  v_add_f32 v16, v16, v52
  v_mfma_f32_16x16x32_bf16 v[196:199], a[156:159], v[136:139], v[196:199]
  v_exp_f32 v56, v56
  v_mfma_f32_16x16x32_bf16 v[208:211], a[160:163], v[136:139], v[208:211]
  v_exp_f32 v57, v57
  v_mfma_f32_16x16x32_bf16 v[220:223], a[164:167], v[136:139], v[220:223]
  v_exp_f32 v58, v58
  v_mfma_f32_16x16x32_bf16 v[232:235], a[168:171], v[136:139], v[232:235]
  v_add_f32 v17, v17, v53
  v_add_f32 v16, v16, v54
  v_mfma_f32_16x16x32_bf16 v[244:247], a[172:175], v[136:139], v[244:247]
  v_exp_f32 v59, v59
  v_cvt_pk_bf16_f32 v140, v56, v57
  v_cvt_pk_bf16_f32 v141, v58, v59
  v_exp_f32 v68, v68
  v_exp_f32 v69, v69
  v_exp_f32 v70, v70
  v_exp_f32 v71, v71
  v_cvt_pk_bf16_f32 v142, v68, v69
  v_cvt_pk_bf16_f32 v143, v70, v71
  v_add_u32 v4, s53, v8
  v_xor_b32 v6, 32, v4
  s_waitcnt lgkmcnt(0)
  ds_write_b32 v249, v250 offset:0
  v_add_u32 v250, 1, v250
  v_readfirstlane_b32 s56, v248
  s_nop 1
  s_cmp_ge_u32 s56, s54
  s_cbranch_scc0 L_spin_tx
L_spun_tx:
  v_mfma_f32_16x16x32_bf16 v[152:155], a[176:179], v[140:143], v[152:155]
  ds_read_b64_tr_b16 a[144:145], v4 offset:0
  v_add_f32 v17, v17, v55
  v_mfma_f32_16x16x32_bf16 v[164:167], a[180:183], v[140:143], v[164:167]
  v_add_f32 v12, v12, v56
  v_add_f32 v13, v13, v57
  v_mfma_f32_16x16x32_bf16 v[176:179], a[184:187], v[140:143], v[176:179]
  v_add_f32 v12, v12, v58
  v_add_f32 v13, v13, v59
  v_mfma_f32_16x16x32_bf16 v[188:191], a[188:191], v[140:143], v[188:191]
  v_exp_f32 v60, v60
  v_mfma_f32_16x16x32_bf16 v[200:203], a[192:195], v[140:143], v[200:203]
  v_exp_f32 v61, v61
  v_mfma_f32_16x16x32_bf16 v[212:215], a[196:199], v[140:143], v[212:215]
  v_exp_f32 v62, v62
  v_mfma_f32_16x16x32_bf16 v[224:227], a[200:203], v[140:143], v[224:227]
  ds_read_b64_tr_b16 a[146:147], v4 offset:1024
  v_add_f32 v12, v12, v68
  v_mfma_f32_16x16x32_bf16 v[236:239], a[204:207], v[140:143], v[236:239]
  ds_read_b64_tr_b16 a[148:149], v6 offset:0
  v_add_f32 v13, v13, v69
  v_exp_f32 v63, v63
  v_cvt_pk_bf16_f32 v144, v60, v61
  v_cvt_pk_bf16_f32 v145, v62, v63
  v_exp_f32 v72, v72
  v_exp_f32 v73, v73
  v_exp_f32 v74, v74
  v_exp_f32 v75, v75
  v_cvt_pk_bf16_f32 v146, v72, v73
  v_cvt_pk_bf16_f32 v147, v74, v75
  s_nop 1
  v_mfma_f32_16x16x32_bf16 v[156:159], a[176:179], v[144:147], v[156:159]
  ds_read_b64_tr_b16 a[150:151], v6 offset:1024
  v_add_f32 v12, v12, v70
  v_mfma_f32_16x16x32_bf16 v[168:171], a[180:183], v[144:147], v[168:171]
  ds_read_b64_tr_b16 a[152:153], v4 offset:256
  v_add_f32 v13, v13, v71
  v_mfma_f32_16x16x32_bf16 v[180:183], a[184:187], v[144:147], v[180:183]
  ds_read_b64_tr_b16 a[154:155], v4 offset:1280
  v_add_f32 v14, v14, v60
  v_mfma_f32_16x16x32_bf16 v[192:195], a[188:191], v[144:147], v[192:195]
  v_add_f32 v15, v15, v61
  v_add_f32 v14, v14, v62
  v_mfma_f32_16x16x32_bf16 v[204:207], a[192:195], v[144:147], v[204:207]
  v_add_f32 v15, v15, v63
  v_add_f32 v14, v14, v72
  v_mfma_f32_16x16x32_bf16 v[216:219], a[196:199], v[144:147], v[216:219]
  ds_read_b64_tr_b16 a[156:157], v6 offset:256
  v_add_f32 v15, v15, v73
  v_mfma_f32_16x16x32_bf16 v[228:231], a[200:203], v[144:147], v[228:231]
  ds_read_b64_tr_b16 a[158:159], v6 offset:1280
  v_add_f32 v14, v14, v74
  v_mfma_f32_16x16x32_bf16 v[240:243], a[204:207], v[144:147], v[240:243]
  ds_read_b64_tr_b16 a[160:161], v4 offset:512
  v_add_f32 v15, v15, v75
  v_exp_f32 v64, v64
  v_exp_f32 v65, v65
  v_exp_f32 v66, v66
  v_exp_f32 v67, v67
  v_cvt_pk_bf16_f32 v148, v64, v65
  v_cvt_pk_bf16_f32 v149, v66, v67
  v_exp_f32 v76, v76
  v_exp_f32 v77, v77
  v_exp_f32 v78, v78
  v_exp_f32 v79, v79
  v_cvt_pk_bf16_f32 v150, v76, v77
  v_cvt_pk_bf16_f32 v151, v78, v79
  s_nop 1
  v_mfma_f32_16x16x32_bf16 v[160:163], a[176:179], v[148:151], v[160:163]
  ds_read_b64_tr_b16 a[162:163], v4 offset:1536
  v_add_f32 v16, v16, v64
  v_mfma_f32_16x16x32_bf16 v[172:175], a[180:183], v[148:151], v[172:175]
  ds_read_b64_tr_b16 a[164:165], v6 offset:512
  v_add_f32 v17, v17, v65
  v_mfma_f32_16x16x32_bf16 v[184:187], a[184:187], v[148:151], v[184:187]
  ds_read_b64_tr_b16 a[166:167], v6 offset:1536
  v_add_f32 v16, v16, v66
  v_mfma_f32_16x16x32_bf16 v[196:199], a[188:191], v[148:151], v[196:199]
  ds_read_b64_tr_b16 a[168:169], v4 offset:768
  v_add_f32 v17, v17, v67
  v_mfma_f32_16x16x32_bf16 v[208:211], a[192:195], v[148:151], v[208:211]
  ds_read_b64_tr_b16 a[170:171], v4 offset:1792
  v_add_f32 v16, v16, v76
  v_mfma_f32_16x16x32_bf16 v[220:223], a[196:199], v[148:151], v[220:223]
  ds_read_b64_tr_b16 a[172:173], v6 offset:768
  v_add_f32 v17, v17, v77
  v_mfma_f32_16x16x32_bf16 v[232:235], a[200:203], v[148:151], v[232:235]
  ds_read_b64_tr_b16 a[174:175], v6 offset:1792
  v_add_f32 v16, v16, v78
  v_mfma_f32_16x16x32_bf16 v[244:247], a[204:207], v[148:151], v[244:247]
  v_add_f32 v17, v17, v79
  v_max3_f32 v10, v10, v123, v124
  v_max3_f32 v10, v10, v125, v126
  v_max_f32 v10, v10, v127
  v_cmp_lt_f32 vcc, s57, v10
  s_nop 1
  s_cbranch_vccnz L_stub_tx
L_back_tx:
  s_cmp_eq_u32 s101, 0
  s_cbranch_scc1 L_nopre
  s_waitcnt vmcnt(0)
  v_xor_b32 v252, s39, v252
  v_xor_b32 v253, s39, v253
  v_xor_b32 v254, s39, v254
  v_xor_b32 v255, s39, v255
  v_or3_b32 v252, v252, v253, v254
  v_or_b32 v252, v252, v255
  s_nop 0
  v_readfirstlane_b32 s63, v252
  s_nop 1
  s_cmp_eq_u32 s63, 0
  s_cbranch_scc0 L_gspin_pl0
L_gspun_pl0:
  buffer_load_dwordx4 a[208:211], v9, s[16:19], s21 offen offset:0 sc1
  buffer_load_dwordx4 a[212:215], v7, s[16:19], s21 offen offset:0 sc1
  buffer_load_dwordx4 a[216:219], v19, s[16:19], s21 offen offset:0 sc1
  buffer_load_dwordx4 a[220:223], v9, s[16:19], s21 offen offset:1024 sc1
  buffer_load_dwordx4 a[224:227], v7, s[16:19], s21 offen offset:1024 sc1
  buffer_load_dwordx4 a[228:231], v19, s[16:19], s21 offen offset:1024 sc1
  buffer_load_dwordx4 a[232:235], v9, s[16:19], s21 offen offset:2048 sc1
  buffer_load_dwordx4 a[236:239], v7, s[16:19], s21 offen offset:2048 sc1
  buffer_load_dwordx4 a[240:243], v19, s[16:19], s21 offen offset:2048 sc1
  buffer_load_dwordx4 a[244:247], v9, s[16:19], s21 offen offset:3072 sc1
  buffer_load_dwordx4 a[248:251], v7, s[16:19], s21 offen offset:3072 sc1
  buffer_load_dwordx4 a[252:255], v19, s[16:19], s21 offen offset:3072 sc1
L_nopre:
  v_exp_f32 v80, v80
  v_exp_f32 v81, v81
  v_exp_f32 v82, v82
  v_exp_f32 v83, v83
  v_cvt_pk_bf16_f32 v128, v80, v81
  v_cvt_pk_bf16_f32 v129, v82, v83
  v_exp_f32 v92, v92
  v_exp_f32 v93, v93
  v_exp_f32 v94, v94
  v_exp_f32 v95, v95
  v_cvt_pk_bf16_f32 v130, v92, v93
  v_cvt_pk_bf16_f32 v131, v94, v95
  s_waitcnt lgkmcnt(8)
  s_nop 0
  v_mfma_f32_16x16x32_bf16 v[152:155], a[144:147], v[128:131], v[152:155]
  v_exp_f32 v84, v84
  v_mfma_f32_16x16x32_bf16 v[164:167], a[148:151], v[128:131], v[164:167]
  v_exp_f32 v85, v85
  v_mfma_f32_16x16x32_bf16 v[176:179], a[152:155], v[128:131], v[176:179]
  v_exp_f32 v86, v86
  v_mfma_f32_16x16x32_bf16 v[188:191], a[156:159], v[128:131], v[188:191]
  s_add_u32 s53, s53, 16384
  s_waitcnt lgkmcnt(0)
  v_mfma_f32_16x16x32_bf16 v[200:203], a[160:163], v[128:131], v[200:203]
  v_exp_f32 v87, v87
  v_mfma_f32_16x16x32_bf16 v[212:215], a[164:167], v[128:131], v[212:215]
  v_exp_f32 v96, v96
  v_mfma_f32_16x16x32_bf16 v[224:227], a[168:171], v[128:131], v[224:227]
  ds_read_b64_tr_b16 a[176:177], v4 offset:8192
  v_cvt_pk_bf16_f32 v132, v84, v85
  v_mfma_f32_16x16x32_bf16 v[236:239], a[172:175], v[128:131], v[236:239]
  ds_read_b64_tr_b16 a[178:179], v4 offset:9216
  v_cvt_pk_bf16_f32 v133, v86, v87
  v_exp_f32 v97, v97
  v_exp_f32 v98, v98
  v_exp_f32 v99, v99
  v_cvt_pk_bf16_f32 v134, v96, v97
  v_cvt_pk_bf16_f32 v135, v98, v99
  s_nop 1
  v_mfma_f32_16x16x32_bf16 v[156:159], a[144:147], v[132:135], v[156:159]
  ds_read_b64_tr_b16 a[180:181], v6 offset:8192
  v_add_f32 v12, v12, v80
  v_mfma_f32_16x16x32_bf16 v[168:171], a[148:151], v[132:135], v[168:171]
  ds_read_b64_tr_b16 a[182:183], v6 offset:9216
  v_add_f32 v13, v13, v81
  v_mfma_f32_16x16x32_bf16 v[180:183], a[152:155], v[132:135], v[180:183]
  ds_read_b64_tr_b16 a[184:185], v4 offset:8448
  v_add_f32 v12, v12, v82
  v_mfma_f32_16x16x32_bf16 v[192:195], a[156:159], v[132:135], v[192:195]
  ds_read_b64_tr_b16 a[186:187], v4 offset:9472
  v_add_f32 v13, v13, v83
  v_mfma_f32_16x16x32_bf16 v[204:207], a[160:163], v[132:135], v[204:207]
  ds_read_b64_tr_b16 a[188:189], v6 offset:8448
  s_cmp_eq_u32 s53, 147456
  s_cselect_b32 s53, 81920, s53
  v_mfma_f32_16x16x32_bf16 v[216:219], a[164:167], v[132:135], v[216:219]
  ds_read_b64_tr_b16 a[190:191], v6 offset:9472
  v_add_f32 v12, v12, v92
  v_mfma_f32_16x16x32_bf16 v[228:231], a[168:171], v[132:135], v[228:231]
  ds_read_b64_tr_b16 a[192:193], v4 offset:8704
  v_add_f32 v13, v13, v93
  v_mfma_f32_16x16x32_bf16 v[240:243], a[172:175], v[132:135], v[240:243]
  ds_read_b64_tr_b16 a[194:195], v4 offset:9728
  v_add_f32 v12, v12, v94
  v_exp_f32 v88, v88
  v_exp_f32 v89, v89
  v_exp_f32 v90, v90
  v_exp_f32 v91, v91
  v_cvt_pk_bf16_f32 v136, v88, v89
  v_cvt_pk_bf16_f32 v137, v90, v91
  v_exp_f32 v100, v100
  v_exp_f32 v101, v101
  v_exp_f32 v102, v102
  v_exp_f32 v103, v103
  v_cvt_pk_bf16_f32 v138, v100, v101
  v_cvt_pk_bf16_f32 v139, v102, v103
  s_nop 1
  v_mfma_f32_16x16x32_bf16 v[160:163], a[144:147], v[136:139], v[160:163]
  ds_read_b64_tr_b16 a[196:197], v6 offset:8704
  v_add_f32 v13, v13, v95
  v_mfma_f32_16x16x32_bf16 v[172:175], a[148:151], v[136:139], v[172:175]
  ds_read_b64_tr_b16 a[198:199], v6 offset:9728
  v_add_f32 v14, v14, v84
  v_mfma_f32_16x16x32_bf16 v[184:187], a[152:155], v[136:139], v[184:187]
  ds_read_b64_tr_b16 a[200:201], v4 offset:8960
  v_add_f32 v15, v15, v85
  v_mfma_f32_16x16x32_bf16 v[196:199], a[156:159], v[136:139], v[196:199]
  ds_read_b64_tr_b16 a[202:203], v4 offset:9984
  v_add_f32 v14, v14, v86
  v_mfma_f32_16x16x32_bf16 v[208:211], a[160:163], v[136:139], v[208:211]
  ds_read_b64_tr_b16 a[204:205], v6 offset:8960
  v_add_f32 v15, v15, v87
  v_mfma_f32_16x16x32_bf16 v[220:223], a[164:167], v[136:139], v[220:223]
  ds_read_b64_tr_b16 a[206:207], v6 offset:9984
  v_add_f32 v14, v14, v96
  v_mfma_f32_16x16x32_bf16 v[232:235], a[168:171], v[136:139], v[232:235]
  v_add_u32 v4, s53, v8
  v_add_f32 v15, v15, v97
  v_mfma_f32_16x16x32_bf16 v[244:247], a[172:175], v[136:139], v[244:247]
  v_add_f32 v14, v14, v98
  v_exp_f32 v104, v104
  v_exp_f32 v105, v105
  v_exp_f32 v106, v106
  v_exp_f32 v107, v107
  v_cvt_pk_bf16_f32 v140, v104, v105
  v_cvt_pk_bf16_f32 v141, v106, v107
  v_exp_f32 v116, v116
  v_exp_f32 v117, v117
  v_exp_f32 v118, v118
  v_exp_f32 v119, v119
  v_cvt_pk_bf16_f32 v142, v116, v117
  v_cvt_pk_bf16_f32 v143, v118, v119
  v_xor_b32 v6, 32, v4
  s_waitcnt lgkmcnt(8)
  v_mfma_f32_16x16x32_bf16 v[152:155], a[176:179], v[140:143], v[152:155]
  v_add_f32 v15, v15, v99
  v_add_f32 v16, v16, v88
  v_mfma_f32_16x16x32_bf16 v[164:167], a[180:183], v[140:143], v[164:167]
  v_add_f32 v17, v17, v89
  v_add_f32 v16, v16, v90
  v_mfma_f32_16x16x32_bf16 v[176:179], a[184:187], v[140:143], v[176:179]
  ds_read_b64_tr_b16 a[144:145], v5 offset:0
  v_add_f32 v17, v17, v91
  v_mfma_f32_16x16x32_bf16 v[188:191], a[188:191], v[140:143], v[188:191]
  ds_read_b64_tr_b16 a[146:147], v5 offset:1024
  s_waitcnt lgkmcnt(2)
  ds_write_b32 v249, v250 offset:0
  v_add_u32 v250, 1, v250
  v_mfma_f32_16x16x32_bf16 v[200:203], a[192:195], v[140:143], v[200:203]
  ds_read_b64_tr_b16 a[148:149], v11 offset:0
  v_add_f32 v16, v16, v100
  v_mfma_f32_16x16x32_bf16 v[212:215], a[196:199], v[140:143], v[212:215]
  ds_read_b64_tr_b16 a[150:151], v11 offset:1024
  v_add_f32 v17, v17, v101
  v_mfma_f32_16x16x32_bf16 v[224:227], a[200:203], v[140:143], v[224:227]
  v_add_f32 v16, v16, v102
  v_add_f32 v17, v17, v103
  v_mfma_f32_16x16x32_bf16 v[236:239], a[204:207], v[140:143], v[236:239]
  v_exp_f32 v108, v108
  v_exp_f32 v109, v109
  v_exp_f32 v110, v110
  v_exp_f32 v111, v111
  v_cvt_pk_bf16_f32 v144, v108, v109
  v_cvt_pk_bf16_f32 v145, v110, v111
  v_exp_f32 v120, v120
  v_exp_f32 v121, v121
  v_exp_f32 v122, v122
  v_exp_f32 v123, v123
  v_cvt_pk_bf16_f32 v146, v120, v121
  v_cvt_pk_bf16_f32 v147, v122, v123
  s_nop 1
  v_mfma_f32_16x16x32_bf16 v[156:159], a[176:179], v[144:147], v[156:159]
  v_add_f32 v12, v12, v104
  v_add_f32 v13, v13, v105
  v_mfma_f32_16x16x32_bf16 v[168:171], a[180:183], v[144:147], v[168:171]
  ds_read_b64_tr_b16 a[152:153], v5 offset:256
  v_add_f32 v12, v12, v106
  v_mfma_f32_16x16x32_bf16 v[180:183], a[184:187], v[144:147], v[180:183]
  ds_read_b64_tr_b16 a[154:155], v5 offset:1280
  v_add_f32 v13, v13, v107
  v_mfma_f32_16x16x32_bf16 v[192:195], a[188:191], v[144:147], v[192:195]
  ds_read_b64_tr_b16 a[156:157], v11 offset:256
  v_add_f32 v12, v12, v116
  v_mfma_f32_16x16x32_bf16 v[204:207], a[192:195], v[144:147], v[204:207]
  ds_read_b64_tr_b16 a[158:159], v11 offset:1280
  v_add_f32 v13, v13, v117
  v_mfma_f32_16x16x32_bf16 v[216:219], a[196:199], v[144:147], v[216:219]
  ds_read_b64_tr_b16 a[160:161], v5 offset:512
  v_add_f32 v12, v12, v118
  v_mfma_f32_16x16x32_bf16 v[228:231], a[200:203], v[144:147], v[228:231]
  ds_read_b64_tr_b16 a[162:163], v5 offset:1536
  v_add_f32 v13, v13, v119
  v_mfma_f32_16x16x32_bf16 v[240:243], a[204:207], v[144:147], v[240:243]
  ds_read_b64_tr_b16 a[164:165], v11 offset:512
  v_add_f32 v14, v14, v108
  v_exp_f32 v112, v112
  v_exp_f32 v113, v113
  v_exp_f32 v114, v114
  v_exp_f32 v115, v115
  v_cvt_pk_bf16_f32 v148, v112, v113
  v_cvt_pk_bf16_f32 v149, v114, v115
  v_exp_f32 v124, v124
  v_exp_f32 v125, v125
  v_exp_f32 v126, v126
  v_exp_f32 v127, v127
  v_cvt_pk_bf16_f32 v150, v124, v125
  v_cvt_pk_bf16_f32 v151, v126, v127
  s_nop 1
  v_mfma_f32_16x16x32_bf16 v[160:163], a[176:179], v[148:151], v[160:163]
  ds_read_b64_tr_b16 a[166:167], v11 offset:1536
  v_add_f32 v15, v15, v109
  v_mfma_f32_16x16x32_bf16 v[172:175], a[180:183], v[148:151], v[172:175]
  ds_read_b64_tr_b16 a[168:169], v5 offset:768
  v_add_f32 v14, v14, v110
  v_mfma_f32_16x16x32_bf16 v[184:187], a[184:187], v[148:151], v[184:187]
  ds_read_b64_tr_b16 a[170:171], v5 offset:1792
  v_add_f32 v15, v15, v111
  v_mfma_f32_16x16x32_bf16 v[196:199], a[188:191], v[148:151], v[196:199]
  ds_read_b64_tr_b16 a[172:173], v11 offset:768
  v_add_f32 v14, v14, v120
  v_mfma_f32_16x16x32_bf16 v[208:211], a[192:195], v[148:151], v[208:211]
  ds_read_b64_tr_b16 a[174:175], v11 offset:1792
  v_add_f32 v15, v15, v121
  v_mfma_f32_16x16x32_bf16 v[220:223], a[196:199], v[148:151], v[220:223]
  v_add_f32 v14, v14, v122
  v_add_f32 v15, v15, v123
  v_mfma_f32_16x16x32_bf16 v[232:235], a[200:203], v[148:151], v[232:235]
  v_add_f32 v16, v16, v112
  v_add_f32 v17, v17, v113
  v_mfma_f32_16x16x32_bf16 v[244:247], a[204:207], v[148:151], v[244:247]
  v_add_f32 v16, v16, v114
  v_add_f32 v17, v17, v115
  v_add_f32 v16, v16, v124
  v_add_f32 v17, v17, v125
  v_add_f32 v16, v16, v126
  v_add_f32 v17, v17, v127
  s_cmp_eq_u32 s101, 1
  s_cbranch_scc1 L_tail
  s_mov_b32 s54, 57
  ds_read_b32 v248, v251 offset:20480
  s_waitcnt lgkmcnt(0)
  v_readfirstlane_b32 s56, v248
  s_nop 1
  s_cmp_ge_u32 s56, s54
  s_cbranch_scc0 L_spin_bnd
L_spun_bnd:
  ds_read_b128 a[144:147], v3 offset:0
  ds_read_b128 a[148:151], v3 offset:256
  ds_read_b128 a[152:155], v3 offset:512
  ds_read_b128 a[156:159], v3 offset:768
  ds_read_b128 a[160:163], v3 offset:1024
  ds_read_b128 a[164:167], v3 offset:1280
  ds_read_b128 a[168:171], v3 offset:1536
  ds_read_b128 a[172:175], v3 offset:1792
  v_add_f32 v12, v12, v13
  v_mov_b32 v22, v12
  s_nop 1
  v_permlane32_swap_b32 v12, v22
  v_add_f32 v12, v12, v22
  v_mov_b32 v22, v12
  s_nop 1
  v_permlane16_swap_b32 v12, v22
  v_add_f32 v12, v12, v22
  v_rcp_f32 v20, v12
  s_nop 0
  v_pk_mul_f32 v[152:153], v[152:153], v[20:21] op_sel_hi:[1,0]
  v_pk_mul_f32 v[154:155], v[154:155], v[20:21] op_sel_hi:[1,0]
  v_pk_mul_f32 v[164:165], v[164:165], v[20:21] op_sel_hi:[1,0]
  v_pk_mul_f32 v[166:167], v[166:167], v[20:21] op_sel_hi:[1,0]
  v_cvt_pk_bf16_f32 v128, v152, v153
  v_cvt_pk_bf16_f32 v129, v154, v155
  v_cvt_pk_bf16_f32 v130, v164, v165
  v_cvt_pk_bf16_f32 v131, v166, v167
  v_accvgpr_write_b32 a48, v128
  v_accvgpr_write_b32 a49, v129
  v_accvgpr_write_b32 a50, v130
  v_accvgpr_write_b32 a51, v131
  v_pk_mul_f32 v[176:177], v[176:177], v[20:21] op_sel_hi:[1,0]
  v_pk_mul_f32 v[178:179], v[178:179], v[20:21] op_sel_hi:[1,0]
  v_pk_mul_f32 v[188:189], v[188:189], v[20:21] op_sel_hi:[1,0]
  v_pk_mul_f32 v[190:191], v[190:191], v[20:21] op_sel_hi:[1,0]
  v_cvt_pk_bf16_f32 v132, v176, v177
  v_cvt_pk_bf16_f32 v133, v178, v179
  v_cvt_pk_bf16_f32 v134, v188, v189
  v_cvt_pk_bf16_f32 v135, v190, v191
  v_accvgpr_write_b32 a60, v132
  v_accvgpr_write_b32 a61, v133
  v_accvgpr_write_b32 a62, v134
  v_accvgpr_write_b32 a63, v135
  v_pk_mul_f32 v[200:201], v[200:201], v[20:21] op_sel_hi:[1,0]
  v_pk_mul_f32 v[202:203], v[202:203], v[20:21] op_sel_hi:[1,0]
  v_pk_mul_f32 v[212:213], v[212:213], v[20:21] op_sel_hi:[1,0]
  v_pk_mul_f32 v[214:215], v[214:215], v[20:21] op_sel_hi:[1,0]
  v_cvt_pk_bf16_f32 v136, v200, v201
  v_cvt_pk_bf16_f32 v137, v202, v203
  v_cvt_pk_bf16_f32 v138, v212, v213
  v_cvt_pk_bf16_f32 v139, v214, v215
  v_accvgpr_write_b32 a72, v136
  v_accvgpr_write_b32 a73, v137
  v_accvgpr_write_b32 a74, v138
  v_accvgpr_write_b32 a75, v139
  v_pk_mul_f32 v[224:225], v[224:225], v[20:21] op_sel_hi:[1,0]
  v_pk_mul_f32 v[226:227], v[226:227], v[20:21] op_sel_hi:[1,0]
  v_pk_mul_f32 v[236:237], v[236:237], v[20:21] op_sel_hi:[1,0]
  v_pk_mul_f32 v[238:239], v[238:239], v[20:21] op_sel_hi:[1,0]
  v_cvt_pk_bf16_f32 v128, v224, v225
  v_cvt_pk_bf16_f32 v129, v226, v227
  v_cvt_pk_bf16_f32 v130, v236, v237
  v_cvt_pk_bf16_f32 v131, v238, v239
  v_accvgpr_write_b32 a84, v128
  v_accvgpr_write_b32 a85, v129
  v_accvgpr_write_b32 a86, v130
  v_accvgpr_write_b32 a87, v131
  v_add_f32 v14, v14, v15
  v_mov_b32 v22, v14
  s_nop 1
  v_permlane32_swap_b32 v14, v22
  v_add_f32 v14, v14, v22
  v_mov_b32 v22, v14
  s_nop 1
  v_permlane16_swap_b32 v14, v22
  v_add_f32 v14, v14, v22
  v_rcp_f32 v20, v14
  s_nop 0
  v_pk_mul_f32 v[156:157], v[156:157], v[20:21] op_sel_hi:[1,0]
  v_pk_mul_f32 v[158:159], v[158:159], v[20:21] op_sel_hi:[1,0]
  v_pk_mul_f32 v[168:169], v[168:169], v[20:21] op_sel_hi:[1,0]
  v_pk_mul_f32 v[170:171], v[170:171], v[20:21] op_sel_hi:[1,0]
  v_cvt_pk_bf16_f32 v132, v156, v157
  v_cvt_pk_bf16_f32 v133, v158, v159
  v_cvt_pk_bf16_f32 v134, v168, v169
  v_cvt_pk_bf16_f32 v135, v170, v171
  v_accvgpr_write_b32 a52, v132
  v_accvgpr_write_b32 a53, v133
  v_accvgpr_write_b32 a54, v134
  v_accvgpr_write_b32 a55, v135
  v_pk_mul_f32 v[180:181], v[180:181], v[20:21] op_sel_hi:[1,0]
  v_pk_mul_f32 v[182:183], v[182:183], v[20:21] op_sel_hi:[1,0]
  v_pk_mul_f32 v[192:193], v[192:193], v[20:21] op_sel_hi:[1,0]
  v_pk_mul_f32 v[194:195], v[194:195], v[20:21] op_sel_hi:[1,0]
  v_cvt_pk_bf16_f32 v136, v180, v181
  v_cvt_pk_bf16_f32 v137, v182, v183
  v_cvt_pk_bf16_f32 v138, v192, v193
  v_cvt_pk_bf16_f32 v139, v194, v195
  v_accvgpr_write_b32 a64, v136
  v_accvgpr_write_b32 a65, v137
  v_accvgpr_write_b32 a66, v138
  v_accvgpr_write_b32 a67, v139
  v_pk_mul_f32 v[204:205], v[204:205], v[20:21] op_sel_hi:[1,0]
  v_pk_mul_f32 v[206:207], v[206:207], v[20:21] op_sel_hi:[1,0]
  v_pk_mul_f32 v[216:217], v[216:217], v[20:21] op_sel_hi:[1,0]
  v_pk_mul_f32 v[218:219], v[218:219], v[20:21] op_sel_hi:[1,0]
  v_cvt_pk_bf16_f32 v128, v204, v205
  v_cvt_pk_bf16_f32 v129, v206, v207
  v_cvt_pk_bf16_f32 v130, v216, v217
  v_cvt_pk_bf16_f32 v131, v218, v219
  v_accvgpr_write_b32 a76, v128
  v_accvgpr_write_b32 a77, v129
  v_accvgpr_write_b32 a78, v130
  v_accvgpr_write_b32 a79, v131
  v_pk_mul_f32 v[228:229], v[228:229], v[20:21] op_sel_hi:[1,0]
  v_pk_mul_f32 v[230:231], v[230:231], v[20:21] op_sel_hi:[1,0]
  v_pk_mul_f32 v[240:241], v[240:241], v[20:21] op_sel_hi:[1,0]
  v_pk_mul_f32 v[242:243], v[242:243], v[20:21] op_sel_hi:[1,0]
  v_cvt_pk_bf16_f32 v132, v228, v229
  v_cvt_pk_bf16_f32 v133, v230, v231
  v_cvt_pk_bf16_f32 v134, v240, v241
  v_cvt_pk_bf16_f32 v135, v242, v243
  v_accvgpr_write_b32 a88, v132
  v_accvgpr_write_b32 a89, v133
  v_accvgpr_write_b32 a90, v134
  v_accvgpr_write_b32 a91, v135
  v_add_f32 v16, v16, v17
  v_mov_b32 v22, v16
  s_nop 1
  v_permlane32_swap_b32 v16, v22
  v_add_f32 v16, v16, v22
  v_mov_b32 v22, v16
  s_nop 1
  v_permlane16_swap_b32 v16, v22
  v_add_f32 v16, v16, v22
  v_rcp_f32 v20, v16
  s_nop 0
  v_pk_mul_f32 v[160:161], v[160:161], v[20:21] op_sel_hi:[1,0]
  v_pk_mul_f32 v[162:163], v[162:163], v[20:21] op_sel_hi:[1,0]
  v_pk_mul_f32 v[172:173], v[172:173], v[20:21] op_sel_hi:[1,0]
  v_pk_mul_f32 v[174:175], v[174:175], v[20:21] op_sel_hi:[1,0]
  v_cvt_pk_bf16_f32 v136, v160, v161
  v_cvt_pk_bf16_f32 v137, v162, v163
  v_cvt_pk_bf16_f32 v138, v172, v173
  v_cvt_pk_bf16_f32 v139, v174, v175
  v_accvgpr_write_b32 a56, v136
  v_accvgpr_write_b32 a57, v137
  v_accvgpr_write_b32 a58, v138
  v_accvgpr_write_b32 a59, v139
  v_pk_mul_f32 v[184:185], v[184:185], v[20:21] op_sel_hi:[1,0]
  v_pk_mul_f32 v[186:187], v[186:187], v[20:21] op_sel_hi:[1,0]
  v_pk_mul_f32 v[196:197], v[196:197], v[20:21] op_sel_hi:[1,0]
  v_pk_mul_f32 v[198:199], v[198:199], v[20:21] op_sel_hi:[1,0]
  v_cvt_pk_bf16_f32 v128, v184, v185
  v_cvt_pk_bf16_f32 v129, v186, v187
  v_cvt_pk_bf16_f32 v130, v196, v197
  v_cvt_pk_bf16_f32 v131, v198, v199
  v_accvgpr_write_b32 a68, v128
  v_accvgpr_write_b32 a69, v129
  v_accvgpr_write_b32 a70, v130
  v_accvgpr_write_b32 a71, v131
  v_pk_mul_f32 v[208:209], v[208:209], v[20:21] op_sel_hi:[1,0]
  v_pk_mul_f32 v[210:211], v[210:211], v[20:21] op_sel_hi:[1,0]
  v_pk_mul_f32 v[220:221], v[220:221], v[20:21] op_sel_hi:[1,0]
  v_pk_mul_f32 v[222:223], v[222:223], v[20:21] op_sel_hi:[1,0]
  v_cvt_pk_bf16_f32 v132, v208, v209
  v_cvt_pk_bf16_f32 v133, v210, v211
  v_cvt_pk_bf16_f32 v134, v220, v221
  v_cvt_pk_bf16_f32 v135, v222, v223
  v_accvgpr_write_b32 a80, v132
  v_accvgpr_write_b32 a81, v133
  v_accvgpr_write_b32 a82, v134
  v_accvgpr_write_b32 a83, v135
  v_pk_mul_f32 v[232:233], v[232:233], v[20:21] op_sel_hi:[1,0]
  v_pk_mul_f32 v[234:235], v[234:235], v[20:21] op_sel_hi:[1,0]
  v_pk_mul_f32 v[244:245], v[244:245], v[20:21] op_sel_hi:[1,0]
  v_pk_mul_f32 v[246:247], v[246:247], v[20:21] op_sel_hi:[1,0]
  v_cvt_pk_bf16_f32 v136, v232, v233
  v_cvt_pk_bf16_f32 v137, v234, v235
  v_cvt_pk_bf16_f32 v138, v244, v245
  v_cvt_pk_bf16_f32 v139, v246, v247
  v_accvgpr_write_b32 a92, v136
  v_accvgpr_write_b32 a93, v137
  v_accvgpr_write_b32 a94, v138
  v_accvgpr_write_b32 a95, v139
  v_accvgpr_mov_b32 a96, a0
  v_accvgpr_mov_b32 a97, a1
  v_accvgpr_mov_b32 a98, a2
  v_accvgpr_mov_b32 a99, a3
  v_accvgpr_mov_b32 a100, a12
  v_accvgpr_mov_b32 a101, a13
  v_accvgpr_mov_b32 a102, a14
  v_accvgpr_mov_b32 a103, a15
  v_accvgpr_mov_b32 a104, a24
  v_accvgpr_mov_b32 a105, a25
  v_accvgpr_mov_b32 a106, a26
  v_accvgpr_mov_b32 a107, a27
  v_accvgpr_mov_b32 a108, a36
  v_accvgpr_mov_b32 a109, a37
  v_accvgpr_mov_b32 a110, a38
  v_accvgpr_mov_b32 a111, a39
  v_accvgpr_mov_b32 a112, a4
  v_accvgpr_mov_b32 a113, a5
  v_accvgpr_mov_b32 a114, a6
  v_accvgpr_mov_b32 a115, a7
  v_accvgpr_mov_b32 a116, a16
  v_accvgpr_mov_b32 a117, a17
  v_accvgpr_mov_b32 a118, a18
  v_accvgpr_mov_b32 a119, a19
  v_accvgpr_mov_b32 a120, a28
  v_accvgpr_mov_b32 a121, a29
  v_accvgpr_mov_b32 a122, a30
  v_accvgpr_mov_b32 a123, a31
  v_accvgpr_mov_b32 a124, a40
  v_accvgpr_mov_b32 a125, a41
  v_accvgpr_mov_b32 a126, a42
  v_accvgpr_mov_b32 a127, a43
  v_accvgpr_mov_b32 a128, a8
  v_accvgpr_mov_b32 a129, a9
  v_accvgpr_mov_b32 a130, a10
  v_accvgpr_mov_b32 a131, a11
  v_accvgpr_mov_b32 a132, a20
  v_accvgpr_mov_b32 a133, a21
  v_accvgpr_mov_b32 a134, a22
  v_accvgpr_mov_b32 a135, a23
  v_accvgpr_mov_b32 a136, a32
  v_accvgpr_mov_b32 a137, a33
  v_accvgpr_mov_b32 a138, a34
  v_accvgpr_mov_b32 a139, a35
  v_accvgpr_mov_b32 a140, a44
  v_accvgpr_mov_b32 a141, a45
  v_accvgpr_mov_b32 a142, a46
  v_accvgpr_mov_b32 a143, a47
  s_mov_b32 s101, 1
  s_nop 1
  s_branch L_task
L_tail:
  s_waitcnt lgkmcnt(8)
  v_add_f32 v12, v12, v13
  v_mov_b32 v22, v12
  s_nop 1
  v_permlane32_swap_b32 v12, v22
  v_add_f32 v12, v12, v22
  v_mov_b32 v22, v12
  s_nop 1
  v_permlane16_swap_b32 v12, v22
  v_add_f32 v12, v12, v22
  v_rcp_f32 v20, v12
  s_nop 0
  v_pk_mul_f32 v[152:153], v[152:153], v[20:21] op_sel_hi:[1,0]
  v_pk_mul_f32 v[154:155], v[154:155], v[20:21] op_sel_hi:[1,0]
  v_pk_mul_f32 v[164:165], v[164:165], v[20:21] op_sel_hi:[1,0]
  v_pk_mul_f32 v[166:167], v[166:167], v[20:21] op_sel_hi:[1,0]
  v_cvt_pk_bf16_f32 v32, v152, v153
  v_cvt_pk_bf16_f32 v33, v154, v155
  v_cvt_pk_bf16_f32 v34, v164, v165
  v_cvt_pk_bf16_f32 v35, v166, v167
  v_pk_mul_f32 v[176:177], v[176:177], v[20:21] op_sel_hi:[1,0]
  v_pk_mul_f32 v[178:179], v[178:179], v[20:21] op_sel_hi:[1,0]
  v_pk_mul_f32 v[188:189], v[188:189], v[20:21] op_sel_hi:[1,0]
  v_pk_mul_f32 v[190:191], v[190:191], v[20:21] op_sel_hi:[1,0]
  v_cvt_pk_bf16_f32 v44, v176, v177
  v_cvt_pk_bf16_f32 v45, v178, v179
  v_cvt_pk_bf16_f32 v46, v188, v189
  v_cvt_pk_bf16_f32 v47, v190, v191
  v_pk_mul_f32 v[200:201], v[200:201], v[20:21] op_sel_hi:[1,0]
  v_pk_mul_f32 v[202:203], v[202:203], v[20:21] op_sel_hi:[1,0]
  v_pk_mul_f32 v[212:213], v[212:213], v[20:21] op_sel_hi:[1,0]
  v_pk_mul_f32 v[214:215], v[214:215], v[20:21] op_sel_hi:[1,0]
  v_cvt_pk_bf16_f32 v56, v200, v201
  v_cvt_pk_bf16_f32 v57, v202, v203
  v_cvt_pk_bf16_f32 v58, v212, v213
  v_cvt_pk_bf16_f32 v59, v214, v215
  v_pk_mul_f32 v[224:225], v[224:225], v[20:21] op_sel_hi:[1,0]
  v_pk_mul_f32 v[226:227], v[226:227], v[20:21] op_sel_hi:[1,0]
  v_pk_mul_f32 v[236:237], v[236:237], v[20:21] op_sel_hi:[1,0]
  v_pk_mul_f32 v[238:239], v[238:239], v[20:21] op_sel_hi:[1,0]
  v_cvt_pk_bf16_f32 v68, v224, v225
  v_cvt_pk_bf16_f32 v69, v226, v227
  v_cvt_pk_bf16_f32 v70, v236, v237
  v_cvt_pk_bf16_f32 v71, v238, v239
  v_add_f32 v14, v14, v15
  v_mov_b32 v22, v14
  s_nop 1
  v_permlane32_swap_b32 v14, v22
  v_add_f32 v14, v14, v22
  v_mov_b32 v22, v14
  s_nop 1
  v_permlane16_swap_b32 v14, v22
  v_add_f32 v14, v14, v22
  v_rcp_f32 v20, v14
  s_nop 0
  v_pk_mul_f32 v[156:157], v[156:157], v[20:21] op_sel_hi:[1,0]
  v_pk_mul_f32 v[158:159], v[158:159], v[20:21] op_sel_hi:[1,0]
  v_pk_mul_f32 v[168:169], v[168:169], v[20:21] op_sel_hi:[1,0]
  v_pk_mul_f32 v[170:171], v[170:171], v[20:21] op_sel_hi:[1,0]
  v_cvt_pk_bf16_f32 v36, v156, v157
  v_cvt_pk_bf16_f32 v37, v158, v159
  v_cvt_pk_bf16_f32 v38, v168, v169
  v_cvt_pk_bf16_f32 v39, v170, v171
  v_pk_mul_f32 v[180:181], v[180:181], v[20:21] op_sel_hi:[1,0]
  v_pk_mul_f32 v[182:183], v[182:183], v[20:21] op_sel_hi:[1,0]
  v_pk_mul_f32 v[192:193], v[192:193], v[20:21] op_sel_hi:[1,0]
  v_pk_mul_f32 v[194:195], v[194:195], v[20:21] op_sel_hi:[1,0]
  v_cvt_pk_bf16_f32 v48, v180, v181
  v_cvt_pk_bf16_f32 v49, v182, v183
  v_cvt_pk_bf16_f32 v50, v192, v193
  v_cvt_pk_bf16_f32 v51, v194, v195
  v_pk_mul_f32 v[204:205], v[204:205], v[20:21] op_sel_hi:[1,0]
  v_pk_mul_f32 v[206:207], v[206:207], v[20:21] op_sel_hi:[1,0]
  v_pk_mul_f32 v[216:217], v[216:217], v[20:21] op_sel_hi:[1,0]
  v_pk_mul_f32 v[218:219], v[218:219], v[20:21] op_sel_hi:[1,0]
  v_cvt_pk_bf16_f32 v60, v204, v205
  v_cvt_pk_bf16_f32 v61, v206, v207
  v_cvt_pk_bf16_f32 v62, v216, v217
  v_cvt_pk_bf16_f32 v63, v218, v219
  v_pk_mul_f32 v[228:229], v[228:229], v[20:21] op_sel_hi:[1,0]
  v_pk_mul_f32 v[230:231], v[230:231], v[20:21] op_sel_hi:[1,0]
  v_pk_mul_f32 v[240:241], v[240:241], v[20:21] op_sel_hi:[1,0]
  v_pk_mul_f32 v[242:243], v[242:243], v[20:21] op_sel_hi:[1,0]
  v_cvt_pk_bf16_f32 v72, v228, v229
  v_cvt_pk_bf16_f32 v73, v230, v231
  v_cvt_pk_bf16_f32 v74, v240, v241
  v_cvt_pk_bf16_f32 v75, v242, v243
  v_add_f32 v16, v16, v17
  v_mov_b32 v22, v16
  s_nop 1
  v_permlane32_swap_b32 v16, v22
  v_add_f32 v16, v16, v22
  v_mov_b32 v22, v16
  s_nop 1
  v_permlane16_swap_b32 v16, v22
  v_add_f32 v16, v16, v22
  v_rcp_f32 v20, v16
  s_nop 0
  v_pk_mul_f32 v[160:161], v[160:161], v[20:21] op_sel_hi:[1,0]
  v_pk_mul_f32 v[162:163], v[162:163], v[20:21] op_sel_hi:[1,0]
  v_pk_mul_f32 v[172:173], v[172:173], v[20:21] op_sel_hi:[1,0]
  v_pk_mul_f32 v[174:175], v[174:175], v[20:21] op_sel_hi:[1,0]
  v_cvt_pk_bf16_f32 v40, v160, v161
  v_cvt_pk_bf16_f32 v41, v162, v163
  v_cvt_pk_bf16_f32 v42, v172, v173
  v_cvt_pk_bf16_f32 v43, v174, v175
  v_pk_mul_f32 v[184:185], v[184:185], v[20:21] op_sel_hi:[1,0]
  v_pk_mul_f32 v[186:187], v[186:187], v[20:21] op_sel_hi:[1,0]
  v_pk_mul_f32 v[196:197], v[196:197], v[20:21] op_sel_hi:[1,0]
  v_pk_mul_f32 v[198:199], v[198:199], v[20:21] op_sel_hi:[1,0]
  v_cvt_pk_bf16_f32 v52, v184, v185
  v_cvt_pk_bf16_f32 v53, v186, v187
  v_cvt_pk_bf16_f32 v54, v196, v197
  v_cvt_pk_bf16_f32 v55, v198, v199
  v_pk_mul_f32 v[208:209], v[208:209], v[20:21] op_sel_hi:[1,0]
  v_pk_mul_f32 v[210:211], v[210:211], v[20:21] op_sel_hi:[1,0]
  v_pk_mul_f32 v[220:221], v[220:221], v[20:21] op_sel_hi:[1,0]
  v_pk_mul_f32 v[222:223], v[222:223], v[20:21] op_sel_hi:[1,0]
  v_cvt_pk_bf16_f32 v64, v208, v209
  v_cvt_pk_bf16_f32 v65, v210, v211
  v_cvt_pk_bf16_f32 v66, v220, v221
  v_cvt_pk_bf16_f32 v67, v222, v223
  v_pk_mul_f32 v[232:233], v[232:233], v[20:21] op_sel_hi:[1,0]
  v_pk_mul_f32 v[234:235], v[234:235], v[20:21] op_sel_hi:[1,0]
  v_pk_mul_f32 v[244:245], v[244:245], v[20:21] op_sel_hi:[1,0]
  v_pk_mul_f32 v[246:247], v[246:247], v[20:21] op_sel_hi:[1,0]
  v_cvt_pk_bf16_f32 v76, v232, v233
  v_cvt_pk_bf16_f32 v77, v234, v235
  v_cvt_pk_bf16_f32 v78, v244, v245
  v_cvt_pk_bf16_f32 v79, v246, v247
  v_mfma_f32_16x16x32_bf16 a[0:3], a[144:147], a[48:51], 0
  ds_read_b64_tr_b16 a[176:177], v5 offset:8192
  s_mov_b32 s54, 90
  v_mfma_f32_16x16x32_bf16 a[12:15], a[148:151], a[48:51], 0
  ds_read_b64_tr_b16 a[178:179], v5 offset:9216
  v_mfma_f32_16x16x32_bf16 a[24:27], a[152:155], a[48:51], 0
  ds_read_b64_tr_b16 a[180:181], v11 offset:8192
  s_add_u32 s62, s38, 0
  buffer_store_dwordx4 v[32:35], v9, s[48:51], s62 offen offset:0 sc1
  v_mfma_f32_16x16x32_bf16 a[36:39], a[156:159], a[48:51], 0
  ds_read_b64_tr_b16 a[182:183], v11 offset:9216
  v_mfma_f32_16x16x32_bf16 a[4:7], a[144:147], a[52:55], 0
  ds_read_b64_tr_b16 a[184:185], v5 offset:8448
  v_mfma_f32_16x16x32_bf16 a[16:19], a[148:151], a[52:55], 0
  ds_read_b64_tr_b16 a[186:187], v5 offset:9472
  v_mfma_f32_16x16x32_bf16 a[28:31], a[152:155], a[52:55], 0
  ds_read_b64_tr_b16 a[188:189], v11 offset:8448
  v_mfma_f32_16x16x32_bf16 a[40:43], a[156:159], a[52:55], 0
  ds_read_b64_tr_b16 a[190:191], v11 offset:9472
  v_mfma_f32_16x16x32_bf16 a[8:11], a[144:147], a[56:59], 0
  ds_read_b64_tr_b16 a[192:193], v5 offset:8704
  v_mfma_f32_16x16x32_bf16 a[20:23], a[148:151], a[56:59], 0
  ds_read_b64_tr_b16 a[194:195], v5 offset:9728
  s_add_u32 s62, s38, 0
  buffer_store_dwordx4 v[44:47], v9, s[48:51], s62 offen offset:1024 sc1
  v_mfma_f32_16x16x32_bf16 a[32:35], a[152:155], a[56:59], 0
  ds_read_b64_tr_b16 a[196:197], v11 offset:8704
  v_mfma_f32_16x16x32_bf16 a[44:47], a[156:159], a[56:59], 0
  ds_read_b64_tr_b16 a[198:199], v11 offset:9728
  s_waitcnt lgkmcnt(12)
  v_mfma_f32_16x16x32_bf16 a[96:99], a[160:163], a[48:51], 0
  ds_read_b64_tr_b16 a[200:201], v5 offset:8960
  v_mfma_f32_16x16x32_bf16 a[108:111], a[164:167], a[48:51], 0
  ds_read_b64_tr_b16 a[202:203], v5 offset:9984
  v_mfma_f32_16x16x32_bf16 a[120:123], a[168:171], a[48:51], 0
  ds_read_b64_tr_b16 a[204:205], v11 offset:8960
  v_mfma_f32_16x16x32_bf16 a[132:135], a[172:175], a[48:51], 0
  ds_read_b64_tr_b16 a[206:207], v11 offset:9984
  v_mfma_f32_16x16x32_bf16 a[100:103], a[160:163], a[52:55], 0
  ds_read_b32 v248, v251 offset:20480
  v_add_u32 v5, 49152, v2
  v_mfma_f32_16x16x32_bf16 a[112:115], a[164:167], a[52:55], 0
  s_add_u32 s62, s38, 0
  buffer_store_dwordx4 v[56:59], v9, s[48:51], s62 offen offset:2048 sc1
  v_xor_b32 v11, 8, v5
  v_mfma_f32_16x16x32_bf16 a[124:127], a[168:171], a[52:55], 0
  v_mfma_f32_16x16x32_bf16 a[136:139], a[172:175], a[52:55], 0
  v_mfma_f32_16x16x32_bf16 a[104:107], a[160:163], a[56:59], 0
  v_mfma_f32_16x16x32_bf16 a[116:119], a[164:167], a[56:59], 0
  v_mfma_f32_16x16x32_bf16 a[128:131], a[168:171], a[56:59], 0
  v_mfma_f32_16x16x32_bf16 a[140:143], a[172:175], a[56:59], 0
  s_waitcnt lgkmcnt(0)
  ds_write_b32 v249, v250 offset:0
  v_add_u32 v250, 1, v250
  v_readfirstlane_b32 s56, v248
  s_nop 1
  s_cmp_ge_u32 s56, s54
  s_cbranch_scc0 L_spin_u0
L_spun_u0:
  v_mfma_f32_16x16x32_bf16 a[0:3], a[176:179], a[60:63], a[0:3]
  ds_read_b64_tr_b16 a[144:145], v5 offset:0
  s_add_u32 s62, s38, 0
  buffer_store_dwordx4 v[68:71], v9, s[48:51], s62 offen offset:3072 sc1
  v_mfma_f32_16x16x32_bf16 a[12:15], a[180:183], a[60:63], a[12:15]
  ds_read_b64_tr_b16 a[146:147], v5 offset:1024
  v_mfma_f32_16x16x32_bf16 a[24:27], a[184:187], a[60:63], a[24:27]
  ds_read_b64_tr_b16 a[148:149], v11 offset:0
  v_mfma_f32_16x16x32_bf16 a[36:39], a[188:191], a[60:63], a[36:39]
  ds_read_b64_tr_b16 a[150:151], v11 offset:1024
  v_mfma_f32_16x16x32_bf16 a[4:7], a[176:179], a[64:67], a[4:7]
  ds_read_b64_tr_b16 a[152:153], v5 offset:256
  v_mfma_f32_16x16x32_bf16 a[16:19], a[180:183], a[64:67], a[16:19]
  ds_read_b64_tr_b16 a[154:155], v5 offset:1280
  v_mfma_f32_16x16x32_bf16 a[28:31], a[184:187], a[64:67], a[28:31]
  ds_read_b64_tr_b16 a[156:157], v11 offset:256
  v_mfma_f32_16x16x32_bf16 a[40:43], a[188:191], a[64:67], a[40:43]
  ds_read_b64_tr_b16 a[158:159], v11 offset:1280
  s_add_u32 s62, s38, 131072
  buffer_store_dwordx4 v[36:39], v9, s[48:51], s62 offen offset:0 sc1
  v_mfma_f32_16x16x32_bf16 a[8:11], a[176:179], a[68:71], a[8:11]
  ds_read_b64_tr_b16 a[160:161], v5 offset:512
  v_mfma_f32_16x16x32_bf16 a[20:23], a[180:183], a[68:71], a[20:23]
  ds_read_b64_tr_b16 a[162:163], v5 offset:1536
  v_mfma_f32_16x16x32_bf16 a[32:35], a[184:187], a[68:71], a[32:35]
  ds_read_b64_tr_b16 a[164:165], v11 offset:512
  v_mfma_f32_16x16x32_bf16 a[44:47], a[188:191], a[68:71], a[44:47]
  ds_read_b64_tr_b16 a[166:167], v11 offset:1536
  v_mfma_f32_16x16x32_bf16 a[96:99], a[192:195], a[60:63], a[96:99]
  ds_read_b64_tr_b16 a[168:169], v5 offset:768
  v_mfma_f32_16x16x32_bf16 a[108:111], a[196:199], a[60:63], a[108:111]
  ds_read_b64_tr_b16 a[170:171], v5 offset:1792
  v_mfma_f32_16x16x32_bf16 a[120:123], a[200:203], a[60:63], a[120:123]
  ds_read_b64_tr_b16 a[172:173], v11 offset:768
  s_add_u32 s62, s38, 131072
  buffer_store_dwordx4 v[48:51], v9, s[48:51], s62 offen offset:1024 sc1
  v_mfma_f32_16x16x32_bf16 a[132:135], a[204:207], a[60:63], a[132:135]
  ds_read_b64_tr_b16 a[174:175], v11 offset:1792
  v_mfma_f32_16x16x32_bf16 a[100:103], a[192:195], a[64:67], a[100:103]
  v_mfma_f32_16x16x32_bf16 a[112:115], a[196:199], a[64:67], a[112:115]
  v_mfma_f32_16x16x32_bf16 a[124:127], a[200:203], a[64:67], a[124:127]
  v_mfma_f32_16x16x32_bf16 a[136:139], a[204:207], a[64:67], a[136:139]
  v_mfma_f32_16x16x32_bf16 a[104:107], a[192:195], a[68:71], a[104:107]
  v_mfma_f32_16x16x32_bf16 a[116:119], a[196:199], a[68:71], a[116:119]
  v_mfma_f32_16x16x32_bf16 a[128:131], a[200:203], a[68:71], a[128:131]
  v_mfma_f32_16x16x32_bf16 a[140:143], a[204:207], a[68:71], a[140:143]
  s_waitcnt lgkmcnt(8)
  v_mfma_f32_16x16x32_bf16 a[0:3], a[144:147], a[72:75], a[0:3]
  ds_read_b64_tr_b16 a[176:177], v5 offset:8192
  s_mov_b32 s54, 91
  v_mfma_f32_16x16x32_bf16 a[12:15], a[148:151], a[72:75], a[12:15]
  ds_read_b64_tr_b16 a[178:179], v5 offset:9216
  v_mfma_f32_16x16x32_bf16 a[24:27], a[152:155], a[72:75], a[24:27]
  ds_read_b64_tr_b16 a[180:181], v11 offset:8192
  buffer_load_dwordx4 v[128:131], v9, s[16:19], s22 offen offset:0 sc1
  v_mfma_f32_16x16x32_bf16 a[36:39], a[156:159], a[72:75], a[36:39]
  ds_read_b64_tr_b16 a[182:183], v11 offset:9216
  v_mfma_f32_16x16x32_bf16 a[4:7], a[144:147], a[76:79], a[4:7]
  ds_read_b64_tr_b16 a[184:185], v5 offset:8448
  v_mfma_f32_16x16x32_bf16 a[16:19], a[148:151], a[76:79], a[16:19]
  ds_read_b64_tr_b16 a[186:187], v5 offset:9472
  s_add_u32 s62, s38, 131072
  buffer_store_dwordx4 v[60:63], v9, s[48:51], s62 offen offset:2048 sc1
  v_mfma_f32_16x16x32_bf16 a[28:31], a[152:155], a[76:79], a[28:31]
  ds_read_b64_tr_b16 a[188:189], v11 offset:8448
  v_mfma_f32_16x16x32_bf16 a[40:43], a[156:159], a[76:79], a[40:43]
  ds_read_b64_tr_b16 a[190:191], v11 offset:9472
  v_mfma_f32_16x16x32_bf16 a[8:11], a[144:147], a[80:83], a[8:11]
  ds_read_b64_tr_b16 a[192:193], v5 offset:8704
  v_mfma_f32_16x16x32_bf16 a[20:23], a[148:151], a[80:83], a[20:23]
  ds_read_b64_tr_b16 a[194:195], v5 offset:9728
  buffer_load_dwordx4 v[132:135], v7, s[16:19], s22 offen offset:0 sc1
  v_mfma_f32_16x16x32_bf16 a[32:35], a[152:155], a[80:83], a[32:35]
  ds_read_b64_tr_b16 a[196:197], v11 offset:8704
  v_mfma_f32_16x16x32_bf16 a[44:47], a[156:159], a[80:83], a[44:47]
  ds_read_b64_tr_b16 a[198:199], v11 offset:9728
  s_waitcnt lgkmcnt(12)
  v_mfma_f32_16x16x32_bf16 a[96:99], a[160:163], a[72:75], a[96:99]
  ds_read_b64_tr_b16 a[200:201], v5 offset:8960
  v_mfma_f32_16x16x32_bf16 a[108:111], a[164:167], a[72:75], a[108:111]
  ds_read_b64_tr_b16 a[202:203], v5 offset:9984
  s_add_u32 s62, s38, 131072
  buffer_store_dwordx4 v[72:75], v9, s[48:51], s62 offen offset:3072 sc1
  v_mfma_f32_16x16x32_bf16 a[120:123], a[168:171], a[72:75], a[120:123]
  ds_read_b64_tr_b16 a[204:205], v11 offset:8960
  v_mfma_f32_16x16x32_bf16 a[132:135], a[172:175], a[72:75], a[132:135]
  ds_read_b64_tr_b16 a[206:207], v11 offset:9984
  v_mfma_f32_16x16x32_bf16 a[100:103], a[160:163], a[76:79], a[100:103]
  ds_read_b32 v248, v251 offset:20480
  v_add_u32 v5, 65536, v2
  v_mfma_f32_16x16x32_bf16 a[112:115], a[164:167], a[76:79], a[112:115]
  buffer_load_dwordx4 v[136:139], v19, s[16:19], s22 offen offset:0 sc1
  v_xor_b32 v11, 8, v5
  v_mfma_f32_16x16x32_bf16 a[124:127], a[168:171], a[76:79], a[124:127]
  v_mfma_f32_16x16x32_bf16 a[136:139], a[172:175], a[76:79], a[136:139]
  v_mfma_f32_16x16x32_bf16 a[104:107], a[160:163], a[80:83], a[104:107]
  s_add_u32 s62, s38, 262144
  buffer_store_dwordx4 v[40:43], v9, s[48:51], s62 offen offset:0 sc1
  v_mfma_f32_16x16x32_bf16 a[116:119], a[164:167], a[80:83], a[116:119]
  v_mfma_f32_16x16x32_bf16 a[128:131], a[168:171], a[80:83], a[128:131]
  v_mfma_f32_16x16x32_bf16 a[140:143], a[172:175], a[80:83], a[140:143]
  s_waitcnt lgkmcnt(0)
  ds_write_b32 v249, v250 offset:0
  v_add_u32 v250, 1, v250
  v_readfirstlane_b32 s56, v248
  s_nop 1
  s_cmp_ge_u32 s56, s54
  s_cbranch_scc0 L_spin_u1
L_spun_u1:
  v_mfma_f32_16x16x32_bf16 a[0:3], a[176:179], a[84:87], a[0:3]
  ds_read_b64_tr_b16 a[144:145], v5 offset:0
  buffer_load_dwordx4 v[140:143], v9, s[16:19], s22 offen offset:1024 sc1
  v_mfma_f32_16x16x32_bf16 a[12:15], a[180:183], a[84:87], a[12:15]
  ds_read_b64_tr_b16 a[146:147], v5 offset:1024
  v_mfma_f32_16x16x32_bf16 a[24:27], a[184:187], a[84:87], a[24:27]
  ds_read_b64_tr_b16 a[148:149], v11 offset:0
  v_mfma_f32_16x16x32_bf16 a[36:39], a[188:191], a[84:87], a[36:39]
  ds_read_b64_tr_b16 a[150:151], v11 offset:1024
  s_add_u32 s62, s38, 262144
  buffer_store_dwordx4 v[52:55], v9, s[48:51], s62 offen offset:1024 sc1
  v_mfma_f32_16x16x32_bf16 a[4:7], a[176:179], a[88:91], a[4:7]
  ds_read_b64_tr_b16 a[152:153], v5 offset:256
  v_mfma_f32_16x16x32_bf16 a[16:19], a[180:183], a[88:91], a[16:19]
  ds_read_b64_tr_b16 a[154:155], v5 offset:1280
  v_mfma_f32_16x16x32_bf16 a[28:31], a[184:187], a[88:91], a[28:31]
  ds_read_b64_tr_b16 a[156:157], v11 offset:256
  v_mfma_f32_16x16x32_bf16 a[40:43], a[188:191], a[88:91], a[40:43]
  ds_read_b64_tr_b16 a[158:159], v11 offset:1280
  buffer_load_dwordx4 v[144:147], v7, s[16:19], s22 offen offset:1024 sc1
  v_mfma_f32_16x16x32_bf16 a[8:11], a[176:179], a[92:95], a[8:11]
  ds_read_b64_tr_b16 a[160:161], v5 offset:512
  v_mfma_f32_16x16x32_bf16 a[20:23], a[180:183], a[92:95], a[20:23]
  ds_read_b64_tr_b16 a[162:163], v5 offset:1536
  v_mfma_f32_16x16x32_bf16 a[32:35], a[184:187], a[92:95], a[32:35]
  ds_read_b64_tr_b16 a[164:165], v11 offset:512
  v_mfma_f32_16x16x32_bf16 a[44:47], a[188:191], a[92:95], a[44:47]
  ds_read_b64_tr_b16 a[166:167], v11 offset:1536
  s_add_u32 s62, s38, 262144
  buffer_store_dwordx4 v[64:67], v9, s[48:51], s62 offen offset:2048 sc1
  v_mfma_f32_16x16x32_bf16 a[96:99], a[192:195], a[84:87], a[96:99]
  ds_read_b64_tr_b16 a[168:169], v5 offset:768
  v_mfma_f32_16x16x32_bf16 a[108:111], a[196:199], a[84:87], a[108:111]
  ds_read_b64_tr_b16 a[170:171], v5 offset:1792
  v_mfma_f32_16x16x32_bf16 a[120:123], a[200:203], a[84:87], a[120:123]
  ds_read_b64_tr_b16 a[172:173], v11 offset:768
  buffer_load_dwordx4 v[148:151], v19, s[16:19], s22 offen offset:1024 sc1
  v_mfma_f32_16x16x32_bf16 a[132:135], a[204:207], a[84:87], a[132:135]
  ds_read_b64_tr_b16 a[174:175], v11 offset:1792
  v_mfma_f32_16x16x32_bf16 a[100:103], a[192:195], a[88:91], a[100:103]
  v_mfma_f32_16x16x32_bf16 a[112:115], a[196:199], a[88:91], a[112:115]
  v_mfma_f32_16x16x32_bf16 a[124:127], a[200:203], a[88:91], a[124:127]
  s_add_u32 s62, s38, 262144
  buffer_store_dwordx4 v[76:79], v9, s[48:51], s62 offen offset:3072 sc1
  v_mfma_f32_16x16x32_bf16 a[136:139], a[204:207], a[88:91], a[136:139]
  v_mfma_f32_16x16x32_bf16 a[104:107], a[192:195], a[92:95], a[104:107]
  v_mfma_f32_16x16x32_bf16 a[116:119], a[196:199], a[92:95], a[116:119]
  v_mfma_f32_16x16x32_bf16 a[128:131], a[200:203], a[92:95], a[128:131]
  v_mfma_f32_16x16x32_bf16 a[140:143], a[204:207], a[92:95], a[140:143]
  s_waitcnt lgkmcnt(8)
  v_mfma_f32_16x16x32_bf16 a[0:3], a[144:147], v[32:35], a[0:3]
  ds_read_b64_tr_b16 a[176:177], v5 offset:8192
  s_mov_b32 s54, 92
  v_mfma_f32_16x16x32_bf16 a[12:15], a[148:151], v[32:35], a[12:15]
  ds_read_b64_tr_b16 a[178:179], v5 offset:9216
  v_mfma_f32_16x16x32_bf16 a[24:27], a[152:155], v[32:35], a[24:27]
  ds_read_b64_tr_b16 a[180:181], v11 offset:8192
  buffer_load_dwordx4 v[152:155], v9, s[16:19], s22 offen offset:2048 sc1
  v_mfma_f32_16x16x32_bf16 a[36:39], a[156:159], v[32:35], a[36:39]
  ds_read_b64_tr_b16 a[182:183], v11 offset:9216
  v_mfma_f32_16x16x32_bf16 a[4:7], a[144:147], v[36:39], a[4:7]
  ds_read_b64_tr_b16 a[184:185], v5 offset:8448
  v_mfma_f32_16x16x32_bf16 a[16:19], a[148:151], v[36:39], a[16:19]
  ds_read_b64_tr_b16 a[186:187], v5 offset:9472
  v_mfma_f32_16x16x32_bf16 a[28:31], a[152:155], v[36:39], a[28:31]
  ds_read_b64_tr_b16 a[188:189], v11 offset:8448
  v_mfma_f32_16x16x32_bf16 a[40:43], a[156:159], v[36:39], a[40:43]
  ds_read_b64_tr_b16 a[190:191], v11 offset:9472
  v_mfma_f32_16x16x32_bf16 a[8:11], a[144:147], v[40:43], a[8:11]
  ds_read_b64_tr_b16 a[192:193], v5 offset:8704
  v_mfma_f32_16x16x32_bf16 a[20:23], a[148:151], v[40:43], a[20:23]
  ds_read_b64_tr_b16 a[194:195], v5 offset:9728
  buffer_load_dwordx4 v[156:159], v7, s[16:19], s22 offen offset:2048 sc1
  v_mfma_f32_16x16x32_bf16 a[32:35], a[152:155], v[40:43], a[32:35]
  ds_read_b64_tr_b16 a[196:197], v11 offset:8704
  v_mfma_f32_16x16x32_bf16 a[44:47], a[156:159], v[40:43], a[44:47]
  ds_read_b64_tr_b16 a[198:199], v11 offset:9728
  s_waitcnt lgkmcnt(12)
  v_mfma_f32_16x16x32_bf16 a[96:99], a[160:163], v[32:35], a[96:99]
  ds_read_b64_tr_b16 a[200:201], v5 offset:8960
  v_mfma_f32_16x16x32_bf16 a[108:111], a[164:167], v[32:35], a[108:111]
  ds_read_b64_tr_b16 a[202:203], v5 offset:9984
  v_mfma_f32_16x16x32_bf16 a[120:123], a[168:171], v[32:35], a[120:123]
  ds_read_b64_tr_b16 a[204:205], v11 offset:8960
  v_mfma_f32_16x16x32_bf16 a[132:135], a[172:175], v[32:35], a[132:135]
  ds_read_b64_tr_b16 a[206:207], v11 offset:9984
  v_mfma_f32_16x16x32_bf16 a[100:103], a[160:163], v[36:39], a[100:103]
  ds_read_b32 v248, v251 offset:20480
  v_add_u32 v5, 81920, v2
  v_mfma_f32_16x16x32_bf16 a[112:115], a[164:167], v[36:39], a[112:115]
  buffer_load_dwordx4 v[160:163], v19, s[16:19], s22 offen offset:2048 sc1
  v_xor_b32 v11, 8, v5
  v_mfma_f32_16x16x32_bf16 a[124:127], a[168:171], v[36:39], a[124:127]
  v_mfma_f32_16x16x32_bf16 a[136:139], a[172:175], v[36:39], a[136:139]
  v_mfma_f32_16x16x32_bf16 a[104:107], a[160:163], v[40:43], a[104:107]
  v_mfma_f32_16x16x32_bf16 a[116:119], a[164:167], v[40:43], a[116:119]
  v_mfma_f32_16x16x32_bf16 a[128:131], a[168:171], v[40:43], a[128:131]
  v_mfma_f32_16x16x32_bf16 a[140:143], a[172:175], v[40:43], a[140:143]
  s_waitcnt lgkmcnt(0)
  ds_write_b32 v249, v250 offset:0
  v_add_u32 v250, 1, v250
  v_readfirstlane_b32 s56, v248
  s_nop 1
  s_cmp_ge_u32 s56, s54
  s_cbranch_scc0 L_spin_u8
L_spun_u8:
  v_mfma_f32_16x16x32_bf16 a[0:3], a[176:179], v[44:47], a[0:3]
  ds_read_b64_tr_b16 a[144:145], v5 offset:0
  buffer_load_dwordx4 v[164:167], v9, s[16:19], s22 offen offset:3072 sc1
  v_mfma_f32_16x16x32_bf16 a[12:15], a[180:183], v[44:47], a[12:15]
  ds_read_b64_tr_b16 a[146:147], v5 offset:1024
  v_mfma_f32_16x16x32_bf16 a[24:27], a[184:187], v[44:47], a[24:27]
  ds_read_b64_tr_b16 a[148:149], v11 offset:0
  v_mfma_f32_16x16x32_bf16 a[36:39], a[188:191], v[44:47], a[36:39]
  ds_read_b64_tr_b16 a[150:151], v11 offset:1024
  v_mfma_f32_16x16x32_bf16 a[4:7], a[176:179], v[48:51], a[4:7]
  ds_read_b64_tr_b16 a[152:153], v5 offset:256
  v_mfma_f32_16x16x32_bf16 a[16:19], a[180:183], v[48:51], a[16:19]
  ds_read_b64_tr_b16 a[154:155], v5 offset:1280
  v_mfma_f32_16x16x32_bf16 a[28:31], a[184:187], v[48:51], a[28:31]
  ds_read_b64_tr_b16 a[156:157], v11 offset:256
  v_mfma_f32_16x16x32_bf16 a[40:43], a[188:191], v[48:51], a[40:43]
  ds_read_b64_tr_b16 a[158:159], v11 offset:1280
  buffer_load_dwordx4 v[168:171], v7, s[16:19], s22 offen offset:3072 sc1
  v_mfma_f32_16x16x32_bf16 a[8:11], a[176:179], v[52:55], a[8:11]
  ds_read_b64_tr_b16 a[160:161], v5 offset:512
  v_mfma_f32_16x16x32_bf16 a[20:23], a[180:183], v[52:55], a[20:23]
  ds_read_b64_tr_b16 a[162:163], v5 offset:1536
  v_mfma_f32_16x16x32_bf16 a[32:35], a[184:187], v[52:55], a[32:35]
  ds_read_b64_tr_b16 a[164:165], v11 offset:512
  v_mfma_f32_16x16x32_bf16 a[44:47], a[188:191], v[52:55], a[44:47]
  ds_read_b64_tr_b16 a[166:167], v11 offset:1536
  v_mfma_f32_16x16x32_bf16 a[96:99], a[192:195], v[44:47], a[96:99]
  ds_read_b64_tr_b16 a[168:169], v5 offset:768
  v_mfma_f32_16x16x32_bf16 a[108:111], a[196:199], v[44:47], a[108:111]
  ds_read_b64_tr_b16 a[170:171], v5 offset:1792
  v_mfma_f32_16x16x32_bf16 a[120:123], a[200:203], v[44:47], a[120:123]
  ds_read_b64_tr_b16 a[172:173], v11 offset:768
  buffer_load_dwordx4 v[172:175], v19, s[16:19], s22 offen offset:3072 sc1
  v_mfma_f32_16x16x32_bf16 a[132:135], a[204:207], v[44:47], a[132:135]
  ds_read_b64_tr_b16 a[174:175], v11 offset:1792
  v_mfma_f32_16x16x32_bf16 a[100:103], a[192:195], v[48:51], a[100:103]
  v_mfma_f32_16x16x32_bf16 a[112:115], a[196:199], v[48:51], a[112:115]
  v_mfma_f32_16x16x32_bf16 a[124:127], a[200:203], v[48:51], a[124:127]
  v_mfma_f32_16x16x32_bf16 a[136:139], a[204:207], v[48:51], a[136:139]
  v_mfma_f32_16x16x32_bf16 a[104:107], a[192:195], v[52:55], a[104:107]
  v_mfma_f32_16x16x32_bf16 a[116:119], a[196:199], v[52:55], a[116:119]
  v_mfma_f32_16x16x32_bf16 a[128:131], a[200:203], v[52:55], a[128:131]
  v_mfma_f32_16x16x32_bf16 a[140:143], a[204:207], v[52:55], a[140:143]
  s_waitcnt lgkmcnt(8)
  s_waitcnt vmcnt(6)
  s_mov_b64 exec, 1
  v_mov_b32 v252, s39
  buffer_store_dword v252, v9, s[40:43], s44 offen offset:128 sc1
  s_mov_b64 exec, -1
  v_mfma_f32_16x16x32_bf16 a[0:3], a[144:147], v[56:59], a[0:3]
  ds_read_b64_tr_b16 a[176:177], v5 offset:8192
  s_mov_b32 s54, 93
  v_mfma_f32_16x16x32_bf16 a[12:15], a[148:151], v[56:59], a[12:15]
  ds_read_b64_tr_b16 a[178:179], v5 offset:9216
  v_mfma_f32_16x16x32_bf16 a[24:27], a[152:155], v[56:59], a[24:27]
  ds_read_b64_tr_b16 a[180:181], v11 offset:8192
  buffer_load_dwordx4 v[176:179], v9, s[16:19], s23 offen offset:0 sc1
  v_mfma_f32_16x16x32_bf16 a[36:39], a[156:159], v[56:59], a[36:39]
  ds_read_b64_tr_b16 a[182:183], v11 offset:9216
  v_mfma_f32_16x16x32_bf16 a[4:7], a[144:147], v[60:63], a[4:7]
  ds_read_b64_tr_b16 a[184:185], v5 offset:8448
  v_mfma_f32_16x16x32_bf16 a[16:19], a[148:151], v[60:63], a[16:19]
  ds_read_b64_tr_b16 a[186:187], v5 offset:9472
  v_mfma_f32_16x16x32_bf16 a[28:31], a[152:155], v[60:63], a[28:31]
  ds_read_b64_tr_b16 a[188:189], v11 offset:8448
  v_mfma_f32_16x16x32_bf16 a[40:43], a[156:159], v[60:63], a[40:43]
  ds_read_b64_tr_b16 a[190:191], v11 offset:9472
  v_mfma_f32_16x16x32_bf16 a[8:11], a[144:147], v[64:67], a[8:11]
  ds_read_b64_tr_b16 a[192:193], v5 offset:8704
  v_mfma_f32_16x16x32_bf16 a[20:23], a[148:151], v[64:67], a[20:23]
  ds_read_b64_tr_b16 a[194:195], v5 offset:9728
  buffer_load_dwordx4 v[180:183], v7, s[16:19], s23 offen offset:0 sc1
  v_mfma_f32_16x16x32_bf16 a[32:35], a[152:155], v[64:67], a[32:35]
  ds_read_b64_tr_b16 a[196:197], v11 offset:8704
  v_mfma_f32_16x16x32_bf16 a[44:47], a[156:159], v[64:67], a[44:47]
  ds_read_b64_tr_b16 a[198:199], v11 offset:9728
  s_waitcnt lgkmcnt(12)
  v_mfma_f32_16x16x32_bf16 a[96:99], a[160:163], v[56:59], a[96:99]
  ds_read_b64_tr_b16 a[200:201], v5 offset:8960
  v_mfma_f32_16x16x32_bf16 a[108:111], a[164:167], v[56:59], a[108:111]
  ds_read_b64_tr_b16 a[202:203], v5 offset:9984
  v_mfma_f32_16x16x32_bf16 a[120:123], a[168:171], v[56:59], a[120:123]
  ds_read_b64_tr_b16 a[204:205], v11 offset:8960
  v_mfma_f32_16x16x32_bf16 a[132:135], a[172:175], v[56:59], a[132:135]
  ds_read_b64_tr_b16 a[206:207], v11 offset:9984
  v_mfma_f32_16x16x32_bf16 a[100:103], a[160:163], v[60:63], a[100:103]
  ds_read_b32 v248, v251 offset:20480
  v_add_u32 v5, 0, v2
  v_mfma_f32_16x16x32_bf16 a[112:115], a[164:167], v[60:63], a[112:115]
  buffer_load_dwordx4 v[184:187], v19, s[16:19], s23 offen offset:0 sc1
  v_xor_b32 v11, 8, v5
  v_mfma_f32_16x16x32_bf16 a[124:127], a[168:171], v[60:63], a[124:127]
  v_mfma_f32_16x16x32_bf16 a[136:139], a[172:175], v[60:63], a[136:139]
  v_mfma_f32_16x16x32_bf16 a[104:107], a[160:163], v[64:67], a[104:107]
  v_mfma_f32_16x16x32_bf16 a[116:119], a[164:167], v[64:67], a[116:119]
  v_mfma_f32_16x16x32_bf16 a[128:131], a[168:171], v[64:67], a[128:131]
  v_mfma_f32_16x16x32_bf16 a[140:143], a[172:175], v[64:67], a[140:143]
  s_waitcnt lgkmcnt(0)
  ds_write_b32 v249, v250 offset:0
  v_add_u32 v250, 1, v250
  v_readfirstlane_b32 s56, v248
  s_nop 1
  s_cmp_ge_u32 s56, s54
  s_cbranch_scc0 L_spin_u9
L_spun_u9:
  v_mfma_f32_16x16x32_bf16 a[0:3], a[176:179], v[68:71], a[0:3]
  ds_read_b64_tr_b16 a[144:145], v5 offset:0
  buffer_load_dwordx4 v[188:191], v9, s[16:19], s23 offen offset:1024 sc1
  v_mfma_f32_16x16x32_bf16 a[12:15], a[180:183], v[68:71], a[12:15]
  ds_read_b64_tr_b16 a[146:147], v5 offset:1024
  v_mfma_f32_16x16x32_bf16 a[24:27], a[184:187], v[68:71], a[24:27]
  ds_read_b64_tr_b16 a[148:149], v11 offset:0
  v_mfma_f32_16x16x32_bf16 a[36:39], a[188:191], v[68:71], a[36:39]
  ds_read_b64_tr_b16 a[150:151], v11 offset:1024
  v_mfma_f32_16x16x32_bf16 a[4:7], a[176:179], v[72:75], a[4:7]
  ds_read_b64_tr_b16 a[152:153], v5 offset:256
  v_mfma_f32_16x16x32_bf16 a[16:19], a[180:183], v[72:75], a[16:19]
  ds_read_b64_tr_b16 a[154:155], v5 offset:1280
  v_mfma_f32_16x16x32_bf16 a[28:31], a[184:187], v[72:75], a[28:31]
  ds_read_b64_tr_b16 a[156:157], v11 offset:256
  v_mfma_f32_16x16x32_bf16 a[40:43], a[188:191], v[72:75], a[40:43]
  ds_read_b64_tr_b16 a[158:159], v11 offset:1280
  buffer_load_dwordx4 v[192:195], v7, s[16:19], s23 offen offset:1024 sc1
  v_mfma_f32_16x16x32_bf16 a[8:11], a[176:179], v[76:79], a[8:11]
  ds_read_b64_tr_b16 a[160:161], v5 offset:512
  v_mfma_f32_16x16x32_bf16 a[20:23], a[180:183], v[76:79], a[20:23]
  ds_read_b64_tr_b16 a[162:163], v5 offset:1536
  v_mfma_f32_16x16x32_bf16 a[32:35], a[184:187], v[76:79], a[32:35]
  ds_read_b64_tr_b16 a[164:165], v11 offset:512
  v_mfma_f32_16x16x32_bf16 a[44:47], a[188:191], v[76:79], a[44:47]
  ds_read_b64_tr_b16 a[166:167], v11 offset:1536
  v_mfma_f32_16x16x32_bf16 a[96:99], a[192:195], v[68:71], a[96:99]
  ds_read_b64_tr_b16 a[168:169], v5 offset:768
  v_mfma_f32_16x16x32_bf16 a[108:111], a[196:199], v[68:71], a[108:111]
  ds_read_b64_tr_b16 a[170:171], v5 offset:1792
  v_mfma_f32_16x16x32_bf16 a[120:123], a[200:203], v[68:71], a[120:123]
  ds_read_b64_tr_b16 a[172:173], v11 offset:768
  buffer_load_dwordx4 v[196:199], v19, s[16:19], s23 offen offset:1024 sc1
  v_mfma_f32_16x16x32_bf16 a[132:135], a[204:207], v[68:71], a[132:135]
  ds_read_b64_tr_b16 a[174:175], v11 offset:1792
  v_mfma_f32_16x16x32_bf16 a[100:103], a[192:195], v[72:75], a[100:103]
  v_mfma_f32_16x16x32_bf16 a[112:115], a[196:199], v[72:75], a[112:115]
  v_mfma_f32_16x16x32_bf16 a[124:127], a[200:203], v[72:75], a[124:127]
  v_mfma_f32_16x16x32_bf16 a[136:139], a[204:207], v[72:75], a[136:139]
  v_mfma_f32_16x16x32_bf16 a[104:107], a[192:195], v[76:79], a[104:107]
  v_mfma_f32_16x16x32_bf16 a[116:119], a[196:199], v[76:79], a[116:119]
  v_mfma_f32_16x16x32_bf16 a[128:131], a[200:203], v[76:79], a[128:131]
  v_mfma_f32_16x16x32_bf16 a[140:143], a[204:207], v[76:79], a[140:143]
  s_waitcnt lgkmcnt(8)
  s_waitcnt vmcnt(36)
  v_mfma_f32_16x16x32_bf16 a[0:3], a[144:147], a[208:211], a[0:3]
  ds_read_b64_tr_b16 a[176:177], v5 offset:8192
  s_mov_b32 s54, 94
  v_mfma_f32_16x16x32_bf16 a[12:15], a[148:151], a[208:211], a[12:15]
  ds_read_b64_tr_b16 a[178:179], v5 offset:9216
  v_mfma_f32_16x16x32_bf16 a[24:27], a[152:155], a[208:211], a[24:27]
  ds_read_b64_tr_b16 a[180:181], v11 offset:8192
  buffer_load_dwordx4 v[200:203], v9, s[16:19], s23 offen offset:2048 sc1
  v_mfma_f32_16x16x32_bf16 a[36:39], a[156:159], a[208:211], a[36:39]
  ds_read_b64_tr_b16 a[182:183], v11 offset:9216
  v_mfma_f32_16x16x32_bf16 a[4:7], a[144:147], a[212:215], a[4:7]
  ds_read_b64_tr_b16 a[184:185], v5 offset:8448
  v_mfma_f32_16x16x32_bf16 a[16:19], a[148:151], a[212:215], a[16:19]
  ds_read_b64_tr_b16 a[186:187], v5 offset:9472
  v_mfma_f32_16x16x32_bf16 a[28:31], a[152:155], a[212:215], a[28:31]
  ds_read_b64_tr_b16 a[188:189], v11 offset:8448
  v_mfma_f32_16x16x32_bf16 a[40:43], a[156:159], a[212:215], a[40:43]
  ds_read_b64_tr_b16 a[190:191], v11 offset:9472
  v_mfma_f32_16x16x32_bf16 a[8:11], a[144:147], a[216:219], a[8:11]
  ds_read_b64_tr_b16 a[192:193], v5 offset:8704
  v_mfma_f32_16x16x32_bf16 a[20:23], a[148:151], a[216:219], a[20:23]
  ds_read_b64_tr_b16 a[194:195], v5 offset:9728
  buffer_load_dwordx4 v[204:207], v7, s[16:19], s23 offen offset:2048 sc1
  v_mfma_f32_16x16x32_bf16 a[32:35], a[152:155], a[216:219], a[32:35]
  ds_read_b64_tr_b16 a[196:197], v11 offset:8704
  v_mfma_f32_16x16x32_bf16 a[44:47], a[156:159], a[216:219], a[44:47]
  ds_read_b64_tr_b16 a[198:199], v11 offset:9728
  s_waitcnt lgkmcnt(12)
  v_mfma_f32_16x16x32_bf16 a[96:99], a[160:163], a[208:211], a[96:99]
  ds_read_b64_tr_b16 a[200:201], v5 offset:8960
  v_mfma_f32_16x16x32_bf16 a[108:111], a[164:167], a[208:211], a[108:111]
  ds_read_b64_tr_b16 a[202:203], v5 offset:9984
  v_mfma_f32_16x16x32_bf16 a[120:123], a[168:171], a[208:211], a[120:123]
  ds_read_b64_tr_b16 a[204:205], v11 offset:8960
  v_mfma_f32_16x16x32_bf16 a[132:135], a[172:175], a[208:211], a[132:135]
  ds_read_b64_tr_b16 a[206:207], v11 offset:9984
  v_mfma_f32_16x16x32_bf16 a[100:103], a[160:163], a[212:215], a[100:103]
  ds_read_b32 v248, v251 offset:20480
  v_add_u32 v5, 98304, v2
  v_mfma_f32_16x16x32_bf16 a[112:115], a[164:167], a[212:215], a[112:115]
  buffer_load_dwordx4 v[208:211], v19, s[16:19], s23 offen offset:2048 sc1
  v_xor_b32 v11, 8, v5
  v_mfma_f32_16x16x32_bf16 a[124:127], a[168:171], a[212:215], a[124:127]
  v_mfma_f32_16x16x32_bf16 a[136:139], a[172:175], a[212:215], a[136:139]
  v_mfma_f32_16x16x32_bf16 a[104:107], a[160:163], a[216:219], a[104:107]
  v_mfma_f32_16x16x32_bf16 a[116:119], a[164:167], a[216:219], a[116:119]
  v_mfma_f32_16x16x32_bf16 a[128:131], a[168:171], a[216:219], a[128:131]
  v_mfma_f32_16x16x32_bf16 a[140:143], a[172:175], a[216:219], a[140:143]
  s_waitcnt lgkmcnt(0)
  ds_write_b32 v249, v250 offset:0
  v_add_u32 v250, 1, v250
  v_readfirstlane_b32 s56, v248
  s_nop 1
  s_cmp_ge_u32 s56, s54
  s_cbranch_scc0 L_spin_u2
L_spun_u2:
  v_mfma_f32_16x16x32_bf16 a[0:3], a[176:179], a[220:223], a[0:3]
  ds_read_b64_tr_b16 a[144:145], v5 offset:0
  buffer_load_dwordx4 v[212:215], v9, s[16:19], s23 offen offset:3072 sc1
  v_mfma_f32_16x16x32_bf16 a[12:15], a[180:183], a[220:223], a[12:15]
  ds_read_b64_tr_b16 a[146:147], v5 offset:1024
  v_mfma_f32_16x16x32_bf16 a[24:27], a[184:187], a[220:223], a[24:27]
  ds_read_b64_tr_b16 a[148:149], v11 offset:0
  v_mfma_f32_16x16x32_bf16 a[36:39], a[188:191], a[220:223], a[36:39]
  ds_read_b64_tr_b16 a[150:151], v11 offset:1024
  v_mfma_f32_16x16x32_bf16 a[4:7], a[176:179], a[224:227], a[4:7]
  ds_read_b64_tr_b16 a[152:153], v5 offset:256
  v_mfma_f32_16x16x32_bf16 a[16:19], a[180:183], a[224:227], a[16:19]
  ds_read_b64_tr_b16 a[154:155], v5 offset:1280
  v_mfma_f32_16x16x32_bf16 a[28:31], a[184:187], a[224:227], a[28:31]
  ds_read_b64_tr_b16 a[156:157], v11 offset:256
  v_mfma_f32_16x16x32_bf16 a[40:43], a[188:191], a[224:227], a[40:43]
  ds_read_b64_tr_b16 a[158:159], v11 offset:1280
  buffer_load_dwordx4 v[216:219], v7, s[16:19], s23 offen offset:3072 sc1
  v_mfma_f32_16x16x32_bf16 a[8:11], a[176:179], a[228:231], a[8:11]
  ds_read_b64_tr_b16 a[160:161], v5 offset:512
  v_mfma_f32_16x16x32_bf16 a[20:23], a[180:183], a[228:231], a[20:23]
  ds_read_b64_tr_b16 a[162:163], v5 offset:1536
  v_mfma_f32_16x16x32_bf16 a[32:35], a[184:187], a[228:231], a[32:35]
  ds_read_b64_tr_b16 a[164:165], v11 offset:512
  v_mfma_f32_16x16x32_bf16 a[44:47], a[188:191], a[228:231], a[44:47]
  ds_read_b64_tr_b16 a[166:167], v11 offset:1536
  v_mfma_f32_16x16x32_bf16 a[96:99], a[192:195], a[220:223], a[96:99]
  ds_read_b64_tr_b16 a[168:169], v5 offset:768
  v_mfma_f32_16x16x32_bf16 a[108:111], a[196:199], a[220:223], a[108:111]
  ds_read_b64_tr_b16 a[170:171], v5 offset:1792
  v_mfma_f32_16x16x32_bf16 a[120:123], a[200:203], a[220:223], a[120:123]
  ds_read_b64_tr_b16 a[172:173], v11 offset:768
  buffer_load_dwordx4 v[220:223], v19, s[16:19], s23 offen offset:3072 sc1
  v_mfma_f32_16x16x32_bf16 a[132:135], a[204:207], a[220:223], a[132:135]
  ds_read_b64_tr_b16 a[174:175], v11 offset:1792
  v_mfma_f32_16x16x32_bf16 a[100:103], a[192:195], a[224:227], a[100:103]
  v_mfma_f32_16x16x32_bf16 a[112:115], a[196:199], a[224:227], a[112:115]
  v_mfma_f32_16x16x32_bf16 a[124:127], a[200:203], a[224:227], a[124:127]
  v_mfma_f32_16x16x32_bf16 a[136:139], a[204:207], a[224:227], a[136:139]
  v_mfma_f32_16x16x32_bf16 a[104:107], a[192:195], a[228:231], a[104:107]
  v_mfma_f32_16x16x32_bf16 a[116:119], a[196:199], a[228:231], a[116:119]
  v_mfma_f32_16x16x32_bf16 a[128:131], a[200:203], a[228:231], a[128:131]
  v_mfma_f32_16x16x32_bf16 a[140:143], a[204:207], a[228:231], a[140:143]
  s_waitcnt lgkmcnt(8)
  s_waitcnt vmcnt(36)
  v_mfma_f32_16x16x32_bf16 a[0:3], a[144:147], a[232:235], a[0:3]
  ds_read_b64_tr_b16 a[176:177], v5 offset:8192
  s_mov_b32 s54, 95
  v_mfma_f32_16x16x32_bf16 a[12:15], a[148:151], a[232:235], a[12:15]
  ds_read_b64_tr_b16 a[178:179], v5 offset:9216
  v_mfma_f32_16x16x32_bf16 a[24:27], a[152:155], a[232:235], a[24:27]
  ds_read_b64_tr_b16 a[180:181], v11 offset:8192
  v_mfma_f32_16x16x32_bf16 a[36:39], a[156:159], a[232:235], a[36:39]
  ds_read_b64_tr_b16 a[182:183], v11 offset:9216
  v_mfma_f32_16x16x32_bf16 a[4:7], a[144:147], a[236:239], a[4:7]
  ds_read_b64_tr_b16 a[184:185], v5 offset:8448
  v_mfma_f32_16x16x32_bf16 a[16:19], a[148:151], a[236:239], a[16:19]
  ds_read_b64_tr_b16 a[186:187], v5 offset:9472
  v_mfma_f32_16x16x32_bf16 a[28:31], a[152:155], a[236:239], a[28:31]
  ds_read_b64_tr_b16 a[188:189], v11 offset:8448
  v_mfma_f32_16x16x32_bf16 a[40:43], a[156:159], a[236:239], a[40:43]
  ds_read_b64_tr_b16 a[190:191], v11 offset:9472
  v_mfma_f32_16x16x32_bf16 a[8:11], a[144:147], a[240:243], a[8:11]
  ds_read_b64_tr_b16 a[192:193], v5 offset:8704
  v_mfma_f32_16x16x32_bf16 a[20:23], a[148:151], a[240:243], a[20:23]
  ds_read_b64_tr_b16 a[194:195], v5 offset:9728
  v_mfma_f32_16x16x32_bf16 a[32:35], a[152:155], a[240:243], a[32:35]
  ds_read_b64_tr_b16 a[196:197], v11 offset:8704
  v_mfma_f32_16x16x32_bf16 a[44:47], a[156:159], a[240:243], a[44:47]
  ds_read_b64_tr_b16 a[198:199], v11 offset:9728
  s_waitcnt lgkmcnt(12)
  v_mfma_f32_16x16x32_bf16 a[96:99], a[160:163], a[232:235], a[96:99]
  ds_read_b64_tr_b16 a[200:201], v5 offset:8960
  v_mfma_f32_16x16x32_bf16 a[108:111], a[164:167], a[232:235], a[108:111]
  ds_read_b64_tr_b16 a[202:203], v5 offset:9984
  v_mfma_f32_16x16x32_bf16 a[120:123], a[168:171], a[232:235], a[120:123]
  ds_read_b64_tr_b16 a[204:205], v11 offset:8960
  v_mfma_f32_16x16x32_bf16 a[132:135], a[172:175], a[232:235], a[132:135]
  ds_read_b64_tr_b16 a[206:207], v11 offset:9984
  v_mfma_f32_16x16x32_bf16 a[100:103], a[160:163], a[236:239], a[100:103]
  ds_read_b32 v248, v251 offset:20480
  v_add_u32 v5, 16384, v2
  v_mfma_f32_16x16x32_bf16 a[112:115], a[164:167], a[236:239], a[112:115]
  v_xor_b32 v11, 8, v5
  v_mfma_f32_16x16x32_bf16 a[124:127], a[168:171], a[236:239], a[124:127]
  v_mfma_f32_16x16x32_bf16 a[136:139], a[172:175], a[236:239], a[136:139]
  v_mfma_f32_16x16x32_bf16 a[104:107], a[160:163], a[240:243], a[104:107]
  v_mfma_f32_16x16x32_bf16 a[116:119], a[164:167], a[240:243], a[116:119]
  v_mfma_f32_16x16x32_bf16 a[128:131], a[168:171], a[240:243], a[128:131]
  v_mfma_f32_16x16x32_bf16 a[140:143], a[172:175], a[240:243], a[140:143]
  s_waitcnt lgkmcnt(0)
  ds_write_b32 v249, v250 offset:0
  v_add_u32 v250, 1, v250
  v_readfirstlane_b32 s56, v248
  s_nop 1
  s_cmp_ge_u32 s56, s54
  s_cbranch_scc0 L_spin_u3
L_spun_u3:
  v_mfma_f32_16x16x32_bf16 a[0:3], a[176:179], a[244:247], a[0:3]
  ds_read_b64_tr_b16 a[144:145], v5 offset:0
  v_mfma_f32_16x16x32_bf16 a[12:15], a[180:183], a[244:247], a[12:15]
  ds_read_b64_tr_b16 a[146:147], v5 offset:1024
  v_mfma_f32_16x16x32_bf16 a[24:27], a[184:187], a[244:247], a[24:27]
  ds_read_b64_tr_b16 a[148:149], v11 offset:0
  v_mfma_f32_16x16x32_bf16 a[36:39], a[188:191], a[244:247], a[36:39]
  ds_read_b64_tr_b16 a[150:151], v11 offset:1024
  v_mfma_f32_16x16x32_bf16 a[4:7], a[176:179], a[248:251], a[4:7]
  ds_read_b64_tr_b16 a[152:153], v5 offset:256
  v_mfma_f32_16x16x32_bf16 a[16:19], a[180:183], a[248:251], a[16:19]
  ds_read_b64_tr_b16 a[154:155], v5 offset:1280
  v_mfma_f32_16x16x32_bf16 a[28:31], a[184:187], a[248:251], a[28:31]
  ds_read_b64_tr_b16 a[156:157], v11 offset:256
  v_mfma_f32_16x16x32_bf16 a[40:43], a[188:191], a[248:251], a[40:43]
  ds_read_b64_tr_b16 a[158:159], v11 offset:1280
  v_mfma_f32_16x16x32_bf16 a[8:11], a[176:179], a[252:255], a[8:11]
  ds_read_b64_tr_b16 a[160:161], v5 offset:512
  v_mfma_f32_16x16x32_bf16 a[20:23], a[180:183], a[252:255], a[20:23]
  ds_read_b64_tr_b16 a[162:163], v5 offset:1536
  v_mfma_f32_16x16x32_bf16 a[32:35], a[184:187], a[252:255], a[32:35]
  ds_read_b64_tr_b16 a[164:165], v11 offset:512
  v_mfma_f32_16x16x32_bf16 a[44:47], a[188:191], a[252:255], a[44:47]
  ds_read_b64_tr_b16 a[166:167], v11 offset:1536
  v_mfma_f32_16x16x32_bf16 a[96:99], a[192:195], a[244:247], a[96:99]
  ds_read_b64_tr_b16 a[168:169], v5 offset:768
  v_mfma_f32_16x16x32_bf16 a[108:111], a[196:199], a[244:247], a[108:111]
  ds_read_b64_tr_b16 a[170:171], v5 offset:1792
  v_mfma_f32_16x16x32_bf16 a[120:123], a[200:203], a[244:247], a[120:123]
  ds_read_b64_tr_b16 a[172:173], v11 offset:768
  v_mfma_f32_16x16x32_bf16 a[132:135], a[204:207], a[244:247], a[132:135]
  ds_read_b64_tr_b16 a[174:175], v11 offset:1792
  v_mfma_f32_16x16x32_bf16 a[100:103], a[192:195], a[248:251], a[100:103]
  v_mfma_f32_16x16x32_bf16 a[112:115], a[196:199], a[248:251], a[112:115]
  v_mfma_f32_16x16x32_bf16 a[124:127], a[200:203], a[248:251], a[124:127]
  v_mfma_f32_16x16x32_bf16 a[136:139], a[204:207], a[248:251], a[136:139]
  v_mfma_f32_16x16x32_bf16 a[104:107], a[192:195], a[252:255], a[104:107]
  v_mfma_f32_16x16x32_bf16 a[116:119], a[196:199], a[252:255], a[116:119]
  v_mfma_f32_16x16x32_bf16 a[128:131], a[200:203], a[252:255], a[128:131]
  v_mfma_f32_16x16x32_bf16 a[140:143], a[204:207], a[252:255], a[140:143]
  s_waitcnt lgkmcnt(8)
  s_waitcnt vmcnt(19)
  v_mfma_f32_16x16x32_bf16 a[0:3], a[144:147], v[128:131], a[0:3]
  ds_read_b64_tr_b16 a[176:177], v5 offset:8192
  s_mov_b32 s54, 96
  v_mfma_f32_16x16x32_bf16 a[12:15], a[148:151], v[128:131], a[12:15]
  ds_read_b64_tr_b16 a[178:179], v5 offset:9216
  s_mov_b64 exec, 1
  buffer_load_dwordx4 v[252:255], v9, s[40:43], s10 offen offset:128 sc1
  s_mov_b64 exec, -1
  v_mfma_f32_16x16x32_bf16 a[24:27], a[152:155], v[128:131], a[24:27]
  ds_read_b64_tr_b16 a[180:181], v11 offset:8192
  v_mfma_f32_16x16x32_bf16 a[36:39], a[156:159], v[128:131], a[36:39]
  ds_read_b64_tr_b16 a[182:183], v11 offset:9216
  v_mfma_f32_16x16x32_bf16 a[4:7], a[144:147], v[132:135], a[4:7]
  ds_read_b64_tr_b16 a[184:185], v5 offset:8448
  v_mfma_f32_16x16x32_bf16 a[16:19], a[148:151], v[132:135], a[16:19]
  ds_read_b64_tr_b16 a[186:187], v5 offset:9472
  v_mfma_f32_16x16x32_bf16 a[28:31], a[152:155], v[132:135], a[28:31]
  ds_read_b64_tr_b16 a[188:189], v11 offset:8448
  v_mfma_f32_16x16x32_bf16 a[40:43], a[156:159], v[132:135], a[40:43]
  ds_read_b64_tr_b16 a[190:191], v11 offset:9472
  v_mfma_f32_16x16x32_bf16 a[8:11], a[144:147], v[136:139], a[8:11]
  ds_read_b64_tr_b16 a[192:193], v5 offset:8704
  v_mfma_f32_16x16x32_bf16 a[20:23], a[148:151], v[136:139], a[20:23]
  ds_read_b64_tr_b16 a[194:195], v5 offset:9728
  v_mfma_f32_16x16x32_bf16 a[32:35], a[152:155], v[136:139], a[32:35]
  ds_read_b64_tr_b16 a[196:197], v11 offset:8704
  v_mfma_f32_16x16x32_bf16 a[44:47], a[156:159], v[136:139], a[44:47]
  ds_read_b64_tr_b16 a[198:199], v11 offset:9728
  s_waitcnt lgkmcnt(12)
  v_mfma_f32_16x16x32_bf16 a[96:99], a[160:163], v[128:131], a[96:99]
  ds_read_b64_tr_b16 a[200:201], v5 offset:8960
  v_mfma_f32_16x16x32_bf16 a[108:111], a[164:167], v[128:131], a[108:111]
  ds_read_b64_tr_b16 a[202:203], v5 offset:9984
  v_mfma_f32_16x16x32_bf16 a[120:123], a[168:171], v[128:131], a[120:123]
  ds_read_b64_tr_b16 a[204:205], v11 offset:8960
  v_mfma_f32_16x16x32_bf16 a[132:135], a[172:175], v[128:131], a[132:135]
  ds_read_b64_tr_b16 a[206:207], v11 offset:9984
  v_mfma_f32_16x16x32_bf16 a[100:103], a[160:163], v[132:135], a[100:103]
  ds_read_b32 v248, v251 offset:20480
  v_add_u32 v5, 114688, v2
  v_mfma_f32_16x16x32_bf16 a[112:115], a[164:167], v[132:135], a[112:115]
  v_xor_b32 v11, 8, v5
  v_mfma_f32_16x16x32_bf16 a[124:127], a[168:171], v[132:135], a[124:127]
  v_mfma_f32_16x16x32_bf16 a[136:139], a[172:175], v[132:135], a[136:139]
  v_mfma_f32_16x16x32_bf16 a[104:107], a[160:163], v[136:139], a[104:107]
  v_mfma_f32_16x16x32_bf16 a[116:119], a[164:167], v[136:139], a[116:119]
  v_mfma_f32_16x16x32_bf16 a[128:131], a[168:171], v[136:139], a[128:131]
  v_mfma_f32_16x16x32_bf16 a[140:143], a[172:175], v[136:139], a[140:143]
  s_waitcnt lgkmcnt(0)
  ds_write_b32 v249, v250 offset:0
  v_add_u32 v250, 1, v250
  v_readfirstlane_b32 s56, v248
  s_nop 1
  s_cmp_ge_u32 s56, s54
  s_cbranch_scc0 L_spin_u4
L_spun_u4:
  v_mfma_f32_16x16x32_bf16 a[0:3], a[176:179], v[140:143], a[0:3]
  ds_read_b64_tr_b16 a[144:145], v5 offset:0
  v_mfma_f32_16x16x32_bf16 a[12:15], a[180:183], v[140:143], a[12:15]
  ds_read_b64_tr_b16 a[146:147], v5 offset:1024
  v_mfma_f32_16x16x32_bf16 a[24:27], a[184:187], v[140:143], a[24:27]
  ds_read_b64_tr_b16 a[148:149], v11 offset:0
  v_mfma_f32_16x16x32_bf16 a[36:39], a[188:191], v[140:143], a[36:39]
  ds_read_b64_tr_b16 a[150:151], v11 offset:1024
  v_mfma_f32_16x16x32_bf16 a[4:7], a[176:179], v[144:147], a[4:7]
  ds_read_b64_tr_b16 a[152:153], v5 offset:256
  v_mfma_f32_16x16x32_bf16 a[16:19], a[180:183], v[144:147], a[16:19]
  ds_read_b64_tr_b16 a[154:155], v5 offset:1280
  v_mfma_f32_16x16x32_bf16 a[28:31], a[184:187], v[144:147], a[28:31]
  ds_read_b64_tr_b16 a[156:157], v11 offset:256
  v_mfma_f32_16x16x32_bf16 a[40:43], a[188:191], v[144:147], a[40:43]
  ds_read_b64_tr_b16 a[158:159], v11 offset:1280
  v_mfma_f32_16x16x32_bf16 a[8:11], a[176:179], v[148:151], a[8:11]
  ds_read_b64_tr_b16 a[160:161], v5 offset:512
  v_mfma_f32_16x16x32_bf16 a[20:23], a[180:183], v[148:151], a[20:23]
  ds_read_b64_tr_b16 a[162:163], v5 offset:1536
  v_mfma_f32_16x16x32_bf16 a[32:35], a[184:187], v[148:151], a[32:35]
  ds_read_b64_tr_b16 a[164:165], v11 offset:512
  v_mfma_f32_16x16x32_bf16 a[44:47], a[188:191], v[148:151], a[44:47]
  ds_read_b64_tr_b16 a[166:167], v11 offset:1536
  v_mfma_f32_16x16x32_bf16 a[96:99], a[192:195], v[140:143], a[96:99]
  ds_read_b64_tr_b16 a[168:169], v5 offset:768
  v_mfma_f32_16x16x32_bf16 a[108:111], a[196:199], v[140:143], a[108:111]
  ds_read_b64_tr_b16 a[170:171], v5 offset:1792
  v_mfma_f32_16x16x32_bf16 a[120:123], a[200:203], v[140:143], a[120:123]
  ds_read_b64_tr_b16 a[172:173], v11 offset:768
  v_mfma_f32_16x16x32_bf16 a[132:135], a[204:207], v[140:143], a[132:135]
  ds_read_b64_tr_b16 a[174:175], v11 offset:1792
  v_mfma_f32_16x16x32_bf16 a[100:103], a[192:195], v[144:147], a[100:103]
  v_mfma_f32_16x16x32_bf16 a[112:115], a[196:199], v[144:147], a[112:115]
  v_mfma_f32_16x16x32_bf16 a[124:127], a[200:203], v[144:147], a[124:127]
  v_mfma_f32_16x16x32_bf16 a[136:139], a[204:207], v[144:147], a[136:139]
  v_mfma_f32_16x16x32_bf16 a[104:107], a[192:195], v[148:151], a[104:107]
  v_mfma_f32_16x16x32_bf16 a[116:119], a[196:199], v[148:151], a[116:119]
  v_mfma_f32_16x16x32_bf16 a[128:131], a[200:203], v[148:151], a[128:131]
  v_mfma_f32_16x16x32_bf16 a[140:143], a[204:207], v[148:151], a[140:143]
  s_waitcnt lgkmcnt(8)
  s_waitcnt vmcnt(13)
  s_waitcnt vmcnt(0)
  v_xor_b32 v252, s39, v252
  v_xor_b32 v253, s39, v253
  v_xor_b32 v254, s39, v254
  v_xor_b32 v255, s39, v255
  v_or3_b32 v252, v252, v253, v254
  v_or_b32 v252, v252, v255
  s_nop 0
  v_readfirstlane_b32 s63, v252
  s_nop 1
  s_cmp_eq_u32 s63, 0
  s_cbranch_scc0 L_gspin_pl1
L_gspun_pl1:
  v_mfma_f32_16x16x32_bf16 a[0:3], a[144:147], v[152:155], a[0:3]
  ds_read_b64_tr_b16 a[176:177], v5 offset:8192
  s_mov_b32 s54, 97
  v_mfma_f32_16x16x32_bf16 a[12:15], a[148:151], v[152:155], a[12:15]
  ds_read_b64_tr_b16 a[178:179], v5 offset:9216
  v_mfma_f32_16x16x32_bf16 a[24:27], a[152:155], v[152:155], a[24:27]
  ds_read_b64_tr_b16 a[180:181], v11 offset:8192
  buffer_load_dwordx4 v[224:227], v9, s[16:19], s34 offen offset:0 sc1
  v_mfma_f32_16x16x32_bf16 a[36:39], a[156:159], v[152:155], a[36:39]
  ds_read_b64_tr_b16 a[182:183], v11 offset:9216
  v_mfma_f32_16x16x32_bf16 a[4:7], a[144:147], v[156:159], a[4:7]
  ds_read_b64_tr_b16 a[184:185], v5 offset:8448
  v_mfma_f32_16x16x32_bf16 a[16:19], a[148:151], v[156:159], a[16:19]
  ds_read_b64_tr_b16 a[186:187], v5 offset:9472
  v_mfma_f32_16x16x32_bf16 a[28:31], a[152:155], v[156:159], a[28:31]
  ds_read_b64_tr_b16 a[188:189], v11 offset:8448
  v_mfma_f32_16x16x32_bf16 a[40:43], a[156:159], v[156:159], a[40:43]
  ds_read_b64_tr_b16 a[190:191], v11 offset:9472
  v_mfma_f32_16x16x32_bf16 a[8:11], a[144:147], v[160:163], a[8:11]
  ds_read_b64_tr_b16 a[192:193], v5 offset:8704
  v_mfma_f32_16x16x32_bf16 a[20:23], a[148:151], v[160:163], a[20:23]
  ds_read_b64_tr_b16 a[194:195], v5 offset:9728
  buffer_load_dwordx4 v[228:231], v7, s[16:19], s34 offen offset:0 sc1
  v_mfma_f32_16x16x32_bf16 a[32:35], a[152:155], v[160:163], a[32:35]
  ds_read_b64_tr_b16 a[196:197], v11 offset:8704
  v_mfma_f32_16x16x32_bf16 a[44:47], a[156:159], v[160:163], a[44:47]
  ds_read_b64_tr_b16 a[198:199], v11 offset:9728
  s_waitcnt lgkmcnt(12)
  v_mfma_f32_16x16x32_bf16 a[96:99], a[160:163], v[152:155], a[96:99]
  ds_read_b64_tr_b16 a[200:201], v5 offset:8960
  v_mfma_f32_16x16x32_bf16 a[108:111], a[164:167], v[152:155], a[108:111]
  ds_read_b64_tr_b16 a[202:203], v5 offset:9984
  v_mfma_f32_16x16x32_bf16 a[120:123], a[168:171], v[152:155], a[120:123]
  ds_read_b64_tr_b16 a[204:205], v11 offset:8960
  v_mfma_f32_16x16x32_bf16 a[132:135], a[172:175], v[152:155], a[132:135]
  ds_read_b64_tr_b16 a[206:207], v11 offset:9984
  v_mfma_f32_16x16x32_bf16 a[100:103], a[160:163], v[156:159], a[100:103]
  ds_read_b32 v248, v251 offset:20480
  v_add_u32 v5, 131072, v2
  v_mfma_f32_16x16x32_bf16 a[112:115], a[164:167], v[156:159], a[112:115]
  buffer_load_dwordx4 v[232:235], v19, s[16:19], s34 offen offset:0 sc1
  v_xor_b32 v11, 8, v5
  v_mfma_f32_16x16x32_bf16 a[124:127], a[168:171], v[156:159], a[124:127]
  v_mfma_f32_16x16x32_bf16 a[136:139], a[172:175], v[156:159], a[136:139]
  v_mfma_f32_16x16x32_bf16 a[104:107], a[160:163], v[160:163], a[104:107]
  v_mfma_f32_16x16x32_bf16 a[116:119], a[164:167], v[160:163], a[116:119]
  v_mfma_f32_16x16x32_bf16 a[128:131], a[168:171], v[160:163], a[128:131]
  v_mfma_f32_16x16x32_bf16 a[140:143], a[172:175], v[160:163], a[140:143]
  s_waitcnt lgkmcnt(0)
  ds_write_b32 v249, v250 offset:0
  v_add_u32 v250, 1, v250
  v_readfirstlane_b32 s56, v248
  s_nop 1
  s_cmp_ge_u32 s56, s54
  s_cbranch_scc0 L_spin_u5
L_spun_u5:
  v_mfma_f32_16x16x32_bf16 a[0:3], a[176:179], v[164:167], a[0:3]
  ds_read_b64_tr_b16 a[144:145], v5 offset:0
  buffer_load_dwordx4 v[236:239], v9, s[16:19], s34 offen offset:1024 sc1
  v_mfma_f32_16x16x32_bf16 a[12:15], a[180:183], v[164:167], a[12:15]
  ds_read_b64_tr_b16 a[146:147], v5 offset:1024
  v_mfma_f32_16x16x32_bf16 a[24:27], a[184:187], v[164:167], a[24:27]
  ds_read_b64_tr_b16 a[148:149], v11 offset:0
  v_mfma_f32_16x16x32_bf16 a[36:39], a[188:191], v[164:167], a[36:39]
  ds_read_b64_tr_b16 a[150:151], v11 offset:1024
  v_mfma_f32_16x16x32_bf16 a[4:7], a[176:179], v[168:171], a[4:7]
  ds_read_b64_tr_b16 a[152:153], v5 offset:256
  v_mfma_f32_16x16x32_bf16 a[16:19], a[180:183], v[168:171], a[16:19]
  ds_read_b64_tr_b16 a[154:155], v5 offset:1280
  v_mfma_f32_16x16x32_bf16 a[28:31], a[184:187], v[168:171], a[28:31]
  ds_read_b64_tr_b16 a[156:157], v11 offset:256
  v_mfma_f32_16x16x32_bf16 a[40:43], a[188:191], v[168:171], a[40:43]
  ds_read_b64_tr_b16 a[158:159], v11 offset:1280
  buffer_load_dwordx4 v[240:243], v7, s[16:19], s34 offen offset:1024 sc1
  v_mfma_f32_16x16x32_bf16 a[8:11], a[176:179], v[172:175], a[8:11]
  ds_read_b64_tr_b16 a[160:161], v5 offset:512
  v_mfma_f32_16x16x32_bf16 a[20:23], a[180:183], v[172:175], a[20:23]
  ds_read_b64_tr_b16 a[162:163], v5 offset:1536
  v_mfma_f32_16x16x32_bf16 a[32:35], a[184:187], v[172:175], a[32:35]
  ds_read_b64_tr_b16 a[164:165], v11 offset:512
  v_mfma_f32_16x16x32_bf16 a[44:47], a[188:191], v[172:175], a[44:47]
  ds_read_b64_tr_b16 a[166:167], v11 offset:1536
  v_mfma_f32_16x16x32_bf16 a[96:99], a[192:195], v[164:167], a[96:99]
  ds_read_b64_tr_b16 a[168:169], v5 offset:768
  v_mfma_f32_16x16x32_bf16 a[108:111], a[196:199], v[164:167], a[108:111]
  ds_read_b64_tr_b16 a[170:171], v5 offset:1792
  v_mfma_f32_16x16x32_bf16 a[120:123], a[200:203], v[164:167], a[120:123]
  ds_read_b64_tr_b16 a[172:173], v11 offset:768
  buffer_load_dwordx4 v[244:247], v19, s[16:19], s34 offen offset:1024 sc1
  v_mfma_f32_16x16x32_bf16 a[132:135], a[204:207], v[164:167], a[132:135]
  ds_read_b64_tr_b16 a[174:175], v11 offset:1792
  v_mfma_f32_16x16x32_bf16 a[100:103], a[192:195], v[168:171], a[100:103]
  v_mfma_f32_16x16x32_bf16 a[112:115], a[196:199], v[168:171], a[112:115]
  v_mfma_f32_16x16x32_bf16 a[124:127], a[200:203], v[168:171], a[124:127]
  v_mfma_f32_16x16x32_bf16 a[136:139], a[204:207], v[168:171], a[136:139]
  v_mfma_f32_16x16x32_bf16 a[104:107], a[192:195], v[172:175], a[104:107]
  v_mfma_f32_16x16x32_bf16 a[116:119], a[196:199], v[172:175], a[116:119]
  v_mfma_f32_16x16x32_bf16 a[128:131], a[200:203], v[172:175], a[128:131]
  v_mfma_f32_16x16x32_bf16 a[140:143], a[204:207], v[172:175], a[140:143]
  s_waitcnt lgkmcnt(8)
  s_waitcnt vmcnt(13)
  v_mfma_f32_16x16x32_bf16 a[0:3], a[144:147], v[176:179], a[0:3]
  ds_read_b64_tr_b16 a[176:177], v5 offset:8192
  s_mov_b32 s54, 98
  v_mfma_f32_16x16x32_bf16 a[12:15], a[148:151], v[176:179], a[12:15]
  ds_read_b64_tr_b16 a[178:179], v5 offset:9216
  v_mfma_f32_16x16x32_bf16 a[24:27], a[152:155], v[176:179], a[24:27]
  ds_read_b64_tr_b16 a[180:181], v11 offset:8192
  buffer_load_dwordx4 v[32:35], v9, s[16:19], s34 offen offset:2048 sc1
  v_mfma_f32_16x16x32_bf16 a[36:39], a[156:159], v[176:179], a[36:39]
  ds_read_b64_tr_b16 a[182:183], v11 offset:9216
  v_mfma_f32_16x16x32_bf16 a[4:7], a[144:147], v[180:183], a[4:7]
  ds_read_b64_tr_b16 a[184:185], v5 offset:8448
  v_mfma_f32_16x16x32_bf16 a[16:19], a[148:151], v[180:183], a[16:19]
  ds_read_b64_tr_b16 a[186:187], v5 offset:9472
  v_mfma_f32_16x16x32_bf16 a[28:31], a[152:155], v[180:183], a[28:31]
  ds_read_b64_tr_b16 a[188:189], v11 offset:8448
  v_mfma_f32_16x16x32_bf16 a[40:43], a[156:159], v[180:183], a[40:43]
  ds_read_b64_tr_b16 a[190:191], v11 offset:9472
  v_mfma_f32_16x16x32_bf16 a[8:11], a[144:147], v[184:187], a[8:11]
  ds_read_b64_tr_b16 a[192:193], v5 offset:8704
  v_mfma_f32_16x16x32_bf16 a[20:23], a[148:151], v[184:187], a[20:23]
  ds_read_b64_tr_b16 a[194:195], v5 offset:9728
  buffer_load_dwordx4 v[36:39], v7, s[16:19], s34 offen offset:2048 sc1
  v_mfma_f32_16x16x32_bf16 a[32:35], a[152:155], v[184:187], a[32:35]
  ds_read_b64_tr_b16 a[196:197], v11 offset:8704
  v_mfma_f32_16x16x32_bf16 a[44:47], a[156:159], v[184:187], a[44:47]
  ds_read_b64_tr_b16 a[198:199], v11 offset:9728
  s_waitcnt lgkmcnt(12)
  v_mfma_f32_16x16x32_bf16 a[96:99], a[160:163], v[176:179], a[96:99]
  ds_read_b64_tr_b16 a[200:201], v5 offset:8960
  v_mfma_f32_16x16x32_bf16 a[108:111], a[164:167], v[176:179], a[108:111]
  ds_read_b64_tr_b16 a[202:203], v5 offset:9984
  v_mfma_f32_16x16x32_bf16 a[120:123], a[168:171], v[176:179], a[120:123]
  ds_read_b64_tr_b16 a[204:205], v11 offset:8960
  v_mfma_f32_16x16x32_bf16 a[132:135], a[172:175], v[176:179], a[132:135]
  ds_read_b64_tr_b16 a[206:207], v11 offset:9984
  v_mfma_f32_16x16x32_bf16 a[100:103], a[160:163], v[180:183], a[100:103]
  ds_read_b32 v248, v251 offset:20480
  v_add_u32 v5, 32768, v2
  v_mfma_f32_16x16x32_bf16 a[112:115], a[164:167], v[180:183], a[112:115]
  buffer_load_dwordx4 v[40:43], v19, s[16:19], s34 offen offset:2048 sc1
  v_xor_b32 v11, 8, v5
  v_mfma_f32_16x16x32_bf16 a[124:127], a[168:171], v[180:183], a[124:127]
  v_mfma_f32_16x16x32_bf16 a[136:139], a[172:175], v[180:183], a[136:139]
  v_mfma_f32_16x16x32_bf16 a[104:107], a[160:163], v[184:187], a[104:107]
  v_mfma_f32_16x16x32_bf16 a[116:119], a[164:167], v[184:187], a[116:119]
  v_mfma_f32_16x16x32_bf16 a[128:131], a[168:171], v[184:187], a[128:131]
  v_mfma_f32_16x16x32_bf16 a[140:143], a[172:175], v[184:187], a[140:143]
  s_waitcnt lgkmcnt(0)
  ds_write_b32 v249, v250 offset:0
  v_add_u32 v250, 1, v250
  v_readfirstlane_b32 s56, v248
  s_nop 1
  s_cmp_ge_u32 s56, s54
  s_cbranch_scc0 L_spin_u6
L_spun_u6:
  v_mfma_f32_16x16x32_bf16 a[0:3], a[176:179], v[188:191], a[0:3]
  ds_read_b64_tr_b16 a[144:145], v5 offset:0
  buffer_load_dwordx4 v[44:47], v9, s[16:19], s34 offen offset:3072 sc1
  v_mfma_f32_16x16x32_bf16 a[12:15], a[180:183], v[188:191], a[12:15]
  ds_read_b64_tr_b16 a[146:147], v5 offset:1024
  v_mfma_f32_16x16x32_bf16 a[24:27], a[184:187], v[188:191], a[24:27]
  ds_read_b64_tr_b16 a[148:149], v11 offset:0
  v_mfma_f32_16x16x32_bf16 a[36:39], a[188:191], v[188:191], a[36:39]
  ds_read_b64_tr_b16 a[150:151], v11 offset:1024
  v_mfma_f32_16x16x32_bf16 a[4:7], a[176:179], v[192:195], a[4:7]
  ds_read_b64_tr_b16 a[152:153], v5 offset:256
  v_mfma_f32_16x16x32_bf16 a[16:19], a[180:183], v[192:195], a[16:19]
  ds_read_b64_tr_b16 a[154:155], v5 offset:1280
  v_mfma_f32_16x16x32_bf16 a[28:31], a[184:187], v[192:195], a[28:31]
  ds_read_b64_tr_b16 a[156:157], v11 offset:256
  v_mfma_f32_16x16x32_bf16 a[40:43], a[188:191], v[192:195], a[40:43]
  ds_read_b64_tr_b16 a[158:159], v11 offset:1280
  buffer_load_dwordx4 v[48:51], v7, s[16:19], s34 offen offset:3072 sc1
  v_mfma_f32_16x16x32_bf16 a[8:11], a[176:179], v[196:199], a[8:11]
  ds_read_b64_tr_b16 a[160:161], v5 offset:512
  v_mfma_f32_16x16x32_bf16 a[20:23], a[180:183], v[196:199], a[20:23]
  ds_read_b64_tr_b16 a[162:163], v5 offset:1536
  v_mfma_f32_16x16x32_bf16 a[32:35], a[184:187], v[196:199], a[32:35]
  ds_read_b64_tr_b16 a[164:165], v11 offset:512
  v_mfma_f32_16x16x32_bf16 a[44:47], a[188:191], v[196:199], a[44:47]
  ds_read_b64_tr_b16 a[166:167], v11 offset:1536
  v_mfma_f32_16x16x32_bf16 a[96:99], a[192:195], v[188:191], a[96:99]
  ds_read_b64_tr_b16 a[168:169], v5 offset:768
  v_mfma_f32_16x16x32_bf16 a[108:111], a[196:199], v[188:191], a[108:111]
  ds_read_b64_tr_b16 a[170:171], v5 offset:1792
  v_mfma_f32_16x16x32_bf16 a[120:123], a[200:203], v[188:191], a[120:123]
  ds_read_b64_tr_b16 a[172:173], v11 offset:768
  buffer_load_dwordx4 v[52:55], v19, s[16:19], s34 offen offset:3072 sc1
  v_mfma_f32_16x16x32_bf16 a[132:135], a[204:207], v[188:191], a[132:135]
  ds_read_b64_tr_b16 a[174:175], v11 offset:1792
  v_mfma_f32_16x16x32_bf16 a[100:103], a[192:195], v[192:195], a[100:103]
  v_mfma_f32_16x16x32_bf16 a[112:115], a[196:199], v[192:195], a[112:115]
  v_mfma_f32_16x16x32_bf16 a[124:127], a[200:203], v[192:195], a[124:127]
  v_mfma_f32_16x16x32_bf16 a[136:139], a[204:207], v[192:195], a[136:139]
  v_mfma_f32_16x16x32_bf16 a[104:107], a[192:195], v[196:199], a[104:107]
  v_mfma_f32_16x16x32_bf16 a[116:119], a[196:199], v[196:199], a[116:119]
  v_mfma_f32_16x16x32_bf16 a[128:131], a[200:203], v[196:199], a[128:131]
  v_mfma_f32_16x16x32_bf16 a[140:143], a[204:207], v[196:199], a[140:143]
  s_waitcnt lgkmcnt(8)
  s_waitcnt vmcnt(13)
  v_mfma_f32_16x16x32_bf16 a[0:3], a[144:147], v[200:203], a[0:3]
  ds_read_b64_tr_b16 a[176:177], v5 offset:8192
  s_mov_b32 s54, 99
  v_mfma_f32_16x16x32_bf16 a[12:15], a[148:151], v[200:203], a[12:15]
  ds_read_b64_tr_b16 a[178:179], v5 offset:9216
  v_mfma_f32_16x16x32_bf16 a[24:27], a[152:155], v[200:203], a[24:27]
  ds_read_b64_tr_b16 a[180:181], v11 offset:8192
  buffer_load_dwordx4 v[56:59], v9, s[16:19], s35 offen offset:0 sc1
  v_mfma_f32_16x16x32_bf16 a[36:39], a[156:159], v[200:203], a[36:39]
  ds_read_b64_tr_b16 a[182:183], v11 offset:9216
  v_mfma_f32_16x16x32_bf16 a[4:7], a[144:147], v[204:207], a[4:7]
  ds_read_b64_tr_b16 a[184:185], v5 offset:8448
  v_mfma_f32_16x16x32_bf16 a[16:19], a[148:151], v[204:207], a[16:19]
  ds_read_b64_tr_b16 a[186:187], v5 offset:9472
  v_mfma_f32_16x16x32_bf16 a[28:31], a[152:155], v[204:207], a[28:31]
  ds_read_b64_tr_b16 a[188:189], v11 offset:8448
  v_mfma_f32_16x16x32_bf16 a[40:43], a[156:159], v[204:207], a[40:43]
  ds_read_b64_tr_b16 a[190:191], v11 offset:9472
  v_mfma_f32_16x16x32_bf16 a[8:11], a[144:147], v[208:211], a[8:11]
  ds_read_b64_tr_b16 a[192:193], v5 offset:8704
  v_mfma_f32_16x16x32_bf16 a[20:23], a[148:151], v[208:211], a[20:23]
  ds_read_b64_tr_b16 a[194:195], v5 offset:9728
  buffer_load_dwordx4 v[60:63], v7, s[16:19], s35 offen offset:0 sc1
  v_mfma_f32_16x16x32_bf16 a[32:35], a[152:155], v[208:211], a[32:35]
  ds_read_b64_tr_b16 a[196:197], v11 offset:8704
  v_mfma_f32_16x16x32_bf16 a[44:47], a[156:159], v[208:211], a[44:47]
  ds_read_b64_tr_b16 a[198:199], v11 offset:9728
  s_waitcnt lgkmcnt(12)
  v_mfma_f32_16x16x32_bf16 a[96:99], a[160:163], v[200:203], a[96:99]
  ds_read_b64_tr_b16 a[200:201], v5 offset:8960
  v_mfma_f32_16x16x32_bf16 a[108:111], a[164:167], v[200:203], a[108:111]
  ds_read_b64_tr_b16 a[202:203], v5 offset:9984
  v_mfma_f32_16x16x32_bf16 a[120:123], a[168:171], v[200:203], a[120:123]
  ds_read_b64_tr_b16 a[204:205], v11 offset:8960
  v_mfma_f32_16x16x32_bf16 a[132:135], a[172:175], v[200:203], a[132:135]
  ds_read_b64_tr_b16 a[206:207], v11 offset:9984
  v_mfma_f32_16x16x32_bf16 a[100:103], a[160:163], v[204:207], a[100:103]
  ds_read_b32 v248, v251 offset:20480
  v_add_u32 v5, 49152, v2
  v_mfma_f32_16x16x32_bf16 a[112:115], a[164:167], v[204:207], a[112:115]
  buffer_load_dwordx4 v[64:67], v19, s[16:19], s35 offen offset:0 sc1
  v_xor_b32 v11, 8, v5
  v_mfma_f32_16x16x32_bf16 a[124:127], a[168:171], v[204:207], a[124:127]
  v_mfma_f32_16x16x32_bf16 a[136:139], a[172:175], v[204:207], a[136:139]
  v_mfma_f32_16x16x32_bf16 a[104:107], a[160:163], v[208:211], a[104:107]
  v_mfma_f32_16x16x32_bf16 a[116:119], a[164:167], v[208:211], a[116:119]
  v_mfma_f32_16x16x32_bf16 a[128:131], a[168:171], v[208:211], a[128:131]
  v_mfma_f32_16x16x32_bf16 a[140:143], a[172:175], v[208:211], a[140:143]
  s_waitcnt lgkmcnt(0)
  ds_write_b32 v249, v250 offset:0
  v_add_u32 v250, 1, v250
  v_readfirstlane_b32 s56, v248
  s_nop 1
  s_cmp_ge_u32 s56, s54
  s_cbranch_scc0 L_spin_u7
L_spun_u7:
  v_mfma_f32_16x16x32_bf16 a[0:3], a[176:179], v[212:215], a[0:3]
  ds_read_b64_tr_b16 a[144:145], v5 offset:0
  buffer_load_dwordx4 v[68:71], v9, s[16:19], s35 offen offset:1024 sc1
  v_mfma_f32_16x16x32_bf16 a[12:15], a[180:183], v[212:215], a[12:15]
  ds_read_b64_tr_b16 a[146:147], v5 offset:1024
  v_mfma_f32_16x16x32_bf16 a[24:27], a[184:187], v[212:215], a[24:27]
  ds_read_b64_tr_b16 a[148:149], v11 offset:0
  v_mfma_f32_16x16x32_bf16 a[36:39], a[188:191], v[212:215], a[36:39]
  ds_read_b64_tr_b16 a[150:151], v11 offset:1024
  v_mfma_f32_16x16x32_bf16 a[4:7], a[176:179], v[216:219], a[4:7]
  ds_read_b64_tr_b16 a[152:153], v5 offset:256
  v_mfma_f32_16x16x32_bf16 a[16:19], a[180:183], v[216:219], a[16:19]
  ds_read_b64_tr_b16 a[154:155], v5 offset:1280
  v_mfma_f32_16x16x32_bf16 a[28:31], a[184:187], v[216:219], a[28:31]
  ds_read_b64_tr_b16 a[156:157], v11 offset:256
  v_mfma_f32_16x16x32_bf16 a[40:43], a[188:191], v[216:219], a[40:43]
  ds_read_b64_tr_b16 a[158:159], v11 offset:1280
  buffer_load_dwordx4 v[72:75], v7, s[16:19], s35 offen offset:1024 sc1
  v_mfma_f32_16x16x32_bf16 a[8:11], a[176:179], v[220:223], a[8:11]
  ds_read_b64_tr_b16 a[160:161], v5 offset:512
  v_mfma_f32_16x16x32_bf16 a[20:23], a[180:183], v[220:223], a[20:23]
  ds_read_b64_tr_b16 a[162:163], v5 offset:1536
  v_mfma_f32_16x16x32_bf16 a[32:35], a[184:187], v[220:223], a[32:35]
  ds_read_b64_tr_b16 a[164:165], v11 offset:512
  v_mfma_f32_16x16x32_bf16 a[44:47], a[188:191], v[220:223], a[44:47]
  ds_read_b64_tr_b16 a[166:167], v11 offset:1536
  v_mfma_f32_16x16x32_bf16 a[96:99], a[192:195], v[212:215], a[96:99]
  ds_read_b64_tr_b16 a[168:169], v5 offset:768
  v_mfma_f32_16x16x32_bf16 a[108:111], a[196:199], v[212:215], a[108:111]
  ds_read_b64_tr_b16 a[170:171], v5 offset:1792
  v_mfma_f32_16x16x32_bf16 a[120:123], a[200:203], v[212:215], a[120:123]
  ds_read_b64_tr_b16 a[172:173], v11 offset:768
  buffer_load_dwordx4 v[76:79], v19, s[16:19], s35 offen offset:1024 sc1
  v_mfma_f32_16x16x32_bf16 a[132:135], a[204:207], v[212:215], a[132:135]
  ds_read_b64_tr_b16 a[174:175], v11 offset:1792
  v_mfma_f32_16x16x32_bf16 a[100:103], a[192:195], v[216:219], a[100:103]
  v_mfma_f32_16x16x32_bf16 a[112:115], a[196:199], v[216:219], a[112:115]
  v_mfma_f32_16x16x32_bf16 a[124:127], a[200:203], v[216:219], a[124:127]
  v_mfma_f32_16x16x32_bf16 a[136:139], a[204:207], v[216:219], a[136:139]
  v_mfma_f32_16x16x32_bf16 a[104:107], a[192:195], v[220:223], a[104:107]
  v_mfma_f32_16x16x32_bf16 a[116:119], a[196:199], v[220:223], a[116:119]
  v_mfma_f32_16x16x32_bf16 a[128:131], a[200:203], v[220:223], a[128:131]
  v_mfma_f32_16x16x32_bf16 a[140:143], a[204:207], v[220:223], a[140:143]
  s_waitcnt lgkmcnt(8)
  s_waitcnt vmcnt(12)
  v_mfma_f32_16x16x32_bf16 a[0:3], a[144:147], v[224:227], a[0:3]
  ds_read_b64_tr_b16 a[176:177], v5 offset:8192
  s_mov_b32 s54, 100
  v_mfma_f32_16x16x32_bf16 a[12:15], a[148:151], v[224:227], a[12:15]
  ds_read_b64_tr_b16 a[178:179], v5 offset:9216
  v_mfma_f32_16x16x32_bf16 a[24:27], a[152:155], v[224:227], a[24:27]
  ds_read_b64_tr_b16 a[180:181], v11 offset:8192
  buffer_load_dwordx4 v[80:83], v9, s[16:19], s35 offen offset:2048 sc1
  v_mfma_f32_16x16x32_bf16 a[36:39], a[156:159], v[224:227], a[36:39]
  ds_read_b64_tr_b16 a[182:183], v11 offset:9216
  v_mfma_f32_16x16x32_bf16 a[4:7], a[144:147], v[228:231], a[4:7]
  ds_read_b64_tr_b16 a[184:185], v5 offset:8448
  v_mfma_f32_16x16x32_bf16 a[16:19], a[148:151], v[228:231], a[16:19]
  ds_read_b64_tr_b16 a[186:187], v5 offset:9472
  v_mfma_f32_16x16x32_bf16 a[28:31], a[152:155], v[228:231], a[28:31]
  ds_read_b64_tr_b16 a[188:189], v11 offset:8448
  v_mfma_f32_16x16x32_bf16 a[40:43], a[156:159], v[228:231], a[40:43]
  ds_read_b64_tr_b16 a[190:191], v11 offset:9472
  v_mfma_f32_16x16x32_bf16 a[8:11], a[144:147], v[232:235], a[8:11]
  ds_read_b64_tr_b16 a[192:193], v5 offset:8704
  v_mfma_f32_16x16x32_bf16 a[20:23], a[148:151], v[232:235], a[20:23]
  ds_read_b64_tr_b16 a[194:195], v5 offset:9728
  buffer_load_dwordx4 v[84:87], v7, s[16:19], s35 offen offset:2048 sc1
  v_mfma_f32_16x16x32_bf16 a[32:35], a[152:155], v[232:235], a[32:35]
  ds_read_b64_tr_b16 a[196:197], v11 offset:8704
  v_mfma_f32_16x16x32_bf16 a[44:47], a[156:159], v[232:235], a[44:47]
  ds_read_b64_tr_b16 a[198:199], v11 offset:9728
  s_waitcnt lgkmcnt(12)
  v_mfma_f32_16x16x32_bf16 a[96:99], a[160:163], v[224:227], a[96:99]
  ds_read_b64_tr_b16 a[200:201], v5 offset:8960
  v_mfma_f32_16x16x32_bf16 a[108:111], a[164:167], v[224:227], a[108:111]
  ds_read_b64_tr_b16 a[202:203], v5 offset:9984
  v_mfma_f32_16x16x32_bf16 a[120:123], a[168:171], v[224:227], a[120:123]
  ds_read_b64_tr_b16 a[204:205], v11 offset:8960
  v_mfma_f32_16x16x32_bf16 a[132:135], a[172:175], v[224:227], a[132:135]
  ds_read_b64_tr_b16 a[206:207], v11 offset:9984
  v_mfma_f32_16x16x32_bf16 a[100:103], a[160:163], v[228:231], a[100:103]
  ds_read_b32 v248, v251 offset:20480
  v_add_u32 v5, 65536, v2
  v_mfma_f32_16x16x32_bf16 a[112:115], a[164:167], v[228:231], a[112:115]
  buffer_load_dwordx4 v[88:91], v19, s[16:19], s35 offen offset:2048 sc1
  v_xor_b32 v11, 8, v5
  v_mfma_f32_16x16x32_bf16 a[124:127], a[168:171], v[228:231], a[124:127]
  v_mfma_f32_16x16x32_bf16 a[136:139], a[172:175], v[228:231], a[136:139]
  v_mfma_f32_16x16x32_bf16 a[104:107], a[160:163], v[232:235], a[104:107]
  v_mfma_f32_16x16x32_bf16 a[116:119], a[164:167], v[232:235], a[116:119]
  v_mfma_f32_16x16x32_bf16 a[128:131], a[168:171], v[232:235], a[128:131]
  v_mfma_f32_16x16x32_bf16 a[140:143], a[172:175], v[232:235], a[140:143]
  s_waitcnt lgkmcnt(0)
  ds_write_b32 v249, v250 offset:0
  v_add_u32 v250, 1, v250
  v_readfirstlane_b32 s56, v248
  s_nop 1
  s_cmp_ge_u32 s56, s54
  s_cbranch_scc0 L_spin_u10
L_spun_u10:
  v_mfma_f32_16x16x32_bf16 a[0:3], a[176:179], v[236:239], a[0:3]
  ds_read_b64_tr_b16 a[144:145], v5 offset:0
  buffer_load_dwordx4 v[92:95], v9, s[16:19], s35 offen offset:3072 sc1
  v_mfma_f32_16x16x32_bf16 a[12:15], a[180:183], v[236:239], a[12:15]
  ds_read_b64_tr_b16 a[146:147], v5 offset:1024
  v_mfma_f32_16x16x32_bf16 a[24:27], a[184:187], v[236:239], a[24:27]
  ds_read_b64_tr_b16 a[148:149], v11 offset:0
  v_mfma_f32_16x16x32_bf16 a[36:39], a[188:191], v[236:239], a[36:39]
  ds_read_b64_tr_b16 a[150:151], v11 offset:1024
  v_mfma_f32_16x16x32_bf16 a[4:7], a[176:179], v[240:243], a[4:7]
  ds_read_b64_tr_b16 a[152:153], v5 offset:256
  v_mfma_f32_16x16x32_bf16 a[16:19], a[180:183], v[240:243], a[16:19]
  ds_read_b64_tr_b16 a[154:155], v5 offset:1280
  v_mfma_f32_16x16x32_bf16 a[28:31], a[184:187], v[240:243], a[28:31]
  ds_read_b64_tr_b16 a[156:157], v11 offset:256
  v_mfma_f32_16x16x32_bf16 a[40:43], a[188:191], v[240:243], a[40:43]
  ds_read_b64_tr_b16 a[158:159], v11 offset:1280
  buffer_load_dwordx4 v[96:99], v7, s[16:19], s35 offen offset:3072 sc1
  v_mfma_f32_16x16x32_bf16 a[8:11], a[176:179], v[244:247], a[8:11]
  ds_read_b64_tr_b16 a[160:161], v5 offset:512
  v_mfma_f32_16x16x32_bf16 a[20:23], a[180:183], v[244:247], a[20:23]
  ds_read_b64_tr_b16 a[162:163], v5 offset:1536
  v_mfma_f32_16x16x32_bf16 a[32:35], a[184:187], v[244:247], a[32:35]
  ds_read_b64_tr_b16 a[164:165], v11 offset:512
  v_mfma_f32_16x16x32_bf16 a[44:47], a[188:191], v[244:247], a[44:47]
  ds_read_b64_tr_b16 a[166:167], v11 offset:1536
  v_mfma_f32_16x16x32_bf16 a[96:99], a[192:195], v[236:239], a[96:99]
  ds_read_b64_tr_b16 a[168:169], v5 offset:768
  v_mfma_f32_16x16x32_bf16 a[108:111], a[196:199], v[236:239], a[108:111]
  ds_read_b64_tr_b16 a[170:171], v5 offset:1792
  v_mfma_f32_16x16x32_bf16 a[120:123], a[200:203], v[236:239], a[120:123]
  ds_read_b64_tr_b16 a[172:173], v11 offset:768
  buffer_load_dwordx4 v[100:103], v19, s[16:19], s35 offen offset:3072 sc1
  v_mfma_f32_16x16x32_bf16 a[132:135], a[204:207], v[236:239], a[132:135]
  ds_read_b64_tr_b16 a[174:175], v11 offset:1792
  v_mfma_f32_16x16x32_bf16 a[100:103], a[192:195], v[240:243], a[100:103]
  v_mfma_f32_16x16x32_bf16 a[112:115], a[196:199], v[240:243], a[112:115]
  v_mfma_f32_16x16x32_bf16 a[124:127], a[200:203], v[240:243], a[124:127]
  v_mfma_f32_16x16x32_bf16 a[136:139], a[204:207], v[240:243], a[136:139]
  v_mfma_f32_16x16x32_bf16 a[104:107], a[192:195], v[244:247], a[104:107]
  v_mfma_f32_16x16x32_bf16 a[116:119], a[196:199], v[244:247], a[116:119]
  v_mfma_f32_16x16x32_bf16 a[128:131], a[200:203], v[244:247], a[128:131]
  v_mfma_f32_16x16x32_bf16 a[140:143], a[204:207], v[244:247], a[140:143]
  s_waitcnt lgkmcnt(8)
  s_waitcnt vmcnt(12)
  v_mfma_f32_16x16x32_bf16 a[0:3], a[144:147], v[32:35], a[0:3]
  ds_read_b64_tr_b16 a[176:177], v5 offset:8192
  s_mov_b32 s54, 101
  v_mfma_f32_16x16x32_bf16 a[12:15], a[148:151], v[32:35], a[12:15]
  ds_read_b64_tr_b16 a[178:179], v5 offset:9216
  v_mfma_f32_16x16x32_bf16 a[24:27], a[152:155], v[32:35], a[24:27]
  ds_read_b64_tr_b16 a[180:181], v11 offset:8192
  buffer_load_dwordx4 v[104:107], v9, s[16:19], s36 offen offset:0 sc1
  v_mfma_f32_16x16x32_bf16 a[36:39], a[156:159], v[32:35], a[36:39]
  ds_read_b64_tr_b16 a[182:183], v11 offset:9216
  v_mfma_f32_16x16x32_bf16 a[4:7], a[144:147], v[36:39], a[4:7]
  ds_read_b64_tr_b16 a[184:185], v5 offset:8448
  v_mfma_f32_16x16x32_bf16 a[16:19], a[148:151], v[36:39], a[16:19]
  ds_read_b64_tr_b16 a[186:187], v5 offset:9472
  v_mfma_f32_16x16x32_bf16 a[28:31], a[152:155], v[36:39], a[28:31]
  ds_read_b64_tr_b16 a[188:189], v11 offset:8448
  v_mfma_f32_16x16x32_bf16 a[40:43], a[156:159], v[36:39], a[40:43]
  ds_read_b64_tr_b16 a[190:191], v11 offset:9472
  v_mfma_f32_16x16x32_bf16 a[8:11], a[144:147], v[40:43], a[8:11]
  ds_read_b64_tr_b16 a[192:193], v5 offset:8704
  v_mfma_f32_16x16x32_bf16 a[20:23], a[148:151], v[40:43], a[20:23]
  ds_read_b64_tr_b16 a[194:195], v5 offset:9728
  buffer_load_dwordx4 v[108:111], v7, s[16:19], s36 offen offset:0 sc1
  v_mfma_f32_16x16x32_bf16 a[32:35], a[152:155], v[40:43], a[32:35]
  ds_read_b64_tr_b16 a[196:197], v11 offset:8704
  v_mfma_f32_16x16x32_bf16 a[44:47], a[156:159], v[40:43], a[44:47]
  ds_read_b64_tr_b16 a[198:199], v11 offset:9728
  s_waitcnt lgkmcnt(12)
  v_mfma_f32_16x16x32_bf16 a[96:99], a[160:163], v[32:35], a[96:99]
  ds_read_b64_tr_b16 a[200:201], v5 offset:8960
  v_mfma_f32_16x16x32_bf16 a[108:111], a[164:167], v[32:35], a[108:111]
  ds_read_b64_tr_b16 a[202:203], v5 offset:9984
  v_mfma_f32_16x16x32_bf16 a[120:123], a[168:171], v[32:35], a[120:123]
  ds_read_b64_tr_b16 a[204:205], v11 offset:8960
  v_mfma_f32_16x16x32_bf16 a[132:135], a[172:175], v[32:35], a[132:135]
  ds_read_b64_tr_b16 a[206:207], v11 offset:9984
  v_mfma_f32_16x16x32_bf16 a[100:103], a[160:163], v[36:39], a[100:103]
  ds_read_b32 v248, v251 offset:20480
  v_add_u32 v5, 81920, v2
  v_mfma_f32_16x16x32_bf16 a[112:115], a[164:167], v[36:39], a[112:115]
  buffer_load_dwordx4 v[112:115], v19, s[16:19], s36 offen offset:0 sc1
  v_xor_b32 v11, 8, v5
  v_mfma_f32_16x16x32_bf16 a[124:127], a[168:171], v[36:39], a[124:127]
  v_mfma_f32_16x16x32_bf16 a[136:139], a[172:175], v[36:39], a[136:139]
  v_mfma_f32_16x16x32_bf16 a[104:107], a[160:163], v[40:43], a[104:107]
  v_mfma_f32_16x16x32_bf16 a[116:119], a[164:167], v[40:43], a[116:119]
  v_mfma_f32_16x16x32_bf16 a[128:131], a[168:171], v[40:43], a[128:131]
  v_mfma_f32_16x16x32_bf16 a[140:143], a[172:175], v[40:43], a[140:143]
  s_waitcnt lgkmcnt(0)
  ds_write_b32 v249, v250 offset:0
  v_add_u32 v250, 1, v250
  v_readfirstlane_b32 s56, v248
  s_nop 1
  s_cmp_ge_u32 s56, s54
  s_cbranch_scc0 L_spin_u11
L_spun_u11:
  v_mfma_f32_16x16x32_bf16 a[0:3], a[176:179], v[44:47], a[0:3]
  ds_read_b64_tr_b16 a[144:145], v5 offset:0
  buffer_load_dwordx4 v[116:119], v9, s[16:19], s36 offen offset:1024 sc1
  v_mfma_f32_16x16x32_bf16 a[12:15], a[180:183], v[44:47], a[12:15]
  ds_read_b64_tr_b16 a[146:147], v5 offset:1024
  v_mfma_f32_16x16x32_bf16 a[24:27], a[184:187], v[44:47], a[24:27]
  ds_read_b64_tr_b16 a[148:149], v11 offset:0
  v_mfma_f32_16x16x32_bf16 a[36:39], a[188:191], v[44:47], a[36:39]
  ds_read_b64_tr_b16 a[150:151], v11 offset:1024
  v_mfma_f32_16x16x32_bf16 a[4:7], a[176:179], v[48:51], a[4:7]
  ds_read_b64_tr_b16 a[152:153], v5 offset:256
  v_mfma_f32_16x16x32_bf16 a[16:19], a[180:183], v[48:51], a[16:19]
  ds_read_b64_tr_b16 a[154:155], v5 offset:1280
  v_mfma_f32_16x16x32_bf16 a[28:31], a[184:187], v[48:51], a[28:31]
  ds_read_b64_tr_b16 a[156:157], v11 offset:256
  v_mfma_f32_16x16x32_bf16 a[40:43], a[188:191], v[48:51], a[40:43]
  ds_read_b64_tr_b16 a[158:159], v11 offset:1280
  buffer_load_dwordx4 v[120:123], v7, s[16:19], s36 offen offset:1024 sc1
  v_mfma_f32_16x16x32_bf16 a[8:11], a[176:179], v[52:55], a[8:11]
  ds_read_b64_tr_b16 a[160:161], v5 offset:512
  v_mfma_f32_16x16x32_bf16 a[20:23], a[180:183], v[52:55], a[20:23]
  ds_read_b64_tr_b16 a[162:163], v5 offset:1536
  v_mfma_f32_16x16x32_bf16 a[32:35], a[184:187], v[52:55], a[32:35]
  ds_read_b64_tr_b16 a[164:165], v11 offset:512
  v_mfma_f32_16x16x32_bf16 a[44:47], a[188:191], v[52:55], a[44:47]
  ds_read_b64_tr_b16 a[166:167], v11 offset:1536
  v_mfma_f32_16x16x32_bf16 a[96:99], a[192:195], v[44:47], a[96:99]
  ds_read_b64_tr_b16 a[168:169], v5 offset:768
  v_mfma_f32_16x16x32_bf16 a[108:111], a[196:199], v[44:47], a[108:111]
  ds_read_b64_tr_b16 a[170:171], v5 offset:1792
  v_mfma_f32_16x16x32_bf16 a[120:123], a[200:203], v[44:47], a[120:123]
  ds_read_b64_tr_b16 a[172:173], v11 offset:768
  buffer_load_dwordx4 v[124:127], v19, s[16:19], s36 offen offset:1024 sc1
  v_mfma_f32_16x16x32_bf16 a[132:135], a[204:207], v[44:47], a[132:135]
  ds_read_b64_tr_b16 a[174:175], v11 offset:1792
  v_mfma_f32_16x16x32_bf16 a[100:103], a[192:195], v[48:51], a[100:103]
  v_mfma_f32_16x16x32_bf16 a[112:115], a[196:199], v[48:51], a[112:115]
  v_mfma_f32_16x16x32_bf16 a[124:127], a[200:203], v[48:51], a[124:127]
  v_mfma_f32_16x16x32_bf16 a[136:139], a[204:207], v[48:51], a[136:139]
  v_mfma_f32_16x16x32_bf16 a[104:107], a[192:195], v[52:55], a[104:107]
  v_mfma_f32_16x16x32_bf16 a[116:119], a[196:199], v[52:55], a[116:119]
  v_mfma_f32_16x16x32_bf16 a[128:131], a[200:203], v[52:55], a[128:131]
  v_mfma_f32_16x16x32_bf16 a[140:143], a[204:207], v[52:55], a[140:143]
  s_waitcnt lgkmcnt(8)
  s_waitcnt vmcnt(12)
  v_mfma_f32_16x16x32_bf16 a[0:3], a[144:147], v[56:59], a[0:3]
  ds_read_b64_tr_b16 a[176:177], v5 offset:8192
  s_mov_b32 s54, 102
  v_mfma_f32_16x16x32_bf16 a[12:15], a[148:151], v[56:59], a[12:15]
  ds_read_b64_tr_b16 a[178:179], v5 offset:9216
  v_mfma_f32_16x16x32_bf16 a[24:27], a[152:155], v[56:59], a[24:27]
  ds_read_b64_tr_b16 a[180:181], v11 offset:8192
  buffer_load_dwordx4 v[128:131], v9, s[16:19], s36 offen offset:2048 sc1
  v_mfma_f32_16x16x32_bf16 a[36:39], a[156:159], v[56:59], a[36:39]
  ds_read_b64_tr_b16 a[182:183], v11 offset:9216
  v_mfma_f32_16x16x32_bf16 a[4:7], a[144:147], v[60:63], a[4:7]
  ds_read_b64_tr_b16 a[184:185], v5 offset:8448
  v_mfma_f32_16x16x32_bf16 a[16:19], a[148:151], v[60:63], a[16:19]
  ds_read_b64_tr_b16 a[186:187], v5 offset:9472
  v_mfma_f32_16x16x32_bf16 a[28:31], a[152:155], v[60:63], a[28:31]
  ds_read_b64_tr_b16 a[188:189], v11 offset:8448
  v_mfma_f32_16x16x32_bf16 a[40:43], a[156:159], v[60:63], a[40:43]
  ds_read_b64_tr_b16 a[190:191], v11 offset:9472
  v_mfma_f32_16x16x32_bf16 a[8:11], a[144:147], v[64:67], a[8:11]
  ds_read_b64_tr_b16 a[192:193], v5 offset:8704
  v_mfma_f32_16x16x32_bf16 a[20:23], a[148:151], v[64:67], a[20:23]
  ds_read_b64_tr_b16 a[194:195], v5 offset:9728
  buffer_load_dwordx4 v[132:135], v7, s[16:19], s36 offen offset:2048 sc1
  v_mfma_f32_16x16x32_bf16 a[32:35], a[152:155], v[64:67], a[32:35]
  ds_read_b64_tr_b16 a[196:197], v11 offset:8704
  v_mfma_f32_16x16x32_bf16 a[44:47], a[156:159], v[64:67], a[44:47]
  ds_read_b64_tr_b16 a[198:199], v11 offset:9728
  s_waitcnt lgkmcnt(12)
  v_mfma_f32_16x16x32_bf16 a[96:99], a[160:163], v[56:59], a[96:99]
  ds_read_b64_tr_b16 a[200:201], v5 offset:8960
  v_mfma_f32_16x16x32_bf16 a[108:111], a[164:167], v[56:59], a[108:111]
  ds_read_b64_tr_b16 a[202:203], v5 offset:9984
  v_mfma_f32_16x16x32_bf16 a[120:123], a[168:171], v[56:59], a[120:123]
  ds_read_b64_tr_b16 a[204:205], v11 offset:8960
  v_mfma_f32_16x16x32_bf16 a[132:135], a[172:175], v[56:59], a[132:135]
  ds_read_b64_tr_b16 a[206:207], v11 offset:9984
  v_mfma_f32_16x16x32_bf16 a[100:103], a[160:163], v[60:63], a[100:103]
  ds_read_b32 v248, v251 offset:20480
  v_add_u32 v5, 0, v2
  v_mfma_f32_16x16x32_bf16 a[112:115], a[164:167], v[60:63], a[112:115]
  buffer_load_dwordx4 v[136:139], v19, s[16:19], s36 offen offset:2048 sc1
  v_xor_b32 v11, 8, v5
  v_mfma_f32_16x16x32_bf16 a[124:127], a[168:171], v[60:63], a[124:127]
  v_mfma_f32_16x16x32_bf16 a[136:139], a[172:175], v[60:63], a[136:139]
  v_mfma_f32_16x16x32_bf16 a[104:107], a[160:163], v[64:67], a[104:107]
  v_mfma_f32_16x16x32_bf16 a[116:119], a[164:167], v[64:67], a[116:119]
  v_mfma_f32_16x16x32_bf16 a[128:131], a[168:171], v[64:67], a[128:131]
  v_mfma_f32_16x16x32_bf16 a[140:143], a[172:175], v[64:67], a[140:143]
  s_waitcnt lgkmcnt(0)
  ds_write_b32 v249, v250 offset:0
  v_add_u32 v250, 1, v250
  v_readfirstlane_b32 s56, v248
  s_nop 1
  s_cmp_ge_u32 s56, s54
  s_cbranch_scc0 L_spin_u12
L_spun_u12:
  v_mfma_f32_16x16x32_bf16 a[0:3], a[176:179], v[68:71], a[0:3]
  ds_read_b64_tr_b16 a[144:145], v5 offset:0
  buffer_load_dwordx4 v[140:143], v9, s[16:19], s36 offen offset:3072 sc1
  v_mfma_f32_16x16x32_bf16 a[12:15], a[180:183], v[68:71], a[12:15]
  ds_read_b64_tr_b16 a[146:147], v5 offset:1024
  v_mfma_f32_16x16x32_bf16 a[24:27], a[184:187], v[68:71], a[24:27]
  ds_read_b64_tr_b16 a[148:149], v11 offset:0
  v_mfma_f32_16x16x32_bf16 a[36:39], a[188:191], v[68:71], a[36:39]
  ds_read_b64_tr_b16 a[150:151], v11 offset:1024
  v_mfma_f32_16x16x32_bf16 a[4:7], a[176:179], v[72:75], a[4:7]
  ds_read_b64_tr_b16 a[152:153], v5 offset:256
  v_mfma_f32_16x16x32_bf16 a[16:19], a[180:183], v[72:75], a[16:19]
  ds_read_b64_tr_b16 a[154:155], v5 offset:1280
  v_mfma_f32_16x16x32_bf16 a[28:31], a[184:187], v[72:75], a[28:31]
  ds_read_b64_tr_b16 a[156:157], v11 offset:256
  v_mfma_f32_16x16x32_bf16 a[40:43], a[188:191], v[72:75], a[40:43]
  ds_read_b64_tr_b16 a[158:159], v11 offset:1280
  buffer_load_dwordx4 v[144:147], v7, s[16:19], s36 offen offset:3072 sc1
  v_mfma_f32_16x16x32_bf16 a[8:11], a[176:179], v[76:79], a[8:11]
  ds_read_b64_tr_b16 a[160:161], v5 offset:512
  v_mfma_f32_16x16x32_bf16 a[20:23], a[180:183], v[76:79], a[20:23]
  ds_read_b64_tr_b16 a[162:163], v5 offset:1536
  v_mfma_f32_16x16x32_bf16 a[32:35], a[184:187], v[76:79], a[32:35]
  ds_read_b64_tr_b16 a[164:165], v11 offset:512
  v_mfma_f32_16x16x32_bf16 a[44:47], a[188:191], v[76:79], a[44:47]
  ds_read_b64_tr_b16 a[166:167], v11 offset:1536
  v_mfma_f32_16x16x32_bf16 a[96:99], a[192:195], v[68:71], a[96:99]
  ds_read_b64_tr_b16 a[168:169], v5 offset:768
  v_mfma_f32_16x16x32_bf16 a[108:111], a[196:199], v[68:71], a[108:111]
  ds_read_b64_tr_b16 a[170:171], v5 offset:1792
  v_mfma_f32_16x16x32_bf16 a[120:123], a[200:203], v[68:71], a[120:123]
  ds_read_b64_tr_b16 a[172:173], v11 offset:768
  buffer_load_dwordx4 v[148:151], v19, s[16:19], s36 offen offset:3072 sc1
  v_mfma_f32_16x16x32_bf16 a[132:135], a[204:207], v[68:71], a[132:135]
  ds_read_b64_tr_b16 a[174:175], v11 offset:1792
  v_mfma_f32_16x16x32_bf16 a[100:103], a[192:195], v[72:75], a[100:103]
  v_mfma_f32_16x16x32_bf16 a[112:115], a[196:199], v[72:75], a[112:115]
  v_mfma_f32_16x16x32_bf16 a[124:127], a[200:203], v[72:75], a[124:127]
  v_mfma_f32_16x16x32_bf16 a[136:139], a[204:207], v[72:75], a[136:139]
  v_mfma_f32_16x16x32_bf16 a[104:107], a[192:195], v[76:79], a[104:107]
  v_mfma_f32_16x16x32_bf16 a[116:119], a[196:199], v[76:79], a[116:119]
  v_mfma_f32_16x16x32_bf16 a[128:131], a[200:203], v[76:79], a[128:131]
  v_mfma_f32_16x16x32_bf16 a[140:143], a[204:207], v[76:79], a[140:143]
  s_waitcnt lgkmcnt(8)
  s_waitcnt vmcnt(12)
  v_mfma_f32_16x16x32_bf16 a[0:3], a[144:147], v[80:83], a[0:3]
  ds_read_b64_tr_b16 a[176:177], v5 offset:8192
  s_mov_b32 s54, 103
  v_mfma_f32_16x16x32_bf16 a[12:15], a[148:151], v[80:83], a[12:15]
  ds_read_b64_tr_b16 a[178:179], v5 offset:9216
  v_mfma_f32_16x16x32_bf16 a[24:27], a[152:155], v[80:83], a[24:27]
  ds_read_b64_tr_b16 a[180:181], v11 offset:8192
  v_mfma_f32_16x16x32_bf16 a[36:39], a[156:159], v[80:83], a[36:39]
  ds_read_b64_tr_b16 a[182:183], v11 offset:9216
  v_mfma_f32_16x16x32_bf16 a[4:7], a[144:147], v[84:87], a[4:7]
  ds_read_b64_tr_b16 a[184:185], v5 offset:8448
  v_mfma_f32_16x16x32_bf16 a[16:19], a[148:151], v[84:87], a[16:19]
  ds_read_b64_tr_b16 a[186:187], v5 offset:9472
  v_mfma_f32_16x16x32_bf16 a[28:31], a[152:155], v[84:87], a[28:31]
  ds_read_b64_tr_b16 a[188:189], v11 offset:8448
  v_mfma_f32_16x16x32_bf16 a[40:43], a[156:159], v[84:87], a[40:43]
  ds_read_b64_tr_b16 a[190:191], v11 offset:9472
  v_mfma_f32_16x16x32_bf16 a[8:11], a[144:147], v[88:91], a[8:11]
  ds_read_b64_tr_b16 a[192:193], v5 offset:8704
  v_mfma_f32_16x16x32_bf16 a[20:23], a[148:151], v[88:91], a[20:23]
  ds_read_b64_tr_b16 a[194:195], v5 offset:9728
  v_mfma_f32_16x16x32_bf16 a[32:35], a[152:155], v[88:91], a[32:35]
  ds_read_b64_tr_b16 a[196:197], v11 offset:8704
  v_mfma_f32_16x16x32_bf16 a[44:47], a[156:159], v[88:91], a[44:47]
  ds_read_b64_tr_b16 a[198:199], v11 offset:9728
  s_waitcnt lgkmcnt(12)
  v_mfma_f32_16x16x32_bf16 a[96:99], a[160:163], v[80:83], a[96:99]
  ds_read_b64_tr_b16 a[200:201], v5 offset:8960
  v_mfma_f32_16x16x32_bf16 a[108:111], a[164:167], v[80:83], a[108:111]
  ds_read_b64_tr_b16 a[202:203], v5 offset:9984
  v_mfma_f32_16x16x32_bf16 a[120:123], a[168:171], v[80:83], a[120:123]
  ds_read_b64_tr_b16 a[204:205], v11 offset:8960
  v_mfma_f32_16x16x32_bf16 a[132:135], a[172:175], v[80:83], a[132:135]
  ds_read_b64_tr_b16 a[206:207], v11 offset:9984
  v_mfma_f32_16x16x32_bf16 a[100:103], a[160:163], v[84:87], a[100:103]
  ds_read_b32 v248, v251 offset:20480
  v_add_u32 v5, 98304, v2
  v_mfma_f32_16x16x32_bf16 a[112:115], a[164:167], v[84:87], a[112:115]
  v_xor_b32 v11, 8, v5
  v_mfma_f32_16x16x32_bf16 a[124:127], a[168:171], v[84:87], a[124:127]
  v_mfma_f32_16x16x32_bf16 a[136:139], a[172:175], v[84:87], a[136:139]
  v_mfma_f32_16x16x32_bf16 a[104:107], a[160:163], v[88:91], a[104:107]
  v_mfma_f32_16x16x32_bf16 a[116:119], a[164:167], v[88:91], a[116:119]
  v_mfma_f32_16x16x32_bf16 a[128:131], a[168:171], v[88:91], a[128:131]
  v_mfma_f32_16x16x32_bf16 a[140:143], a[172:175], v[88:91], a[140:143]
  s_waitcnt lgkmcnt(0)
  ds_write_b32 v249, v250 offset:0
  v_add_u32 v250, 1, v250
  v_readfirstlane_b32 s56, v248
  s_nop 1
  s_cmp_ge_u32 s56, s54
  s_cbranch_scc0 L_spin_u13
L_spun_u13:
  v_mfma_f32_16x16x32_bf16 a[0:3], a[176:179], v[92:95], a[0:3]
  ds_read_b64_tr_b16 a[144:145], v5 offset:0
  v_mfma_f32_16x16x32_bf16 a[12:15], a[180:183], v[92:95], a[12:15]
  ds_read_b64_tr_b16 a[146:147], v5 offset:1024
  v_mfma_f32_16x16x32_bf16 a[24:27], a[184:187], v[92:95], a[24:27]
  ds_read_b64_tr_b16 a[148:149], v11 offset:0
  v_mfma_f32_16x16x32_bf16 a[36:39], a[188:191], v[92:95], a[36:39]
  ds_read_b64_tr_b16 a[150:151], v11 offset:1024
  v_mfma_f32_16x16x32_bf16 a[4:7], a[176:179], v[96:99], a[4:7]
  ds_read_b64_tr_b16 a[152:153], v5 offset:256
  v_mfma_f32_16x16x32_bf16 a[16:19], a[180:183], v[96:99], a[16:19]
  ds_read_b64_tr_b16 a[154:155], v5 offset:1280
  v_mfma_f32_16x16x32_bf16 a[28:31], a[184:187], v[96:99], a[28:31]
  ds_read_b64_tr_b16 a[156:157], v11 offset:256
  v_mfma_f32_16x16x32_bf16 a[40:43], a[188:191], v[96:99], a[40:43]
  ds_read_b64_tr_b16 a[158:159], v11 offset:1280
  v_mfma_f32_16x16x32_bf16 a[8:11], a[176:179], v[100:103], a[8:11]
  ds_read_b64_tr_b16 a[160:161], v5 offset:512
  v_mfma_f32_16x16x32_bf16 a[20:23], a[180:183], v[100:103], a[20:23]
  ds_read_b64_tr_b16 a[162:163], v5 offset:1536
  v_mfma_f32_16x16x32_bf16 a[32:35], a[184:187], v[100:103], a[32:35]
  ds_read_b64_tr_b16 a[164:165], v11 offset:512
  v_mfma_f32_16x16x32_bf16 a[44:47], a[188:191], v[100:103], a[44:47]
  ds_read_b64_tr_b16 a[166:167], v11 offset:1536
  v_mfma_f32_16x16x32_bf16 a[96:99], a[192:195], v[92:95], a[96:99]
  ds_read_b64_tr_b16 a[168:169], v5 offset:768
  v_mfma_f32_16x16x32_bf16 a[108:111], a[196:199], v[92:95], a[108:111]
  ds_read_b64_tr_b16 a[170:171], v5 offset:1792
  v_mfma_f32_16x16x32_bf16 a[120:123], a[200:203], v[92:95], a[120:123]
  ds_read_b64_tr_b16 a[172:173], v11 offset:768
  v_mfma_f32_16x16x32_bf16 a[132:135], a[204:207], v[92:95], a[132:135]
  ds_read_b64_tr_b16 a[174:175], v11 offset:1792
  v_mfma_f32_16x16x32_bf16 a[100:103], a[192:195], v[96:99], a[100:103]
  v_mfma_f32_16x16x32_bf16 a[112:115], a[196:199], v[96:99], a[112:115]
  v_mfma_f32_16x16x32_bf16 a[124:127], a[200:203], v[96:99], a[124:127]
  v_mfma_f32_16x16x32_bf16 a[136:139], a[204:207], v[96:99], a[136:139]
  v_mfma_f32_16x16x32_bf16 a[104:107], a[192:195], v[100:103], a[104:107]
  v_mfma_f32_16x16x32_bf16 a[116:119], a[196:199], v[100:103], a[116:119]
  v_mfma_f32_16x16x32_bf16 a[128:131], a[200:203], v[100:103], a[128:131]
  v_mfma_f32_16x16x32_bf16 a[140:143], a[204:207], v[100:103], a[140:143]
  s_waitcnt lgkmcnt(8)
  s_waitcnt vmcnt(6)
  v_mfma_f32_16x16x32_bf16 a[0:3], a[144:147], v[104:107], a[0:3]
  ds_read_b64_tr_b16 a[176:177], v5 offset:8192
  s_mov_b32 s54, 104
  v_mfma_f32_16x16x32_bf16 a[12:15], a[148:151], v[104:107], a[12:15]
  ds_read_b64_tr_b16 a[178:179], v5 offset:9216
  v_mfma_f32_16x16x32_bf16 a[24:27], a[152:155], v[104:107], a[24:27]
  ds_read_b64_tr_b16 a[180:181], v11 offset:8192
  v_mfma_f32_16x16x32_bf16 a[36:39], a[156:159], v[104:107], a[36:39]
  ds_read_b64_tr_b16 a[182:183], v11 offset:9216
  v_mfma_f32_16x16x32_bf16 a[4:7], a[144:147], v[108:111], a[4:7]
  ds_read_b64_tr_b16 a[184:185], v5 offset:8448
  v_mfma_f32_16x16x32_bf16 a[16:19], a[148:151], v[108:111], a[16:19]
  ds_read_b64_tr_b16 a[186:187], v5 offset:9472
  v_mfma_f32_16x16x32_bf16 a[28:31], a[152:155], v[108:111], a[28:31]
  ds_read_b64_tr_b16 a[188:189], v11 offset:8448
  v_mfma_f32_16x16x32_bf16 a[40:43], a[156:159], v[108:111], a[40:43]
  ds_read_b64_tr_b16 a[190:191], v11 offset:9472
  v_mfma_f32_16x16x32_bf16 a[8:11], a[144:147], v[112:115], a[8:11]
  ds_read_b64_tr_b16 a[192:193], v5 offset:8704
  v_mfma_f32_16x16x32_bf16 a[20:23], a[148:151], v[112:115], a[20:23]
  ds_read_b64_tr_b16 a[194:195], v5 offset:9728
  v_mfma_f32_16x16x32_bf16 a[32:35], a[152:155], v[112:115], a[32:35]
  ds_read_b64_tr_b16 a[196:197], v11 offset:8704
  v_mfma_f32_16x16x32_bf16 a[44:47], a[156:159], v[112:115], a[44:47]
  ds_read_b64_tr_b16 a[198:199], v11 offset:9728
  s_waitcnt lgkmcnt(12)
  v_mfma_f32_16x16x32_bf16 a[96:99], a[160:163], v[104:107], a[96:99]
  ds_read_b64_tr_b16 a[200:201], v5 offset:8960
  v_mfma_f32_16x16x32_bf16 a[108:111], a[164:167], v[104:107], a[108:111]
  ds_read_b64_tr_b16 a[202:203], v5 offset:9984
  v_mfma_f32_16x16x32_bf16 a[120:123], a[168:171], v[104:107], a[120:123]
  ds_read_b64_tr_b16 a[204:205], v11 offset:8960
  v_mfma_f32_16x16x32_bf16 a[132:135], a[172:175], v[104:107], a[132:135]
  ds_read_b64_tr_b16 a[206:207], v11 offset:9984
  v_mfma_f32_16x16x32_bf16 a[100:103], a[160:163], v[108:111], a[100:103]
  ds_read_b32 v248, v251 offset:20480
  v_add_u32 v5, 16384, v2
  v_mfma_f32_16x16x32_bf16 a[112:115], a[164:167], v[108:111], a[112:115]
  v_xor_b32 v11, 8, v5
  v_mfma_f32_16x16x32_bf16 a[124:127], a[168:171], v[108:111], a[124:127]
  v_mfma_f32_16x16x32_bf16 a[136:139], a[172:175], v[108:111], a[136:139]
  v_mfma_f32_16x16x32_bf16 a[104:107], a[160:163], v[112:115], a[104:107]
  v_mfma_f32_16x16x32_bf16 a[116:119], a[164:167], v[112:115], a[116:119]
  v_mfma_f32_16x16x32_bf16 a[128:131], a[168:171], v[112:115], a[128:131]
  v_mfma_f32_16x16x32_bf16 a[140:143], a[172:175], v[112:115], a[140:143]
  s_waitcnt lgkmcnt(0)
  ds_write_b32 v249, v250 offset:0
  v_add_u32 v250, 1, v250
  v_readfirstlane_b32 s56, v248
  s_nop 1
  s_cmp_ge_u32 s56, s54
  s_cbranch_scc0 L_spin_u14
L_spun_u14:
  v_mfma_f32_16x16x32_bf16 a[0:3], a[176:179], v[116:119], a[0:3]
  ds_read_b64_tr_b16 a[144:145], v5 offset:0
  v_mfma_f32_16x16x32_bf16 a[12:15], a[180:183], v[116:119], a[12:15]
  ds_read_b64_tr_b16 a[146:147], v5 offset:1024
  v_mfma_f32_16x16x32_bf16 a[24:27], a[184:187], v[116:119], a[24:27]
  ds_read_b64_tr_b16 a[148:149], v11 offset:0
  v_mfma_f32_16x16x32_bf16 a[36:39], a[188:191], v[116:119], a[36:39]
  ds_read_b64_tr_b16 a[150:151], v11 offset:1024
  v_mfma_f32_16x16x32_bf16 a[4:7], a[176:179], v[120:123], a[4:7]
  ds_read_b64_tr_b16 a[152:153], v5 offset:256
  v_mfma_f32_16x16x32_bf16 a[16:19], a[180:183], v[120:123], a[16:19]
  ds_read_b64_tr_b16 a[154:155], v5 offset:1280
  v_mfma_f32_16x16x32_bf16 a[28:31], a[184:187], v[120:123], a[28:31]
  ds_read_b64_tr_b16 a[156:157], v11 offset:256
  v_mfma_f32_16x16x32_bf16 a[40:43], a[188:191], v[120:123], a[40:43]
  ds_read_b64_tr_b16 a[158:159], v11 offset:1280
  v_mfma_f32_16x16x32_bf16 a[8:11], a[176:179], v[124:127], a[8:11]
  ds_read_b64_tr_b16 a[160:161], v5 offset:512
  v_mfma_f32_16x16x32_bf16 a[20:23], a[180:183], v[124:127], a[20:23]
  ds_read_b64_tr_b16 a[162:163], v5 offset:1536
  v_mfma_f32_16x16x32_bf16 a[32:35], a[184:187], v[124:127], a[32:35]
  ds_read_b64_tr_b16 a[164:165], v11 offset:512
  v_mfma_f32_16x16x32_bf16 a[44:47], a[188:191], v[124:127], a[44:47]
  ds_read_b64_tr_b16 a[166:167], v11 offset:1536
  v_mfma_f32_16x16x32_bf16 a[96:99], a[192:195], v[116:119], a[96:99]
  ds_read_b64_tr_b16 a[168:169], v5 offset:768
  v_mfma_f32_16x16x32_bf16 a[108:111], a[196:199], v[116:119], a[108:111]
  ds_read_b64_tr_b16 a[170:171], v5 offset:1792
  v_mfma_f32_16x16x32_bf16 a[120:123], a[200:203], v[116:119], a[120:123]
  ds_read_b64_tr_b16 a[172:173], v11 offset:768
  v_mfma_f32_16x16x32_bf16 a[132:135], a[204:207], v[116:119], a[132:135]
  ds_read_b64_tr_b16 a[174:175], v11 offset:1792
  v_mfma_f32_16x16x32_bf16 a[100:103], a[192:195], v[120:123], a[100:103]
  v_mfma_f32_16x16x32_bf16 a[112:115], a[196:199], v[120:123], a[112:115]
  v_mfma_f32_16x16x32_bf16 a[124:127], a[200:203], v[120:123], a[124:127]
  v_mfma_f32_16x16x32_bf16 a[136:139], a[204:207], v[120:123], a[136:139]
  v_mfma_f32_16x16x32_bf16 a[104:107], a[192:195], v[124:127], a[104:107]
  v_mfma_f32_16x16x32_bf16 a[116:119], a[196:199], v[124:127], a[116:119]
  v_mfma_f32_16x16x32_bf16 a[128:131], a[200:203], v[124:127], a[128:131]
  v_mfma_f32_16x16x32_bf16 a[140:143], a[204:207], v[124:127], a[140:143]
  s_waitcnt lgkmcnt(8)
  s_waitcnt vmcnt(0)
  s_mul_i32 s62, s3, 6144
  v_mfma_f32_16x16x32_bf16 a[0:3], a[144:147], v[128:131], a[0:3]
  ds_read_b64_tr_b16 a[176:177], v5 offset:8192
  v_mfma_f32_16x16x32_bf16 a[12:15], a[148:151], v[128:131], a[12:15]
  ds_read_b64_tr_b16 a[178:179], v5 offset:9216
  v_mfma_f32_16x16x32_bf16 a[24:27], a[152:155], v[128:131], a[24:27]
  ds_read_b64_tr_b16 a[180:181], v11 offset:8192
  v_mfma_f32_16x16x32_bf16 a[36:39], a[156:159], v[128:131], a[36:39]
  ds_read_b64_tr_b16 a[182:183], v11 offset:9216
  v_mfma_f32_16x16x32_bf16 a[4:7], a[144:147], v[132:135], a[4:7]
  ds_read_b64_tr_b16 a[184:185], v5 offset:8448
  v_mfma_f32_16x16x32_bf16 a[16:19], a[148:151], v[132:135], a[16:19]
  ds_read_b64_tr_b16 a[186:187], v5 offset:9472
  v_mfma_f32_16x16x32_bf16 a[28:31], a[152:155], v[132:135], a[28:31]
  ds_read_b64_tr_b16 a[188:189], v11 offset:8448
  v_mfma_f32_16x16x32_bf16 a[40:43], a[156:159], v[132:135], a[40:43]
  ds_read_b64_tr_b16 a[190:191], v11 offset:9472
  v_mfma_f32_16x16x32_bf16 a[8:11], a[144:147], v[136:139], a[8:11]
  ds_read_b64_tr_b16 a[192:193], v5 offset:8704
  v_mfma_f32_16x16x32_bf16 a[20:23], a[148:151], v[136:139], a[20:23]
  ds_read_b64_tr_b16 a[194:195], v5 offset:9728
  v_mfma_f32_16x16x32_bf16 a[32:35], a[152:155], v[136:139], a[32:35]
  ds_read_b64_tr_b16 a[196:197], v11 offset:8704
  v_mfma_f32_16x16x32_bf16 a[44:47], a[156:159], v[136:139], a[44:47]
  ds_read_b64_tr_b16 a[198:199], v11 offset:9728
  s_waitcnt lgkmcnt(12)
  v_mfma_f32_16x16x32_bf16 a[96:99], a[160:163], v[128:131], a[96:99]
  ds_read_b64_tr_b16 a[200:201], v5 offset:8960
  v_mfma_f32_16x16x32_bf16 a[108:111], a[164:167], v[128:131], a[108:111]
  ds_read_b64_tr_b16 a[202:203], v5 offset:9984
  v_mfma_f32_16x16x32_bf16 a[120:123], a[168:171], v[128:131], a[120:123]
  ds_read_b64_tr_b16 a[204:205], v11 offset:8960
  v_mfma_f32_16x16x32_bf16 a[132:135], a[172:175], v[128:131], a[132:135]
  ds_read_b64_tr_b16 a[206:207], v11 offset:9984
  v_mfma_f32_16x16x32_bf16 a[100:103], a[160:163], v[132:135], a[100:103]
  v_mfma_f32_16x16x32_bf16 a[112:115], a[164:167], v[132:135], a[112:115]
  v_mfma_f32_16x16x32_bf16 a[124:127], a[168:171], v[132:135], a[124:127]
  v_mfma_f32_16x16x32_bf16 a[136:139], a[172:175], v[132:135], a[136:139]
  v_mfma_f32_16x16x32_bf16 a[104:107], a[160:163], v[136:139], a[104:107]
  v_mfma_f32_16x16x32_bf16 a[116:119], a[164:167], v[136:139], a[116:119]
  v_mfma_f32_16x16x32_bf16 a[128:131], a[168:171], v[136:139], a[128:131]
  v_mfma_f32_16x16x32_bf16 a[140:143], a[172:175], v[136:139], a[140:143]
  s_waitcnt lgkmcnt(0)
  ds_write_b32 v249, v250 offset:0
  v_add_u32 v250, 1, v250
  v_mfma_f32_16x16x32_bf16 a[120:123], a[200:203], v[140:143], a[120:123]
  v_mfma_f32_16x16x32_bf16 a[132:135], a[204:207], v[140:143], a[132:135]
  v_mfma_f32_16x16x32_bf16 a[124:127], a[200:203], v[144:147], a[124:127]
  v_mfma_f32_16x16x32_bf16 a[136:139], a[204:207], v[144:147], a[136:139]
  v_mfma_f32_16x16x32_bf16 a[128:131], a[200:203], v[148:151], a[128:131]
  v_mfma_f32_16x16x32_bf16 a[140:143], a[204:207], v[148:151], a[140:143]
  s_add_u32 s55, s4, 3
  s_and_b32 s55, s55, 3
  s_mul_i32 s55, s55, 55296
  s_add_u32 s55, s55, s62
  s_add_u32 s63, s55, 36864
  buffer_store_dwordx4 a[120:123], v9, s[24:27], s63 offen offset:0 sc1
  buffer_store_dwordx4 a[132:135], v9, s[24:27], s63 offen offset:1024 sc1
  v_mfma_f32_16x16x32_bf16 a[96:99], a[192:195], v[140:143], a[96:99]
  v_mfma_f32_16x16x32_bf16 a[108:111], a[196:199], v[140:143], a[108:111]
  s_add_u32 s63, s55, 38912
  buffer_store_dwordx4 a[124:127], v9, s[24:27], s63 offen offset:0 sc1
  buffer_store_dwordx4 a[136:139], v9, s[24:27], s63 offen offset:1024 sc1
  v_mfma_f32_16x16x32_bf16 a[100:103], a[192:195], v[144:147], a[100:103]
  v_mfma_f32_16x16x32_bf16 a[112:115], a[196:199], v[144:147], a[112:115]
  s_add_u32 s63, s55, 40960
  buffer_store_dwordx4 a[128:131], v9, s[24:27], s63 offen offset:0 sc1
  buffer_store_dwordx4 a[140:143], v9, s[24:27], s63 offen offset:1024 sc1
  v_mfma_f32_16x16x32_bf16 a[104:107], a[192:195], v[148:151], a[104:107]
  v_mfma_f32_16x16x32_bf16 a[116:119], a[196:199], v[148:151], a[116:119]
  s_add_u32 s55, s4, 2
  s_and_b32 s55, s55, 3
  s_mul_i32 s55, s55, 55296
  s_add_u32 s55, s55, s62
  s_add_u32 s63, s55, 18432
  buffer_store_dwordx4 a[96:99], v9, s[24:27], s63 offen offset:0 sc1
  buffer_store_dwordx4 a[108:111], v9, s[24:27], s63 offen offset:1024 sc1
  v_mfma_f32_16x16x32_bf16 a[24:27], a[184:187], v[140:143], a[24:27]
  v_mfma_f32_16x16x32_bf16 a[36:39], a[188:191], v[140:143], a[36:39]
  s_add_u32 s63, s55, 20480
  buffer_store_dwordx4 a[100:103], v9, s[24:27], s63 offen offset:0 sc1
  buffer_store_dwordx4 a[112:115], v9, s[24:27], s63 offen offset:1024 sc1
  v_mfma_f32_16x16x32_bf16 a[28:31], a[184:187], v[144:147], a[28:31]
  v_mfma_f32_16x16x32_bf16 a[40:43], a[188:191], v[144:147], a[40:43]
  s_add_u32 s63, s55, 22528
  buffer_store_dwordx4 a[104:107], v9, s[24:27], s63 offen offset:0 sc1
  buffer_store_dwordx4 a[116:119], v9, s[24:27], s63 offen offset:1024 sc1
  v_mfma_f32_16x16x32_bf16 a[32:35], a[184:187], v[148:151], a[32:35]
  v_mfma_f32_16x16x32_bf16 a[44:47], a[188:191], v[148:151], a[44:47]
  s_add_u32 s55, s4, 1
  s_and_b32 s55, s55, 3
  s_mul_i32 s55, s55, 55296
  s_add_u32 s55, s55, s62
  s_add_u32 s63, s55, 0
  buffer_store_dwordx4 a[24:27], v9, s[24:27], s63 offen offset:0 sc1
  buffer_store_dwordx4 a[36:39], v9, s[24:27], s63 offen offset:1024 sc1
  v_mfma_f32_16x16x32_bf16 a[0:3], a[176:179], v[140:143], a[0:3]
  v_mfma_f32_16x16x32_bf16 a[12:15], a[180:183], v[140:143], a[12:15]
  s_add_u32 s63, s55, 2048
  buffer_store_dwordx4 a[28:31], v9, s[24:27], s63 offen offset:0 sc1
  buffer_store_dwordx4 a[40:43], v9, s[24:27], s63 offen offset:1024 sc1
  v_mfma_f32_16x16x32_bf16 a[4:7], a[176:179], v[144:147], a[4:7]
  v_mfma_f32_16x16x32_bf16 a[16:19], a[180:183], v[144:147], a[16:19]
  s_add_u32 s63, s55, 4096
  buffer_store_dwordx4 a[32:35], v9, s[24:27], s63 offen offset:0 sc1
  buffer_store_dwordx4 a[44:47], v9, s[24:27], s63 offen offset:1024 sc1
  v_mfma_f32_16x16x32_bf16 a[8:11], a[176:179], v[148:151], a[8:11]
  v_mfma_f32_16x16x32_bf16 a[20:23], a[180:183], v[148:151], a[20:23]
  v_and_b32 v134, 15, v0
  v_lshlrev_b32 v134, 11, v134
  v_and_b32 v135, 48, v0
  v_add_u32 v134, v134, v135
  v_accvgpr_read_b32 v32, a0
  v_accvgpr_read_b32 v33, a1
  v_accvgpr_read_b32 v34, a2
  v_accvgpr_read_b32 v35, a3
  v_accvgpr_read_b32 v36, a4
  v_accvgpr_read_b32 v37, a5
  v_accvgpr_read_b32 v38, a6
  v_accvgpr_read_b32 v39, a7
  v_accvgpr_read_b32 v40, a8
  v_accvgpr_read_b32 v41, a9
  v_accvgpr_read_b32 v42, a10
  v_accvgpr_read_b32 v43, a11
  v_accvgpr_read_b32 v44, a12
  v_accvgpr_read_b32 v45, a13
  v_accvgpr_read_b32 v46, a14
  v_accvgpr_read_b32 v47, a15
  v_accvgpr_read_b32 v48, a16
  v_accvgpr_read_b32 v49, a17
  v_accvgpr_read_b32 v50, a18
  v_accvgpr_read_b32 v51, a19
  v_accvgpr_read_b32 v52, a20
  v_accvgpr_read_b32 v53, a21
  v_accvgpr_read_b32 v54, a22
  v_accvgpr_read_b32 v55, a23
  s_mov_b64 exec, 1
  v_mov_b32 v252, s39
  s_add_u32 s63, s4, 3
  s_and_b32 s63, s63, 3
  s_lshl_b32 s63, s63, 6
  s_add_u32 s63, s63, s45
  s_waitcnt vmcnt(12)
  buffer_store_dword v252, v9, s[40:43], s63 offen offset:8 sc1
  s_add_u32 s63, s4, 2
  s_and_b32 s63, s63, 3
  s_lshl_b32 s63, s63, 6
  s_add_u32 s63, s63, s45
  s_waitcnt vmcnt(7)
  buffer_store_dword v252, v9, s[40:43], s63 offen offset:4 sc1
  s_add_u32 s63, s4, 1
  s_and_b32 s63, s63, 3
  s_lshl_b32 s63, s63, 6
  s_add_u32 s63, s63, s45
  s_waitcnt vmcnt(2)
  buffer_store_dword v252, v9, s[40:43], s63 offen offset:0 sc1
  buffer_load_dwordx4 v[136:139], v9, s[40:43], s11 offen offset:0 sc1
L_pp:
  s_add_u32 s32, s32, 1
  s_cmp_gt_u32 s32, 4194304
  s_cbranch_scc1 L_k1_end
  buffer_load_dwordx4 v[140:143], v9, s[40:43], s11 offen offset:0 sc1
  s_waitcnt vmcnt(1)
  v_xor_b32 v136, s39, v136
  v_xor_b32 v137, s39, v137
  v_xor_b32 v138, s39, v138
  v_or3_b32 v136, v136, v137, v138
  s_nop 0
  v_readfirstlane_b32 s63, v136
  s_nop 1
  s_cmp_eq_u32 s63, 0
  s_cbranch_scc1 L_ppok
  buffer_load_dwordx4 v[136:139], v9, s[40:43], s11 offen offset:0 sc1
  s_waitcnt vmcnt(1)
  v_xor_b32 v140, s39, v140
  v_xor_b32 v141, s39, v141
  v_xor_b32 v142, s39, v142
  v_or3_b32 v140, v140, v141, v142
  s_nop 0
  v_readfirstlane_b32 s63, v140
  s_nop 1
  s_cmp_eq_u32 s63, 0
  s_cbranch_scc0 L_pp
L_ppok:
  s_mov_b64 exec, -1
  s_mul_i32 s55, s4, 55296
  s_add_u32 s55, s55, s62
  s_add_u32 s63, s55, 0
  buffer_load_dwordx4 v[152:155], v9, s[24:27], s63 offen offset:0 sc1
  buffer_load_dwordx4 v[156:159], v9, s[24:27], s63 offen offset:1024 sc1
  s_add_u32 s63, s55, 18432
  buffer_load_dwordx4 v[160:163], v9, s[24:27], s63 offen offset:0 sc1
  buffer_load_dwordx4 v[164:167], v9, s[24:27], s63 offen offset:1024 sc1
  s_add_u32 s63, s55, 36864
  buffer_load_dwordx4 v[168:171], v9, s[24:27], s63 offen offset:0 sc1
  buffer_load_dwordx4 v[172:175], v9, s[24:27], s63 offen offset:1024 sc1
  s_add_u32 s63, s55, 2048
  buffer_load_dwordx4 v[176:179], v9, s[24:27], s63 offen offset:0 sc1
  buffer_load_dwordx4 v[180:183], v9, s[24:27], s63 offen offset:1024 sc1
  s_add_u32 s63, s55, 20480
  buffer_load_dwordx4 v[184:187], v9, s[24:27], s63 offen offset:0 sc1
  buffer_load_dwordx4 v[188:191], v9, s[24:27], s63 offen offset:1024 sc1
  s_add_u32 s63, s55, 38912
  buffer_load_dwordx4 v[192:195], v9, s[24:27], s63 offen offset:0 sc1
  buffer_load_dwordx4 v[196:199], v9, s[24:27], s63 offen offset:1024 sc1
  s_add_u32 s63, s55, 4096
  buffer_load_dwordx4 v[200:203], v9, s[24:27], s63 offen offset:0 sc1
  buffer_load_dwordx4 v[204:207], v9, s[24:27], s63 offen offset:1024 sc1
  s_add_u32 s63, s55, 22528
  buffer_load_dwordx4 v[208:211], v9, s[24:27], s63 offen offset:0 sc1
  buffer_load_dwordx4 v[212:215], v9, s[24:27], s63 offen offset:1024 sc1
  s_add_u32 s63, s55, 40960
  buffer_load_dwordx4 v[216:219], v9, s[24:27], s63 offen offset:0 sc1
  buffer_load_dwordx4 v[220:223], v9, s[24:27], s63 offen offset:1024 sc1
  s_waitcnt vmcnt(12)
  v_pk_add_f32 v[32:33], v[32:33], v[152:153]
  v_pk_add_f32 v[160:161], v[160:161], v[168:169]
  v_pk_add_f32 v[32:33], v[32:33], v[160:161]
  v_pk_add_f32 v[34:35], v[34:35], v[154:155]
  v_pk_add_f32 v[162:163], v[162:163], v[170:171]
  v_pk_add_f32 v[34:35], v[34:35], v[162:163]
  v_pk_add_f32 v[44:45], v[44:45], v[156:157]
  v_pk_add_f32 v[164:165], v[164:165], v[172:173]
  v_pk_add_f32 v[44:45], v[44:45], v[164:165]
  v_pk_add_f32 v[46:47], v[46:47], v[158:159]
  v_pk_add_f32 v[166:167], v[166:167], v[174:175]
  v_pk_add_f32 v[46:47], v[46:47], v[166:167]
  v_cvt_pk_bf16_f32 v32, v32, v33
  v_cvt_pk_bf16_f32 v34, v34, v35
  v_cvt_pk_bf16_f32 v44, v44, v45
  v_cvt_pk_bf16_f32 v46, v46, v47
  v_cndmask_b32 v152, v32, v44, s[46:47]
  v_cndmask_b32 v154, v44, v32, s[46:47]
  v_cndmask_b32 v153, v34, v46, s[46:47]
  v_cndmask_b32 v155, v46, v34, s[46:47]
  s_mov_b32 s63, 0
  buffer_store_dwordx4 v[152:155], v134, s[28:31], s63 offen offset:0 nt
  s_waitcnt vmcnt(7)
  v_pk_add_f32 v[36:37], v[36:37], v[176:177]
  v_pk_add_f32 v[184:185], v[184:185], v[192:193]
  v_pk_add_f32 v[36:37], v[36:37], v[184:185]
  v_pk_add_f32 v[38:39], v[38:39], v[178:179]
  v_pk_add_f32 v[186:187], v[186:187], v[194:195]
  v_pk_add_f32 v[38:39], v[38:39], v[186:187]
  v_pk_add_f32 v[48:49], v[48:49], v[180:181]
  v_pk_add_f32 v[188:189], v[188:189], v[196:197]
  v_pk_add_f32 v[48:49], v[48:49], v[188:189]
  v_pk_add_f32 v[50:51], v[50:51], v[182:183]
  v_pk_add_f32 v[190:191], v[190:191], v[198:199]
  v_pk_add_f32 v[50:51], v[50:51], v[190:191]
  v_cvt_pk_bf16_f32 v36, v36, v37
  v_cvt_pk_bf16_f32 v38, v38, v39
  v_cvt_pk_bf16_f32 v48, v48, v49
  v_cvt_pk_bf16_f32 v50, v50, v51
  v_cndmask_b32 v176, v36, v48, s[46:47]
  v_cndmask_b32 v178, v48, v36, s[46:47]
  v_cndmask_b32 v177, v38, v50, s[46:47]
  v_cndmask_b32 v179, v50, v38, s[46:47]
  s_mov_b32 s63, 32768
  buffer_store_dwordx4 v[176:179], v134, s[28:31], s63 offen offset:0 nt
  s_waitcnt vmcnt(2)
  v_pk_add_f32 v[40:41], v[40:41], v[200:201]
  v_pk_add_f32 v[208:209], v[208:209], v[216:217]
  v_pk_add_f32 v[40:41], v[40:41], v[208:209]
  v_pk_add_f32 v[42:43], v[42:43], v[202:203]
  v_pk_add_f32 v[210:211], v[210:211], v[218:219]
  v_pk_add_f32 v[42:43], v[42:43], v[210:211]
  v_pk_add_f32 v[52:53], v[52:53], v[204:205]
  v_pk_add_f32 v[212:213], v[212:213], v[220:221]
  v_pk_add_f32 v[52:53], v[52:53], v[212:213]
  v_pk_add_f32 v[54:55], v[54:55], v[206:207]
  v_pk_add_f32 v[214:215], v[214:215], v[222:223]
  v_pk_add_f32 v[54:55], v[54:55], v[214:215]
  v_cvt_pk_bf16_f32 v40, v40, v41
  v_cvt_pk_bf16_f32 v42, v42, v43
  v_cvt_pk_bf16_f32 v52, v52, v53
  v_cvt_pk_bf16_f32 v54, v54, v55
  v_cndmask_b32 v200, v40, v52, s[46:47]
  v_cndmask_b32 v202, v52, v40, s[46:47]
  v_cndmask_b32 v201, v42, v54, s[46:47]
  v_cndmask_b32 v203, v54, v42, s[46:47]
  s_mov_b32 s63, 65536
  buffer_store_dwordx4 v[200:203], v134, s[28:31], s63 offen offset:0 nt
  s_branch L_k1_end
L_qconv2:
  s_lshr_b32 s63, s2, 3
  s_mul_i32 s63, s63, 3
  s_add_u32 s63, s63, s3
  s_lshl_b32 s63, s63, 10
  v_add_u32 v128, s63, v9
  v_min_u32 v128, L_k1_end-concat_heads__gqa_block_cached__gqa_block_cached__near_ridge_kernel-16, v128
  global_load_dwordx4 a[252:255], v128, s[96:97]
  v_accvgpr_read_b32 v128, a0
  v_accvgpr_read_b32 v129, a1
  v_accvgpr_read_b32 v130, a2
  v_accvgpr_read_b32 v131, a3
  v_accvgpr_read_b32 v132, a12
  v_accvgpr_read_b32 v133, a13
  v_accvgpr_read_b32 v134, a14
  v_accvgpr_read_b32 v135, a15
  v_pk_mul_f32 v[128:129], v[128:129], s[58:59]
  v_pk_mul_f32 v[130:131], v[130:131], s[58:59]
  v_pk_mul_f32 v[132:133], v[132:133], s[58:59]
  v_pk_mul_f32 v[134:135], v[134:135], s[58:59]
  v_cvt_pk_bf16_f32 v128, v128, v129
  v_cvt_pk_bf16_f32 v130, v130, v131
  v_cvt_pk_bf16_f32 v132, v132, v133
  v_cvt_pk_bf16_f32 v134, v134, v135
  v_cndmask_b32 v129, v128, v132, s[46:47]
  v_cndmask_b32 v133, v132, v128, s[46:47]
  v_cndmask_b32 v131, v130, v134, s[46:47]
  v_cndmask_b32 v135, v134, v130, s[46:47]
  v_accvgpr_write_b32 a0, v129
  v_accvgpr_write_b32 a1, v131
  v_accvgpr_write_b32 a2, v133
  v_accvgpr_write_b32 a3, v135
  v_accvgpr_read_b32 v128, a4
  v_accvgpr_read_b32 v129, a5
  v_accvgpr_read_b32 v130, a6
  v_accvgpr_read_b32 v131, a7
  v_accvgpr_read_b32 v132, a16
  v_accvgpr_read_b32 v133, a17
  v_accvgpr_read_b32 v134, a18
  v_accvgpr_read_b32 v135, a19
  v_pk_mul_f32 v[128:129], v[128:129], s[58:59]
  v_pk_mul_f32 v[130:131], v[130:131], s[58:59]
  v_pk_mul_f32 v[132:133], v[132:133], s[58:59]
  v_pk_mul_f32 v[134:135], v[134:135], s[58:59]
  v_cvt_pk_bf16_f32 v128, v128, v129
  v_cvt_pk_bf16_f32 v130, v130, v131
  v_cvt_pk_bf16_f32 v132, v132, v133
  v_cvt_pk_bf16_f32 v134, v134, v135
  v_cndmask_b32 v129, v128, v132, s[46:47]
  v_cndmask_b32 v133, v132, v128, s[46:47]
  v_cndmask_b32 v131, v130, v134, s[46:47]
  v_cndmask_b32 v135, v134, v130, s[46:47]
  v_accvgpr_write_b32 a4, v129
  v_accvgpr_write_b32 a5, v131
  v_accvgpr_write_b32 a6, v133
  v_accvgpr_write_b32 a7, v135
  v_accvgpr_read_b32 v128, a8
  v_accvgpr_read_b32 v129, a9
  v_accvgpr_read_b32 v130, a10
  v_accvgpr_read_b32 v131, a11
  v_accvgpr_read_b32 v132, a20
  v_accvgpr_read_b32 v133, a21
  v_accvgpr_read_b32 v134, a22
  v_accvgpr_read_b32 v135, a23
  v_pk_mul_f32 v[128:129], v[128:129], s[58:59]
  v_pk_mul_f32 v[130:131], v[130:131], s[58:59]
  v_pk_mul_f32 v[132:133], v[132:133], s[58:59]
  v_pk_mul_f32 v[134:135], v[134:135], s[58:59]
  v_cvt_pk_bf16_f32 v128, v128, v129
  v_cvt_pk_bf16_f32 v130, v130, v131
  v_cvt_pk_bf16_f32 v132, v132, v133
  v_cvt_pk_bf16_f32 v134, v134, v135
  v_cndmask_b32 v129, v128, v132, s[46:47]
  v_cndmask_b32 v133, v132, v128, s[46:47]
  v_cndmask_b32 v131, v130, v134, s[46:47]
  v_cndmask_b32 v135, v134, v130, s[46:47]
  v_accvgpr_write_b32 a8, v129
  v_accvgpr_write_b32 a9, v131
  v_accvgpr_write_b32 a10, v133
  v_accvgpr_write_b32 a11, v135
  v_accvgpr_read_b32 v128, a24
  v_accvgpr_read_b32 v129, a25
  v_accvgpr_read_b32 v130, a26
  v_accvgpr_read_b32 v131, a27
  v_accvgpr_read_b32 v132, a36
  v_accvgpr_read_b32 v133, a37
  v_accvgpr_read_b32 v134, a38
  v_accvgpr_read_b32 v135, a39
  v_pk_mul_f32 v[128:129], v[128:129], s[58:59]
  v_pk_mul_f32 v[130:131], v[130:131], s[58:59]
  v_pk_mul_f32 v[132:133], v[132:133], s[58:59]
  v_pk_mul_f32 v[134:135], v[134:135], s[58:59]
  v_cvt_pk_bf16_f32 v128, v128, v129
  v_cvt_pk_bf16_f32 v130, v130, v131
  v_cvt_pk_bf16_f32 v132, v132, v133
  v_cvt_pk_bf16_f32 v134, v134, v135
  v_cndmask_b32 v129, v128, v132, s[46:47]
  v_cndmask_b32 v133, v132, v128, s[46:47]
  v_cndmask_b32 v131, v130, v134, s[46:47]
  v_cndmask_b32 v135, v134, v130, s[46:47]
  v_accvgpr_write_b32 a12, v129
  v_accvgpr_write_b32 a13, v131
  v_accvgpr_write_b32 a14, v133
  v_accvgpr_write_b32 a15, v135
  v_accvgpr_read_b32 v128, a28
  v_accvgpr_read_b32 v129, a29
  v_accvgpr_read_b32 v130, a30
  v_accvgpr_read_b32 v131, a31
  v_accvgpr_read_b32 v132, a40
  v_accvgpr_read_b32 v133, a41
  v_accvgpr_read_b32 v134, a42
  v_accvgpr_read_b32 v135, a43
  v_pk_mul_f32 v[128:129], v[128:129], s[58:59]
  v_pk_mul_f32 v[130:131], v[130:131], s[58:59]
  v_pk_mul_f32 v[132:133], v[132:133], s[58:59]
  v_pk_mul_f32 v[134:135], v[134:135], s[58:59]
  v_cvt_pk_bf16_f32 v128, v128, v129
  v_cvt_pk_bf16_f32 v130, v130, v131
  v_cvt_pk_bf16_f32 v132, v132, v133
  v_cvt_pk_bf16_f32 v134, v134, v135
  v_cndmask_b32 v129, v128, v132, s[46:47]
  v_cndmask_b32 v133, v132, v128, s[46:47]
  v_cndmask_b32 v131, v130, v134, s[46:47]
  v_cndmask_b32 v135, v134, v130, s[46:47]
  v_accvgpr_write_b32 a16, v129
  v_accvgpr_write_b32 a17, v131
  v_accvgpr_write_b32 a18, v133
  v_accvgpr_write_b32 a19, v135
  v_accvgpr_read_b32 v128, a32
  v_accvgpr_read_b32 v129, a33
  v_accvgpr_read_b32 v130, a34
  v_accvgpr_read_b32 v131, a35
  v_accvgpr_read_b32 v132, a44
  v_accvgpr_read_b32 v133, a45
  v_accvgpr_read_b32 v134, a46
  v_accvgpr_read_b32 v135, a47
  v_pk_mul_f32 v[128:129], v[128:129], s[58:59]
  v_pk_mul_f32 v[130:131], v[130:131], s[58:59]
  v_pk_mul_f32 v[132:133], v[132:133], s[58:59]
  v_pk_mul_f32 v[134:135], v[134:135], s[58:59]
  v_cvt_pk_bf16_f32 v128, v128, v129
  v_cvt_pk_bf16_f32 v130, v130, v131
  v_cvt_pk_bf16_f32 v132, v132, v133
  v_cvt_pk_bf16_f32 v134, v134, v135
  v_cndmask_b32 v129, v128, v132, s[46:47]
  v_cndmask_b32 v133, v132, v128, s[46:47]
  v_cndmask_b32 v131, v130, v134, s[46:47]
  v_cndmask_b32 v135, v134, v130, s[46:47]
  v_accvgpr_write_b32 a20, v129
  v_accvgpr_write_b32 a21, v131
  v_accvgpr_write_b32 a22, v133
  v_accvgpr_write_b32 a23, v135
  v_accvgpr_read_b32 v128, a48
  v_accvgpr_read_b32 v129, a49
  v_accvgpr_read_b32 v130, a50
  v_accvgpr_read_b32 v131, a51
  v_accvgpr_read_b32 v132, a60
  v_accvgpr_read_b32 v133, a61
  v_accvgpr_read_b32 v134, a62
  v_accvgpr_read_b32 v135, a63
  v_pk_mul_f32 v[128:129], v[128:129], s[58:59]
  v_pk_mul_f32 v[130:131], v[130:131], s[58:59]
  v_pk_mul_f32 v[132:133], v[132:133], s[58:59]
  v_pk_mul_f32 v[134:135], v[134:135], s[58:59]
  v_cvt_pk_bf16_f32 v128, v128, v129
  v_cvt_pk_bf16_f32 v130, v130, v131
  v_cvt_pk_bf16_f32 v132, v132, v133
  v_cvt_pk_bf16_f32 v134, v134, v135
  v_cndmask_b32 v129, v128, v132, s[46:47]
  v_cndmask_b32 v133, v132, v128, s[46:47]
  v_cndmask_b32 v131, v130, v134, s[46:47]
  v_cndmask_b32 v135, v134, v130, s[46:47]
  v_accvgpr_write_b32 a24, v129
  v_accvgpr_write_b32 a25, v131
  v_accvgpr_write_b32 a26, v133
  v_accvgpr_write_b32 a27, v135
  v_accvgpr_read_b32 v128, a52
  v_accvgpr_read_b32 v129, a53
  v_accvgpr_read_b32 v130, a54
  v_accvgpr_read_b32 v131, a55
  v_accvgpr_read_b32 v132, a64
  v_accvgpr_read_b32 v133, a65
  v_accvgpr_read_b32 v134, a66
  v_accvgpr_read_b32 v135, a67
  v_pk_mul_f32 v[128:129], v[128:129], s[58:59]
  v_pk_mul_f32 v[130:131], v[130:131], s[58:59]
  v_pk_mul_f32 v[132:133], v[132:133], s[58:59]
  v_pk_mul_f32 v[134:135], v[134:135], s[58:59]
  v_cvt_pk_bf16_f32 v128, v128, v129
  v_cvt_pk_bf16_f32 v130, v130, v131
  v_cvt_pk_bf16_f32 v132, v132, v133
  v_cvt_pk_bf16_f32 v134, v134, v135
  v_cndmask_b32 v129, v128, v132, s[46:47]
  v_cndmask_b32 v133, v132, v128, s[46:47]
  v_cndmask_b32 v131, v130, v134, s[46:47]
  v_cndmask_b32 v135, v134, v130, s[46:47]
  v_accvgpr_write_b32 a28, v129
  v_accvgpr_write_b32 a29, v131
  v_accvgpr_write_b32 a30, v133
  v_accvgpr_write_b32 a31, v135
  v_accvgpr_read_b32 v128, a56
  v_accvgpr_read_b32 v129, a57
  v_accvgpr_read_b32 v130, a58
  v_accvgpr_read_b32 v131, a59
  v_accvgpr_read_b32 v132, a68
  v_accvgpr_read_b32 v133, a69
  v_accvgpr_read_b32 v134, a70
  v_accvgpr_read_b32 v135, a71
  v_pk_mul_f32 v[128:129], v[128:129], s[58:59]
  v_pk_mul_f32 v[130:131], v[130:131], s[58:59]
  v_pk_mul_f32 v[132:133], v[132:133], s[58:59]
  v_pk_mul_f32 v[134:135], v[134:135], s[58:59]
  v_cvt_pk_bf16_f32 v128, v128, v129
  v_cvt_pk_bf16_f32 v130, v130, v131
  v_cvt_pk_bf16_f32 v132, v132, v133
  v_cvt_pk_bf16_f32 v134, v134, v135
  v_cndmask_b32 v129, v128, v132, s[46:47]
  v_cndmask_b32 v133, v132, v128, s[46:47]
  v_cndmask_b32 v131, v130, v134, s[46:47]
  v_cndmask_b32 v135, v134, v130, s[46:47]
  v_accvgpr_write_b32 a32, v129
  v_accvgpr_write_b32 a33, v131
  v_accvgpr_write_b32 a34, v133
  v_accvgpr_write_b32 a35, v135
  v_accvgpr_read_b32 v128, a72
  v_accvgpr_read_b32 v129, a73
  v_accvgpr_read_b32 v130, a74
  v_accvgpr_read_b32 v131, a75
  v_accvgpr_read_b32 v132, a84
  v_accvgpr_read_b32 v133, a85
  v_accvgpr_read_b32 v134, a86
  v_accvgpr_read_b32 v135, a87
  v_pk_mul_f32 v[128:129], v[128:129], s[58:59]
  v_pk_mul_f32 v[130:131], v[130:131], s[58:59]
  v_pk_mul_f32 v[132:133], v[132:133], s[58:59]
  v_pk_mul_f32 v[134:135], v[134:135], s[58:59]
  v_cvt_pk_bf16_f32 v128, v128, v129
  v_cvt_pk_bf16_f32 v130, v130, v131
  v_cvt_pk_bf16_f32 v132, v132, v133
  v_cvt_pk_bf16_f32 v134, v134, v135
  v_cndmask_b32 v129, v128, v132, s[46:47]
  v_cndmask_b32 v133, v132, v128, s[46:47]
  v_cndmask_b32 v131, v130, v134, s[46:47]
  v_cndmask_b32 v135, v134, v130, s[46:47]
  v_accvgpr_write_b32 a36, v129
  v_accvgpr_write_b32 a37, v131
  v_accvgpr_write_b32 a38, v133
  v_accvgpr_write_b32 a39, v135
  v_accvgpr_read_b32 v128, a76
  v_accvgpr_read_b32 v129, a77
  v_accvgpr_read_b32 v130, a78
  v_accvgpr_read_b32 v131, a79
  v_accvgpr_read_b32 v132, a88
  v_accvgpr_read_b32 v133, a89
  v_accvgpr_read_b32 v134, a90
  v_accvgpr_read_b32 v135, a91
  v_pk_mul_f32 v[128:129], v[128:129], s[58:59]
  v_pk_mul_f32 v[130:131], v[130:131], s[58:59]
  v_pk_mul_f32 v[132:133], v[132:133], s[58:59]
  v_pk_mul_f32 v[134:135], v[134:135], s[58:59]
  v_cvt_pk_bf16_f32 v128, v128, v129
  v_cvt_pk_bf16_f32 v130, v130, v131
  v_cvt_pk_bf16_f32 v132, v132, v133
  v_cvt_pk_bf16_f32 v134, v134, v135
  v_cndmask_b32 v129, v128, v132, s[46:47]
  v_cndmask_b32 v133, v132, v128, s[46:47]
  v_cndmask_b32 v131, v130, v134, s[46:47]
  v_cndmask_b32 v135, v134, v130, s[46:47]
  v_accvgpr_write_b32 a40, v129
  v_accvgpr_write_b32 a41, v131
  v_accvgpr_write_b32 a42, v133
  v_accvgpr_write_b32 a43, v135
  v_accvgpr_read_b32 v128, a80
  v_accvgpr_read_b32 v129, a81
  v_accvgpr_read_b32 v130, a82
  v_accvgpr_read_b32 v131, a83
  v_accvgpr_read_b32 v132, a92
  v_accvgpr_read_b32 v133, a93
  v_accvgpr_read_b32 v134, a94
  v_accvgpr_read_b32 v135, a95
  v_pk_mul_f32 v[128:129], v[128:129], s[58:59]
  v_pk_mul_f32 v[130:131], v[130:131], s[58:59]
  v_pk_mul_f32 v[132:133], v[132:133], s[58:59]
  v_pk_mul_f32 v[134:135], v[134:135], s[58:59]
  v_cvt_pk_bf16_f32 v128, v128, v129
  v_cvt_pk_bf16_f32 v130, v130, v131
  v_cvt_pk_bf16_f32 v132, v132, v133
  v_cvt_pk_bf16_f32 v134, v134, v135
  v_cndmask_b32 v129, v128, v132, s[46:47]
  v_cndmask_b32 v133, v132, v128, s[46:47]
  v_cndmask_b32 v131, v130, v134, s[46:47]
  v_cndmask_b32 v135, v134, v130, s[46:47]
  v_accvgpr_write_b32 a44, v129
  v_accvgpr_write_b32 a45, v131
  v_accvgpr_write_b32 a46, v133
  v_accvgpr_write_b32 a47, v135
  s_branch L_qconv2_back
L_str1_0:
  s_mov_b64 exec, 1
  global_load_dword v254, v9, s[98:99] sc1
  s_mov_b64 exec, -1
  s_lshr_b32 s63, s2, 3
  s_mul_i32 s63, s63, 3
  s_add_u32 s63, s63, s3
  s_lshl_b32 s63, s63, 10
  v_add_u32 v128, s63, v9
  v_min_u32 v128, L_k1_end-concat_heads__gqa_block_cached__gqa_block_cached__near_ridge_kernel-16, v128
  global_load_dwordx4 a[252:255], v128, s[96:97]
  s_branch L_str1_back
L_str1_1:
  s_add_u32 s62, s37, 0
  buffer_store_dwordx4 a[48:51], v9, s[48:51], s62 offen offset:0 sc1
  s_add_u32 s62, s37, 0
  buffer_store_dwordx4 a[60:63], v9, s[48:51], s62 offen offset:1024 sc1
  s_add_u32 s62, s37, 0
  buffer_store_dwordx4 a[72:75], v9, s[48:51], s62 offen offset:2048 sc1
  s_add_u32 s62, s37, 0
  buffer_store_dwordx4 a[84:87], v9, s[48:51], s62 offen offset:3072 sc1
  s_add_u32 s62, s37, 131072
  buffer_store_dwordx4 a[52:55], v9, s[48:51], s62 offen offset:0 sc1
  s_add_u32 s62, s37, 131072
  buffer_store_dwordx4 a[64:67], v9, s[48:51], s62 offen offset:1024 sc1
  s_add_u32 s62, s37, 131072
  buffer_store_dwordx4 a[76:79], v9, s[48:51], s62 offen offset:2048 sc1
  s_add_u32 s62, s37, 131072
  buffer_store_dwordx4 a[88:91], v9, s[48:51], s62 offen offset:3072 sc1
  s_add_u32 s62, s37, 262144
  buffer_store_dwordx4 a[56:59], v9, s[48:51], s62 offen offset:0 sc1
  s_add_u32 s62, s37, 262144
  buffer_store_dwordx4 a[68:71], v9, s[48:51], s62 offen offset:1024 sc1
  s_add_u32 s62, s37, 262144
  buffer_store_dwordx4 a[80:83], v9, s[48:51], s62 offen offset:2048 sc1
  s_add_u32 s62, s37, 262144
  buffer_store_dwordx4 a[92:95], v9, s[48:51], s62 offen offset:3072 sc1
  s_branch L_str1_back
L_getnonce:
  s_add_u32 s32, s32, 1
  s_cmp_gt_u32 s32, 4194304
  s_cbranch_scc1 L_k1_end
  s_mov_b64 exec, 1
  global_load_dword v254, v9, s[98:99] sc1
  s_mov_b64 exec, -1
L_dosig0:
  s_waitcnt vmcnt(0)
  v_readfirstlane_b32 s39, v254
  s_nop 1
  s_cmp_eq_u32 s39, 0
  s_cbranch_scc1 L_getnonce
  s_mov_b64 exec, 1
  v_mov_b32 v252, s39
  buffer_store_dword v252, v9, s[40:43], s44 offen offset:0 sc1
  s_mov_b64 exec, -1
  s_lshr_b32 s63, s2, 3
  s_mul_i32 s63, s63, 3
  s_add_u32 s63, s63, s3
  s_lshl_b32 s63, s63, 10
  v_add_u32 v128, s63, v9
  v_min_u32 v128, L_k1_end-concat_heads__gqa_block_cached__gqa_block_cached__near_ridge_kernel-16, v128
  global_load_dwordx4 a[252:255], v128, s[96:97]
  s_branch L_str1_back
L_spin_init:
  s_sleep 2
  s_add_u32 s32, s32, 1
  s_cmp_gt_u32 s32, 4194304
  s_cbranch_scc1 L_k1_end
  ds_read_b32 v248, v251 offset:20480
  s_waitcnt lgkmcnt(0)
  v_readfirstlane_b32 s56, v248
  s_nop 1
  s_cmp_ge_u32 s56, s54
  s_cbranch_scc0 L_spin_init
  s_branch L_spun_init
L_spin_p0:
  s_sleep 2
  s_add_u32 s32, s32, 1
  s_cmp_gt_u32 s32, 4194304
  s_cbranch_scc1 L_k1_end
  ds_read_b32 v248, v251 offset:20480
  s_waitcnt lgkmcnt(0)
  v_readfirstlane_b32 s56, v248
  s_nop 1
  s_cmp_ge_u32 s56, s54
  s_cbranch_scc0 L_spin_p0
  s_branch L_spun_p0
L_spin_p1:
  s_sleep 2
  s_add_u32 s32, s32, 1
  s_cmp_gt_u32 s32, 4194304
  s_cbranch_scc1 L_k1_end
  ds_read_b32 v248, v251 offset:20480
  s_waitcnt lgkmcnt(0)
  v_readfirstlane_b32 s56, v248
  s_nop 1
  s_cmp_ge_u32 s56, s54
  s_cbranch_scc0 L_spin_p1
  s_branch L_spun_p1
L_spin_p2:
  s_sleep 2
  s_add_u32 s32, s32, 1
  s_cmp_gt_u32 s32, 4194304
  s_cbranch_scc1 L_k1_end
  ds_read_b32 v248, v251 offset:20480
  s_waitcnt lgkmcnt(0)
  v_readfirstlane_b32 s56, v248
  s_nop 1
  s_cmp_ge_u32 s56, s54
  s_cbranch_scc0 L_spin_p2
  s_branch L_spun_p2
L_spin_p3:
  s_sleep 2
  s_add_u32 s32, s32, 1
  s_cmp_gt_u32 s32, 4194304
  s_cbranch_scc1 L_k1_end
  ds_read_b32 v248, v251 offset:20480
  s_waitcnt lgkmcnt(0)
  v_readfirstlane_b32 s56, v248
  s_nop 1
  s_cmp_ge_u32 s56, s54
  s_cbranch_scc0 L_spin_p3
  s_branch L_spun_p3
L_spin_p4:
  s_sleep 2
  s_add_u32 s32, s32, 1
  s_cmp_gt_u32 s32, 4194304
  s_cbranch_scc1 L_k1_end
  ds_read_b32 v248, v251 offset:20480
  s_waitcnt lgkmcnt(0)
  v_readfirstlane_b32 s56, v248
  s_nop 1
  s_cmp_ge_u32 s56, s54
  s_cbranch_scc0 L_spin_p4
  s_branch L_spun_p4
L_spin_p5:
  s_sleep 2
  s_add_u32 s32, s32, 1
  s_cmp_gt_u32 s32, 4194304
  s_cbranch_scc1 L_k1_end
  ds_read_b32 v248, v251 offset:20480
  s_waitcnt lgkmcnt(0)
  v_readfirstlane_b32 s56, v248
  s_nop 1
  s_cmp_ge_u32 s56, s54
  s_cbranch_scc0 L_spin_p5
  s_branch L_spun_p5
L_spin_p6:
  s_sleep 2
  s_add_u32 s32, s32, 1
  s_cmp_gt_u32 s32, 4194304
  s_cbranch_scc1 L_k1_end
  ds_read_b32 v248, v251 offset:20480
  s_waitcnt lgkmcnt(0)
  v_readfirstlane_b32 s56, v248
  s_nop 1
  s_cmp_ge_u32 s56, s54
  s_cbranch_scc0 L_spin_p6
  s_branch L_spun_p6
L_spin_p7:
  s_sleep 2
  s_add_u32 s32, s32, 1
  s_cmp_gt_u32 s32, 4194304
  s_cbranch_scc1 L_k1_end
  ds_read_b32 v248, v251 offset:20480
  s_waitcnt lgkmcnt(0)
  v_readfirstlane_b32 s56, v248
  s_nop 1
  s_cmp_ge_u32 s56, s54
  s_cbranch_scc0 L_spin_p7
  s_branch L_spun_p7
L_spin_p8:
  s_sleep 2
  s_add_u32 s32, s32, 1
  s_cmp_gt_u32 s32, 4194304
  s_cbranch_scc1 L_k1_end
  ds_read_b32 v248, v251 offset:20480
  s_waitcnt lgkmcnt(0)
  v_readfirstlane_b32 s56, v248
  s_nop 1
  s_cmp_ge_u32 s56, s54
  s_cbranch_scc0 L_spin_p8
  s_branch L_spun_p8
L_spin_p9:
  s_sleep 2
  s_add_u32 s32, s32, 1
  s_cmp_gt_u32 s32, 4194304
  s_cbranch_scc1 L_k1_end
  ds_read_b32 v248, v251 offset:20480
  s_waitcnt lgkmcnt(0)
  v_readfirstlane_b32 s56, v248
  s_nop 1
  s_cmp_ge_u32 s56, s54
  s_cbranch_scc0 L_spin_p9
  s_branch L_spun_p9
L_spin_p10:
  s_sleep 2
  s_add_u32 s32, s32, 1
  s_cmp_gt_u32 s32, 4194304
  s_cbranch_scc1 L_k1_end
  ds_read_b32 v248, v251 offset:20480
  s_waitcnt lgkmcnt(0)
  v_readfirstlane_b32 s56, v248
  s_nop 1
  s_cmp_ge_u32 s56, s54
  s_cbranch_scc0 L_spin_p10
  s_branch L_spun_p10
L_spin_p11:
  s_sleep 2
  s_add_u32 s32, s32, 1
  s_cmp_gt_u32 s32, 4194304
  s_cbranch_scc1 L_k1_end
  ds_read_b32 v248, v251 offset:20480
  s_waitcnt lgkmcnt(0)
  v_readfirstlane_b32 s56, v248
  s_nop 1
  s_cmp_ge_u32 s56, s54
  s_cbranch_scc0 L_spin_p11
  s_branch L_spun_p11
L_spin_p12:
  s_sleep 2
  s_add_u32 s32, s32, 1
  s_cmp_gt_u32 s32, 4194304
  s_cbranch_scc1 L_k1_end
  ds_read_b32 v248, v251 offset:20480
  s_waitcnt lgkmcnt(0)
  v_readfirstlane_b32 s56, v248
  s_nop 1
  s_cmp_ge_u32 s56, s54
  s_cbranch_scc0 L_spin_p12
  s_branch L_spun_p12
L_spin_p13:
  s_sleep 2
  s_add_u32 s32, s32, 1
  s_cmp_gt_u32 s32, 4194304
  s_cbranch_scc1 L_k1_end
  ds_read_b32 v248, v251 offset:20480
  s_waitcnt lgkmcnt(0)
  v_readfirstlane_b32 s56, v248
  s_nop 1
  s_cmp_ge_u32 s56, s54
  s_cbranch_scc0 L_spin_p13
  s_branch L_spun_p13
L_spin_p14:
  s_sleep 2
  s_add_u32 s32, s32, 1
  s_cmp_gt_u32 s32, 4194304
  s_cbranch_scc1 L_k1_end
  ds_read_b32 v248, v251 offset:20480
  s_waitcnt lgkmcnt(0)
  v_readfirstlane_b32 s56, v248
  s_nop 1
  s_cmp_ge_u32 s56, s54
  s_cbranch_scc0 L_spin_p14
  s_branch L_spun_p14
L_spin_p15:
  s_sleep 2
  s_add_u32 s32, s32, 1
  s_cmp_gt_u32 s32, 4194304
  s_cbranch_scc1 L_k1_end
  ds_read_b32 v248, v251 offset:20480
  s_waitcnt lgkmcnt(0)
  v_readfirstlane_b32 s56, v248
  s_nop 1
  s_cmp_ge_u32 s56, s54
  s_cbranch_scc0 L_spin_p15
  s_branch L_spun_p15
L_spin_pro0:
  s_sleep 2
  s_add_u32 s32, s32, 1
  s_cmp_gt_u32 s32, 4194304
  s_cbranch_scc1 L_k1_end
  ds_read_b32 v248, v251 offset:20480
  s_waitcnt lgkmcnt(0)
  v_readfirstlane_b32 s56, v248
  s_nop 1
  s_cmp_ge_u32 s56, s54
  s_cbranch_scc0 L_spin_pro0
  s_branch L_spun_pro0
L_spin_te:
  s_sleep 2
  s_add_u32 s32, s32, 1
  s_cmp_gt_u32 s32, 4194304
  s_cbranch_scc1 L_k1_end
  ds_read_b32 v248, v251 offset:20480
  s_waitcnt lgkmcnt(0)
  v_readfirstlane_b32 s56, v248
  s_nop 1
  s_cmp_ge_u32 s56, s54
  s_cbranch_scc0 L_spin_te
  s_branch L_spun_te
L_spin_to:
  s_sleep 2
  s_add_u32 s32, s32, 1
  s_cmp_gt_u32 s32, 4194304
  s_cbranch_scc1 L_k1_end
  ds_read_b32 v248, v251 offset:20480
  s_waitcnt lgkmcnt(0)
  v_readfirstlane_b32 s56, v248
  s_nop 1
  s_cmp_ge_u32 s56, s54
  s_cbranch_scc0 L_spin_to
  s_branch L_spun_to
L_spin_tx:
  s_sleep 2
  s_add_u32 s32, s32, 1
  s_cmp_gt_u32 s32, 4194304
  s_cbranch_scc1 L_k1_end
  ds_read_b32 v248, v251 offset:20480
  s_waitcnt lgkmcnt(0)
  v_readfirstlane_b32 s56, v248
  s_nop 1
  s_cmp_ge_u32 s56, s54
  s_cbranch_scc0 L_spin_tx
  s_branch L_spun_tx
L_spin_bnd:
  s_sleep 2
  s_add_u32 s32, s32, 1
  s_cmp_gt_u32 s32, 4194304
  s_cbranch_scc1 L_k1_end
  ds_read_b32 v248, v251 offset:20480
  s_waitcnt lgkmcnt(0)
  v_readfirstlane_b32 s56, v248
  s_nop 1
  s_cmp_ge_u32 s56, s54
  s_cbranch_scc0 L_spin_bnd
  s_branch L_spun_bnd
L_spin_u0:
  s_sleep 2
  s_add_u32 s32, s32, 1
  s_cmp_gt_u32 s32, 4194304
  s_cbranch_scc1 L_k1_end
  ds_read_b32 v248, v251 offset:20480
  s_waitcnt lgkmcnt(0)
  v_readfirstlane_b32 s56, v248
  s_nop 1
  s_cmp_ge_u32 s56, s54
  s_cbranch_scc0 L_spin_u0
  s_branch L_spun_u0
L_spin_u1:
  s_sleep 2
  s_add_u32 s32, s32, 1
  s_cmp_gt_u32 s32, 4194304
  s_cbranch_scc1 L_k1_end
  ds_read_b32 v248, v251 offset:20480
  s_waitcnt lgkmcnt(0)
  v_readfirstlane_b32 s56, v248
  s_nop 1
  s_cmp_ge_u32 s56, s54
  s_cbranch_scc0 L_spin_u1
  s_branch L_spun_u1
L_spin_u8:
  s_sleep 2
  s_add_u32 s32, s32, 1
  s_cmp_gt_u32 s32, 4194304
  s_cbranch_scc1 L_k1_end
  ds_read_b32 v248, v251 offset:20480
  s_waitcnt lgkmcnt(0)
  v_readfirstlane_b32 s56, v248
  s_nop 1
  s_cmp_ge_u32 s56, s54
  s_cbranch_scc0 L_spin_u8
  s_branch L_spun_u8
L_spin_u9:
  s_sleep 2
  s_add_u32 s32, s32, 1
  s_cmp_gt_u32 s32, 4194304
  s_cbranch_scc1 L_k1_end
  ds_read_b32 v248, v251 offset:20480
  s_waitcnt lgkmcnt(0)
  v_readfirstlane_b32 s56, v248
  s_nop 1
  s_cmp_ge_u32 s56, s54
  s_cbranch_scc0 L_spin_u9
  s_branch L_spun_u9
L_spin_u2:
  s_sleep 2
  s_add_u32 s32, s32, 1
  s_cmp_gt_u32 s32, 4194304
  s_cbranch_scc1 L_k1_end
  ds_read_b32 v248, v251 offset:20480
  s_waitcnt lgkmcnt(0)
  v_readfirstlane_b32 s56, v248
  s_nop 1
  s_cmp_ge_u32 s56, s54
  s_cbranch_scc0 L_spin_u2
  s_branch L_spun_u2
L_spin_u3:
  s_sleep 2
  s_add_u32 s32, s32, 1
  s_cmp_gt_u32 s32, 4194304
  s_cbranch_scc1 L_k1_end
  ds_read_b32 v248, v251 offset:20480
  s_waitcnt lgkmcnt(0)
  v_readfirstlane_b32 s56, v248
  s_nop 1
  s_cmp_ge_u32 s56, s54
  s_cbranch_scc0 L_spin_u3
  s_branch L_spun_u3
L_spin_u4:
  s_sleep 2
  s_add_u32 s32, s32, 1
  s_cmp_gt_u32 s32, 4194304
  s_cbranch_scc1 L_k1_end
  ds_read_b32 v248, v251 offset:20480
  s_waitcnt lgkmcnt(0)
  v_readfirstlane_b32 s56, v248
  s_nop 1
  s_cmp_ge_u32 s56, s54
  s_cbranch_scc0 L_spin_u4
  s_branch L_spun_u4
L_spin_u5:
  s_sleep 2
  s_add_u32 s32, s32, 1
  s_cmp_gt_u32 s32, 4194304
  s_cbranch_scc1 L_k1_end
  ds_read_b32 v248, v251 offset:20480
  s_waitcnt lgkmcnt(0)
  v_readfirstlane_b32 s56, v248
  s_nop 1
  s_cmp_ge_u32 s56, s54
  s_cbranch_scc0 L_spin_u5
  s_branch L_spun_u5
L_spin_u6:
  s_sleep 2
  s_add_u32 s32, s32, 1
  s_cmp_gt_u32 s32, 4194304
  s_cbranch_scc1 L_k1_end
  ds_read_b32 v248, v251 offset:20480
  s_waitcnt lgkmcnt(0)
  v_readfirstlane_b32 s56, v248
  s_nop 1
  s_cmp_ge_u32 s56, s54
  s_cbranch_scc0 L_spin_u6
  s_branch L_spun_u6
L_spin_u7:
  s_sleep 2
  s_add_u32 s32, s32, 1
  s_cmp_gt_u32 s32, 4194304
  s_cbranch_scc1 L_k1_end
  ds_read_b32 v248, v251 offset:20480
  s_waitcnt lgkmcnt(0)
  v_readfirstlane_b32 s56, v248
  s_nop 1
  s_cmp_ge_u32 s56, s54
  s_cbranch_scc0 L_spin_u7
  s_branch L_spun_u7
L_spin_u10:
  s_sleep 2
  s_add_u32 s32, s32, 1
  s_cmp_gt_u32 s32, 4194304
  s_cbranch_scc1 L_k1_end
  ds_read_b32 v248, v251 offset:20480
  s_waitcnt lgkmcnt(0)
  v_readfirstlane_b32 s56, v248
  s_nop 1
  s_cmp_ge_u32 s56, s54
  s_cbranch_scc0 L_spin_u10
  s_branch L_spun_u10
L_spin_u11:
  s_sleep 2
  s_add_u32 s32, s32, 1
  s_cmp_gt_u32 s32, 4194304
  s_cbranch_scc1 L_k1_end
  ds_read_b32 v248, v251 offset:20480
  s_waitcnt lgkmcnt(0)
  v_readfirstlane_b32 s56, v248
  s_nop 1
  s_cmp_ge_u32 s56, s54
  s_cbranch_scc0 L_spin_u11
  s_branch L_spun_u11
L_spin_u12:
  s_sleep 2
  s_add_u32 s32, s32, 1
  s_cmp_gt_u32 s32, 4194304
  s_cbranch_scc1 L_k1_end
  ds_read_b32 v248, v251 offset:20480
  s_waitcnt lgkmcnt(0)
  v_readfirstlane_b32 s56, v248
  s_nop 1
  s_cmp_ge_u32 s56, s54
  s_cbranch_scc0 L_spin_u12
  s_branch L_spun_u12
L_spin_u13:
  s_sleep 2
  s_add_u32 s32, s32, 1
  s_cmp_gt_u32 s32, 4194304
  s_cbranch_scc1 L_k1_end
  ds_read_b32 v248, v251 offset:20480
  s_waitcnt lgkmcnt(0)
  v_readfirstlane_b32 s56, v248
  s_nop 1
  s_cmp_ge_u32 s56, s54
  s_cbranch_scc0 L_spin_u13
  s_branch L_spun_u13
L_spin_u14:
  s_sleep 2
  s_add_u32 s32, s32, 1
  s_cmp_gt_u32 s32, 4194304
  s_cbranch_scc1 L_k1_end
  ds_read_b32 v248, v251 offset:20480
  s_waitcnt lgkmcnt(0)
  v_readfirstlane_b32 s56, v248
  s_nop 1
  s_cmp_ge_u32 s56, s54
  s_cbranch_scc0 L_spin_u14
  s_branch L_spun_u14
L_stub_te:
  s_call_b64 s[60:61], L_rare1
  s_branch L_back_te
L_stub_to:
  s_call_b64 s[60:61], L_rare0
  s_branch L_back_to
L_stub_tx:
  s_call_b64 s[60:61], L_rare1
  s_branch L_back_tx
L_rare0:
  s_nop 9
  v_max3_f32 v128, v32, v33, v34
  v_max3_f32 v128, v128, v35, v44
  v_max3_f32 v128, v128, v45, v46
  v_max3_f32 v128, v128, v47, v56
  v_max3_f32 v128, v128, v57, v58
  v_max3_f32 v128, v128, v59, v68
  v_max3_f32 v128, v128, v69, v70
  v_max_f32 v128, v128, v71
  v_max3_f32 v129, v36, v37, v38
  v_max3_f32 v129, v129, v39, v48
  v_max3_f32 v129, v129, v49, v50
  v_max3_f32 v129, v129, v51, v60
  v_max3_f32 v129, v129, v61, v62
  v_max3_f32 v129, v129, v63, v72
  v_max3_f32 v129, v129, v73, v74
  v_max_f32 v129, v129, v75
  v_max3_f32 v130, v40, v41, v42
  v_max3_f32 v130, v130, v43, v52
  v_max3_f32 v130, v130, v53, v54
  v_max3_f32 v130, v130, v55, v64
  v_max3_f32 v130, v130, v65, v66
  v_max3_f32 v130, v130, v67, v76
  v_max3_f32 v130, v130, v77, v78
  v_max_f32 v130, v130, v79
  v_mov_b32 v131, v128
  s_nop 1
  v_permlane32_swap_b32 v128, v131
  v_max_f32 v128, v128, v131
  v_mov_b32 v131, v129
  s_nop 1
  v_permlane32_swap_b32 v129, v131
  v_max_f32 v129, v129, v131
  v_mov_b32 v131, v130
  s_nop 1
  v_permlane32_swap_b32 v130, v131
  v_max_f32 v130, v130, v131
  v_mov_b32 v131, v128
  s_nop 1
  v_permlane16_swap_b32 v128, v131
  v_max_f32 v128, v128, v131
  v_mov_b32 v131, v129
  s_nop 1
  v_permlane16_swap_b32 v129, v131
  v_max_f32 v129, v129, v131
  v_mov_b32 v131, v130
  s_nop 1
  v_permlane16_swap_b32 v130, v131
  v_max_f32 v130, v130, v131
  v_max_f32 v128, 0, v128
  v_exp_f32 v132, -v128
  v_sub_f32 v20, v20, v128
  v_sub_f32 v21, v21, v128
  v_sub_f32 v22, v22, v128
  v_sub_f32 v23, v23, v128
  v_sub_f32 v32, v32, v128
  v_sub_f32 v33, v33, v128
  v_sub_f32 v34, v34, v128
  v_sub_f32 v35, v35, v128
  v_sub_f32 v44, v44, v128
  v_sub_f32 v45, v45, v128
  v_sub_f32 v46, v46, v128
  v_sub_f32 v47, v47, v128
  v_sub_f32 v56, v56, v128
  v_sub_f32 v57, v57, v128
  v_sub_f32 v58, v58, v128
  v_sub_f32 v59, v59, v128
  v_sub_f32 v68, v68, v128
  v_sub_f32 v69, v69, v128
  v_sub_f32 v70, v70, v128
  v_sub_f32 v71, v71, v128
  v_mul_f32 v152, v132, v152
  v_mul_f32 v153, v132, v153
  v_mul_f32 v154, v132, v154
  v_mul_f32 v155, v132, v155
  v_mul_f32 v164, v132, v164
  v_mul_f32 v165, v132, v165
  v_mul_f32 v166, v132, v166
  v_mul_f32 v167, v132, v167
  v_mul_f32 v176, v132, v176
  v_mul_f32 v177, v132, v177
  v_mul_f32 v178, v132, v178
  v_mul_f32 v179, v132, v179
  v_mul_f32 v188, v132, v188
  v_mul_f32 v189, v132, v189
  v_mul_f32 v190, v132, v190
  v_mul_f32 v191, v132, v191
  v_mul_f32 v200, v132, v200
  v_mul_f32 v201, v132, v201
  v_mul_f32 v202, v132, v202
  v_mul_f32 v203, v132, v203
  v_mul_f32 v212, v132, v212
  v_mul_f32 v213, v132, v213
  v_mul_f32 v214, v132, v214
  v_mul_f32 v215, v132, v215
  v_mul_f32 v224, v132, v224
  v_mul_f32 v225, v132, v225
  v_mul_f32 v226, v132, v226
  v_mul_f32 v227, v132, v227
  v_mul_f32 v236, v132, v236
  v_mul_f32 v237, v132, v237
  v_mul_f32 v238, v132, v238
  v_mul_f32 v239, v132, v239
  v_mul_f32 v12, v132, v12
  v_mul_f32 v13, v132, v13
  v_max_f32 v129, 0, v129
  v_exp_f32 v133, -v129
  v_sub_f32 v24, v24, v129
  v_sub_f32 v25, v25, v129
  v_sub_f32 v26, v26, v129
  v_sub_f32 v27, v27, v129
  v_sub_f32 v36, v36, v129
  v_sub_f32 v37, v37, v129
  v_sub_f32 v38, v38, v129
  v_sub_f32 v39, v39, v129
  v_sub_f32 v48, v48, v129
  v_sub_f32 v49, v49, v129
  v_sub_f32 v50, v50, v129
  v_sub_f32 v51, v51, v129
  v_sub_f32 v60, v60, v129
  v_sub_f32 v61, v61, v129
  v_sub_f32 v62, v62, v129
  v_sub_f32 v63, v63, v129
  v_sub_f32 v72, v72, v129
  v_sub_f32 v73, v73, v129
  v_sub_f32 v74, v74, v129
  v_sub_f32 v75, v75, v129
  v_mul_f32 v156, v133, v156
  v_mul_f32 v157, v133, v157
  v_mul_f32 v158, v133, v158
  v_mul_f32 v159, v133, v159
  v_mul_f32 v168, v133, v168
  v_mul_f32 v169, v133, v169
  v_mul_f32 v170, v133, v170
  v_mul_f32 v171, v133, v171
  v_mul_f32 v180, v133, v180
  v_mul_f32 v181, v133, v181
  v_mul_f32 v182, v133, v182
  v_mul_f32 v183, v133, v183
  v_mul_f32 v192, v133, v192
  v_mul_f32 v193, v133, v193
  v_mul_f32 v194, v133, v194
  v_mul_f32 v195, v133, v195
  v_mul_f32 v204, v133, v204
  v_mul_f32 v205, v133, v205
  v_mul_f32 v206, v133, v206
  v_mul_f32 v207, v133, v207
  v_mul_f32 v216, v133, v216
  v_mul_f32 v217, v133, v217
  v_mul_f32 v218, v133, v218
  v_mul_f32 v219, v133, v219
  v_mul_f32 v228, v133, v228
  v_mul_f32 v229, v133, v229
  v_mul_f32 v230, v133, v230
  v_mul_f32 v231, v133, v231
  v_mul_f32 v240, v133, v240
  v_mul_f32 v241, v133, v241
  v_mul_f32 v242, v133, v242
  v_mul_f32 v243, v133, v243
  v_mul_f32 v14, v133, v14
  v_mul_f32 v15, v133, v15
  v_max_f32 v130, 0, v130
  v_exp_f32 v134, -v130
  v_sub_f32 v28, v28, v130
  v_sub_f32 v29, v29, v130
  v_sub_f32 v30, v30, v130
  v_sub_f32 v31, v31, v130
  v_sub_f32 v40, v40, v130
  v_sub_f32 v41, v41, v130
  v_sub_f32 v42, v42, v130
  v_sub_f32 v43, v43, v130
  v_sub_f32 v52, v52, v130
  v_sub_f32 v53, v53, v130
  v_sub_f32 v54, v54, v130
  v_sub_f32 v55, v55, v130
  v_sub_f32 v64, v64, v130
  v_sub_f32 v65, v65, v130
  v_sub_f32 v66, v66, v130
  v_sub_f32 v67, v67, v130
  v_sub_f32 v76, v76, v130
  v_sub_f32 v77, v77, v130
  v_sub_f32 v78, v78, v130
  v_sub_f32 v79, v79, v130
  v_mul_f32 v160, v134, v160
  v_mul_f32 v161, v134, v161
  v_mul_f32 v162, v134, v162
  v_mul_f32 v163, v134, v163
  v_mul_f32 v172, v134, v172
  v_mul_f32 v173, v134, v173
  v_mul_f32 v174, v134, v174
  v_mul_f32 v175, v134, v175
  v_mul_f32 v184, v134, v184
  v_mul_f32 v185, v134, v185
  v_mul_f32 v186, v134, v186
  v_mul_f32 v187, v134, v187
  v_mul_f32 v196, v134, v196
  v_mul_f32 v197, v134, v197
  v_mul_f32 v198, v134, v198
  v_mul_f32 v199, v134, v199
  v_mul_f32 v208, v134, v208
  v_mul_f32 v209, v134, v209
  v_mul_f32 v210, v134, v210
  v_mul_f32 v211, v134, v211
  v_mul_f32 v220, v134, v220
  v_mul_f32 v221, v134, v221
  v_mul_f32 v222, v134, v222
  v_mul_f32 v223, v134, v223
  v_mul_f32 v232, v134, v232
  v_mul_f32 v233, v134, v233
  v_mul_f32 v234, v134, v234
  v_mul_f32 v235, v134, v235
  v_mul_f32 v244, v134, v244
  v_mul_f32 v245, v134, v245
  v_mul_f32 v246, v134, v246
  v_mul_f32 v247, v134, v247
  v_mul_f32 v16, v134, v16
  v_mul_f32 v17, v134, v17
  s_nop 3
  s_setpc_b64 s[60:61]
L_rare1:
  s_nop 9
  v_max3_f32 v128, v80, v81, v82
  v_max3_f32 v128, v128, v83, v92
  v_max3_f32 v128, v128, v93, v94
  v_max3_f32 v128, v128, v95, v104
  v_max3_f32 v128, v128, v105, v106
  v_max3_f32 v128, v128, v107, v116
  v_max3_f32 v128, v128, v117, v118
  v_max_f32 v128, v128, v119
  v_max3_f32 v129, v84, v85, v86
  v_max3_f32 v129, v129, v87, v96
  v_max3_f32 v129, v129, v97, v98
  v_max3_f32 v129, v129, v99, v108
  v_max3_f32 v129, v129, v109, v110
  v_max3_f32 v129, v129, v111, v120
  v_max3_f32 v129, v129, v121, v122
  v_max_f32 v129, v129, v123
  v_max3_f32 v130, v88, v89, v90
  v_max3_f32 v130, v130, v91, v100
  v_max3_f32 v130, v130, v101, v102
  v_max3_f32 v130, v130, v103, v112
  v_max3_f32 v130, v130, v113, v114
  v_max3_f32 v130, v130, v115, v124
  v_max3_f32 v130, v130, v125, v126
  v_max_f32 v130, v130, v127
  v_mov_b32 v131, v128
  s_nop 1
  v_permlane32_swap_b32 v128, v131
  v_max_f32 v128, v128, v131
  v_mov_b32 v131, v129
  s_nop 1
  v_permlane32_swap_b32 v129, v131
  v_max_f32 v129, v129, v131
  v_mov_b32 v131, v130
  s_nop 1
  v_permlane32_swap_b32 v130, v131
  v_max_f32 v130, v130, v131
  v_mov_b32 v131, v128
  s_nop 1
  v_permlane16_swap_b32 v128, v131
  v_max_f32 v128, v128, v131
  v_mov_b32 v131, v129
  s_nop 1
  v_permlane16_swap_b32 v129, v131
  v_max_f32 v129, v129, v131
  v_mov_b32 v131, v130
  s_nop 1
  v_permlane16_swap_b32 v130, v131
  v_max_f32 v130, v130, v131
  v_max_f32 v128, 0, v128
  v_exp_f32 v132, -v128
  v_sub_f32 v20, v20, v128
  v_sub_f32 v21, v21, v128
  v_sub_f32 v22, v22, v128
  v_sub_f32 v23, v23, v128
  v_sub_f32 v80, v80, v128
  v_sub_f32 v81, v81, v128
  v_sub_f32 v82, v82, v128
  v_sub_f32 v83, v83, v128
  v_sub_f32 v92, v92, v128
  v_sub_f32 v93, v93, v128
  v_sub_f32 v94, v94, v128
  v_sub_f32 v95, v95, v128
  v_sub_f32 v104, v104, v128
  v_sub_f32 v105, v105, v128
  v_sub_f32 v106, v106, v128
  v_sub_f32 v107, v107, v128
  v_sub_f32 v116, v116, v128
  v_sub_f32 v117, v117, v128
  v_sub_f32 v118, v118, v128
  v_sub_f32 v119, v119, v128
  v_mul_f32 v152, v132, v152
  v_mul_f32 v153, v132, v153
  v_mul_f32 v154, v132, v154
  v_mul_f32 v155, v132, v155
  v_mul_f32 v164, v132, v164
  v_mul_f32 v165, v132, v165
  v_mul_f32 v166, v132, v166
  v_mul_f32 v167, v132, v167
  v_mul_f32 v176, v132, v176
  v_mul_f32 v177, v132, v177
  v_mul_f32 v178, v132, v178
  v_mul_f32 v179, v132, v179
  v_mul_f32 v188, v132, v188
  v_mul_f32 v189, v132, v189
  v_mul_f32 v190, v132, v190
  v_mul_f32 v191, v132, v191
  v_mul_f32 v200, v132, v200
  v_mul_f32 v201, v132, v201
  v_mul_f32 v202, v132, v202
  v_mul_f32 v203, v132, v203
  v_mul_f32 v212, v132, v212
  v_mul_f32 v213, v132, v213
  v_mul_f32 v214, v132, v214
  v_mul_f32 v215, v132, v215
  v_mul_f32 v224, v132, v224
  v_mul_f32 v225, v132, v225
  v_mul_f32 v226, v132, v226
  v_mul_f32 v227, v132, v227
  v_mul_f32 v236, v132, v236
  v_mul_f32 v237, v132, v237
  v_mul_f32 v238, v132, v238
  v_mul_f32 v239, v132, v239
  v_mul_f32 v12, v132, v12
  v_mul_f32 v13, v132, v13
  v_max_f32 v129, 0, v129
  v_exp_f32 v133, -v129
  v_sub_f32 v24, v24, v129
  v_sub_f32 v25, v25, v129
  v_sub_f32 v26, v26, v129
  v_sub_f32 v27, v27, v129
  v_sub_f32 v84, v84, v129
  v_sub_f32 v85, v85, v129
  v_sub_f32 v86, v86, v129
  v_sub_f32 v87, v87, v129
  v_sub_f32 v96, v96, v129
  v_sub_f32 v97, v97, v129
  v_sub_f32 v98, v98, v129
  v_sub_f32 v99, v99, v129
  v_sub_f32 v108, v108, v129
  v_sub_f32 v109, v109, v129
  v_sub_f32 v110, v110, v129
  v_sub_f32 v111, v111, v129
  v_sub_f32 v120, v120, v129
  v_sub_f32 v121, v121, v129
  v_sub_f32 v122, v122, v129
  v_sub_f32 v123, v123, v129
  v_mul_f32 v156, v133, v156
  v_mul_f32 v157, v133, v157
  v_mul_f32 v158, v133, v158
  v_mul_f32 v159, v133, v159
  v_mul_f32 v168, v133, v168
  v_mul_f32 v169, v133, v169
  v_mul_f32 v170, v133, v170
  v_mul_f32 v171, v133, v171
  v_mul_f32 v180, v133, v180
  v_mul_f32 v181, v133, v181
  v_mul_f32 v182, v133, v182
  v_mul_f32 v183, v133, v183
  v_mul_f32 v192, v133, v192
  v_mul_f32 v193, v133, v193
  v_mul_f32 v194, v133, v194
  v_mul_f32 v195, v133, v195
  v_mul_f32 v204, v133, v204
  v_mul_f32 v205, v133, v205
  v_mul_f32 v206, v133, v206
  v_mul_f32 v207, v133, v207
  v_mul_f32 v216, v133, v216
  v_mul_f32 v217, v133, v217
  v_mul_f32 v218, v133, v218
  v_mul_f32 v219, v133, v219
  v_mul_f32 v228, v133, v228
  v_mul_f32 v229, v133, v229
  v_mul_f32 v230, v133, v230
  v_mul_f32 v231, v133, v231
  v_mul_f32 v240, v133, v240
  v_mul_f32 v241, v133, v241
  v_mul_f32 v242, v133, v242
  v_mul_f32 v243, v133, v243
  v_mul_f32 v14, v133, v14
  v_mul_f32 v15, v133, v15
  v_max_f32 v130, 0, v130
  v_exp_f32 v134, -v130
  v_sub_f32 v28, v28, v130
  v_sub_f32 v29, v29, v130
  v_sub_f32 v30, v30, v130
  v_sub_f32 v31, v31, v130
  v_sub_f32 v88, v88, v130
  v_sub_f32 v89, v89, v130
  v_sub_f32 v90, v90, v130
  v_sub_f32 v91, v91, v130
  v_sub_f32 v100, v100, v130
  v_sub_f32 v101, v101, v130
  v_sub_f32 v102, v102, v130
  v_sub_f32 v103, v103, v130
  v_sub_f32 v112, v112, v130
  v_sub_f32 v113, v113, v130
  v_sub_f32 v114, v114, v130
  v_sub_f32 v115, v115, v130
  v_sub_f32 v124, v124, v130
  v_sub_f32 v125, v125, v130
  v_sub_f32 v126, v126, v130
  v_sub_f32 v127, v127, v130
  v_mul_f32 v160, v134, v160
  v_mul_f32 v161, v134, v161
  v_mul_f32 v162, v134, v162
  v_mul_f32 v163, v134, v163
  v_mul_f32 v172, v134, v172
  v_mul_f32 v173, v134, v173
  v_mul_f32 v174, v134, v174
  v_mul_f32 v175, v134, v175
  v_mul_f32 v184, v134, v184
  v_mul_f32 v185, v134, v185
  v_mul_f32 v186, v134, v186
  v_mul_f32 v187, v134, v187
  v_mul_f32 v196, v134, v196
  v_mul_f32 v197, v134, v197
  v_mul_f32 v198, v134, v198
  v_mul_f32 v199, v134, v199
  v_mul_f32 v208, v134, v208
  v_mul_f32 v209, v134, v209
  v_mul_f32 v210, v134, v210
  v_mul_f32 v211, v134, v211
  v_mul_f32 v220, v134, v220
  v_mul_f32 v221, v134, v221
  v_mul_f32 v222, v134, v222
  v_mul_f32 v223, v134, v223
  v_mul_f32 v232, v134, v232
  v_mul_f32 v233, v134, v233
  v_mul_f32 v234, v134, v234
  v_mul_f32 v235, v134, v235
  v_mul_f32 v244, v134, v244
  v_mul_f32 v245, v134, v245
  v_mul_f32 v246, v134, v246
  v_mul_f32 v247, v134, v247
  v_mul_f32 v16, v134, v16
  v_mul_f32 v17, v134, v17
  s_nop 3
  s_setpc_b64 s[60:61]
L_gspin_pl0:
  s_add_u32 s32, s32, 1
  s_cmp_gt_u32 s32, 4194304
  s_cbranch_scc1 L_k1_end
  s_sleep 1
  s_mov_b64 exec, 1
  buffer_load_dwordx4 v[252:255], v9, s[40:43], s10 offen offset:0 sc1
  s_mov_b64 exec, -1
  s_waitcnt vmcnt(0)
  v_xor_b32 v252, s39, v252
  v_xor_b32 v253, s39, v253
  v_xor_b32 v254, s39, v254
  v_xor_b32 v255, s39, v255
  v_or3_b32 v252, v252, v253, v254
  v_or_b32 v252, v252, v255
  s_nop 0
  v_readfirstlane_b32 s63, v252
  s_nop 1
  s_cmp_eq_u32 s63, 0
  s_cbranch_scc0 L_gspin_pl0
  s_branch L_gspun_pl0
L_gspin_pl1:
  s_add_u32 s32, s32, 1
  s_cmp_gt_u32 s32, 4194304
  s_cbranch_scc1 L_k1_end
  s_sleep 1
  s_mov_b64 exec, 1
  buffer_load_dwordx4 v[252:255], v9, s[40:43], s10 offen offset:128 sc1
  s_mov_b64 exec, -1
  s_waitcnt vmcnt(0)
  v_xor_b32 v252, s39, v252
  v_xor_b32 v253, s39, v253
  v_xor_b32 v254, s39, v254
  v_xor_b32 v255, s39, v255
  v_or3_b32 v252, v252, v253, v254
  v_or_b32 v252, v252, v255
  s_nop 0
  v_readfirstlane_b32 s63, v252
  s_nop 1
  s_cmp_eq_u32 s63, 0
  s_cbranch_scc0 L_gspin_pl1
  s_branch L_gspun_pl1
L_loader:
  s_lshl_b32 s6, s5, 8
  s_sub_u32 s7, 4194304, s6
  s_add_u32 s48, s72, s6
  s_addc_u32 s49, s73, 0
  s_mov_b32 s50, s7
  s_mov_b32 s51, 131072
  v_bfe_u32 v16, v0, 2, 2
  v_add_u32 v15, s4, v13
  v_and_b32 v15, 3, v15
  v_lshlrev_b32 v15, 6, v15
  v_lshl_add_u32 v15, v16, 10, v15
  v_lshl_add_u32 v44, v19, 4, v15
  v_xor_b32 v46, 16, v44
  v_add_u32 v45, 15360, v44
  v_add_u32 v47, 17408, v46
  v_add_u32 v46, 2048, v46
  s_mov_b32 s56, 0
  s_mov_b32 s44, 0
  v_mov_b32 v40, 131072
  v_lshlrev_b32 v9, 4, v0
  s_waitcnt vmcnt(32)
  s_max_u32 s44, s44, 1
  v_mov_b32 v30, s44
  ds_write_b32 v40, v30 offset:20480
  s_add_u32 s22, s20, 1
  s_and_b32 s22, s22, 7
  s_lshl_b32 s22, s22, 7
  s_mov_b32 m0, 133120
  s_nop 0
  buffer_load_dwordx4 v20, s[16:19], s22 offen offset:0 lds
  buffer_load_dwordx4 v21, s[16:19], s22 offen offset:1024 lds
  buffer_load_dwordx4 v22, s[16:19], s22 offen offset:2048 lds
  buffer_load_dwordx4 v23, s[16:19], s22 offen offset:3072 lds
  s_add_u32 s22, s22, 32768
  s_mov_b32 m0, 137216
  s_nop 0
  buffer_load_dwordx4 v20, s[16:19], s22 offen offset:0 lds
  buffer_load_dwordx4 v21, s[16:19], s22 offen offset:1024 lds
  buffer_load_dwordx4 v22, s[16:19], s22 offen offset:2048 lds
  buffer_load_dwordx4 v23, s[16:19], s22 offen offset:3072 lds
  s_add_u32 s22, s22, 32768
  s_mov_b32 m0, 141312
  s_nop 0
  buffer_load_dwordx4 v20, s[16:19], s22 offen offset:0 lds
  buffer_load_dwordx4 v21, s[16:19], s22 offen offset:1024 lds
  buffer_load_dwordx4 v22, s[16:19], s22 offen offset:2048 lds
  buffer_load_dwordx4 v23, s[16:19], s22 offen offset:3072 lds
  s_add_u32 s22, s22, 32768
  s_mov_b32 m0, 145408
  s_nop 0
  buffer_load_dwordx4 v20, s[16:19], s22 offen offset:0 lds
  buffer_load_dwordx4 v21, s[16:19], s22 offen offset:1024 lds
  buffer_load_dwordx4 v22, s[16:19], s22 offen offset:2048 lds
  buffer_load_dwordx4 v23, s[16:19], s22 offen offset:3072 lds
  s_add_u32 s22, s22, 32768
  s_mov_b32 m0, 149504
  s_nop 0
  buffer_load_dwordx4 v20, s[16:19], s22 offen offset:0 lds
  buffer_load_dwordx4 v21, s[16:19], s22 offen offset:1024 lds
  s_waitcnt vmcnt(34)
  s_max_u32 s44, s44, 2
  v_mov_b32 v30, s44
  ds_write_b32 v40, v30 offset:20480
  s_add_u32 s21, s20, 1
  s_and_b32 s21, s21, 7
  s_lshl_b32 s21, s21, 19
  s_add_u32 s21, s21, s35
  s_mov_b32 m0, 49152
  s_nop 0
  buffer_load_dwordx4 v36, s[40:43], s21 offen offset:0 lds
  buffer_load_dwordx4 v37, s[40:43], s21 offen offset:1024 lds
  buffer_load_dwordx4 v38, s[40:43], s21 offen offset:2048 lds
  buffer_load_dwordx4 v39, s[40:43], s21 offen offset:3072 lds
  s_add_u32 s21, s21, 131072
  s_mov_b32 m0, 53248
  s_nop 0
  buffer_load_dwordx4 v36, s[40:43], s21 offen offset:0 lds
  buffer_load_dwordx4 v37, s[40:43], s21 offen offset:1024 lds
  buffer_load_dwordx4 v38, s[40:43], s21 offen offset:2048 lds
  buffer_load_dwordx4 v39, s[40:43], s21 offen offset:3072 lds
  s_add_u32 s21, s21, 131072
  s_mov_b32 m0, 57344
  s_nop 0
  buffer_load_dwordx4 v36, s[40:43], s21 offen offset:0 lds
  buffer_load_dwordx4 v37, s[40:43], s21 offen offset:1024 lds
  buffer_load_dwordx4 v38, s[40:43], s21 offen offset:2048 lds
  buffer_load_dwordx4 v39, s[40:43], s21 offen offset:3072 lds
  s_add_u32 s21, s21, 131072
  s_mov_b32 m0, 61440
  s_nop 0
  buffer_load_dwordx4 v36, s[40:43], s21 offen offset:0 lds
  buffer_load_dwordx4 v37, s[40:43], s21 offen offset:1024 lds
  buffer_load_dwordx4 v38, s[40:43], s21 offen offset:2048 lds
  buffer_load_dwordx4 v39, s[40:43], s21 offen offset:3072 lds
  s_waitcnt vmcnt(34)
  s_max_u32 s44, s44, 3
  v_mov_b32 v30, s44
  ds_write_b32 v40, v30 offset:20480
  s_add_u32 s21, s20, 1
  s_and_b32 s21, s21, 7
  s_lshl_b32 s21, s21, 19
  s_add_u32 s21, s21, s36
  s_mov_b32 m0, 65536
  s_nop 0
  buffer_load_dwordx4 v36, s[40:43], s21 offen offset:0 lds
  buffer_load_dwordx4 v37, s[40:43], s21 offen offset:1024 lds
  buffer_load_dwordx4 v38, s[40:43], s21 offen offset:2048 lds
  buffer_load_dwordx4 v39, s[40:43], s21 offen offset:3072 lds
  s_add_u32 s21, s21, 131072
  s_mov_b32 m0, 69632
  s_nop 0
  buffer_load_dwordx4 v36, s[40:43], s21 offen offset:0 lds
  buffer_load_dwordx4 v37, s[40:43], s21 offen offset:1024 lds
  buffer_load_dwordx4 v38, s[40:43], s21 offen offset:2048 lds
  buffer_load_dwordx4 v39, s[40:43], s21 offen offset:3072 lds
  s_add_u32 s21, s21, 131072
  s_mov_b32 m0, 73728
  s_nop 0
  buffer_load_dwordx4 v36, s[40:43], s21 offen offset:0 lds
  buffer_load_dwordx4 v37, s[40:43], s21 offen offset:1024 lds
  buffer_load_dwordx4 v38, s[40:43], s21 offen offset:2048 lds
  buffer_load_dwordx4 v39, s[40:43], s21 offen offset:3072 lds
  s_add_u32 s21, s21, 131072
  s_mov_b32 m0, 77824
  s_nop 0
  buffer_load_dwordx4 v36, s[40:43], s21 offen offset:0 lds
  buffer_load_dwordx4 v37, s[40:43], s21 offen offset:1024 lds
  buffer_load_dwordx4 v38, s[40:43], s21 offen offset:2048 lds
  buffer_load_dwordx4 v39, s[40:43], s21 offen offset:3072 lds
  s_waitcnt vmcnt(32)
  s_max_u32 s44, s44, 4
  v_mov_b32 v30, s44
  ds_write_b32 v40, v30 offset:20480
  s_cmp_ge_u32 s56, 1
  s_cbranch_scc1 L_free_6
  s_mov_b32 s54, 1
  s_mov_b32 s23, 6
  s_mov_b32 s45, 5
  s_call_b64 s[60:61], L_poll
L_free_6:
  s_add_u32 s22, s20, 2
  s_and_b32 s22, s22, 7
  s_lshl_b32 s22, s22, 7
  s_mov_b32 m0, 114688
  s_nop 0
  buffer_load_dwordx4 v20, s[16:19], s22 offen offset:0 lds
  buffer_load_dwordx4 v21, s[16:19], s22 offen offset:1024 lds
  buffer_load_dwordx4 v22, s[16:19], s22 offen offset:2048 lds
  buffer_load_dwordx4 v23, s[16:19], s22 offen offset:3072 lds
  s_add_u32 s22, s22, 32768
  s_mov_b32 m0, 118784
  s_nop 0
  buffer_load_dwordx4 v20, s[16:19], s22 offen offset:0 lds
  buffer_load_dwordx4 v21, s[16:19], s22 offen offset:1024 lds
  buffer_load_dwordx4 v22, s[16:19], s22 offen offset:2048 lds
  buffer_load_dwordx4 v23, s[16:19], s22 offen offset:3072 lds
  s_add_u32 s22, s22, 32768
  s_mov_b32 m0, 122880
  s_nop 0
  buffer_load_dwordx4 v20, s[16:19], s22 offen offset:0 lds
  buffer_load_dwordx4 v21, s[16:19], s22 offen offset:1024 lds
  buffer_load_dwordx4 v22, s[16:19], s22 offen offset:2048 lds
  buffer_load_dwordx4 v23, s[16:19], s22 offen offset:3072 lds
  s_add_u32 s22, s22, 32768
  s_mov_b32 m0, 126976
  s_nop 0
  buffer_load_dwordx4 v20, s[16:19], s22 offen offset:0 lds
  buffer_load_dwordx4 v21, s[16:19], s22 offen offset:1024 lds
  buffer_load_dwordx4 v22, s[16:19], s22 offen offset:2048 lds
  buffer_load_dwordx4 v23, s[16:19], s22 offen offset:3072 lds
  s_add_u32 s22, s22, 32768
  s_mov_b32 m0, 131072
  s_nop 0
  buffer_load_dwordx4 v20, s[16:19], s22 offen offset:0 lds
  buffer_load_dwordx4 v21, s[16:19], s22 offen offset:1024 lds
  s_waitcnt vmcnt(34)
  s_max_u32 s44, s44, 5
  v_mov_b32 v30, s44
  ds_write_b32 v40, v30 offset:20480
  s_cmp_ge_u32 s56, 1
  s_cbranch_scc1 L_free_7
  s_mov_b32 s54, 1
  s_mov_b32 s23, 7
  s_mov_b32 s45, 6
  s_call_b64 s[60:61], L_poll
L_free_7:
  s_add_u32 s21, s20, 2
  s_and_b32 s21, s21, 7
  s_lshl_b32 s21, s21, 19
  s_add_u32 s21, s21, s35
  s_mov_b32 m0, 32768
  s_nop 0
  buffer_load_dwordx4 v36, s[40:43], s21 offen offset:0 lds
  buffer_load_dwordx4 v37, s[40:43], s21 offen offset:1024 lds
  buffer_load_dwordx4 v38, s[40:43], s21 offen offset:2048 lds
  buffer_load_dwordx4 v39, s[40:43], s21 offen offset:3072 lds
  s_add_u32 s21, s21, 131072
  s_mov_b32 m0, 36864
  s_nop 0
  buffer_load_dwordx4 v36, s[40:43], s21 offen offset:0 lds
  buffer_load_dwordx4 v37, s[40:43], s21 offen offset:1024 lds
  buffer_load_dwordx4 v38, s[40:43], s21 offen offset:2048 lds
  buffer_load_dwordx4 v39, s[40:43], s21 offen offset:3072 lds
  s_add_u32 s21, s21, 131072
  s_mov_b32 m0, 40960
  s_nop 0
  buffer_load_dwordx4 v36, s[40:43], s21 offen offset:0 lds
  buffer_load_dwordx4 v37, s[40:43], s21 offen offset:1024 lds
  buffer_load_dwordx4 v38, s[40:43], s21 offen offset:2048 lds
  buffer_load_dwordx4 v39, s[40:43], s21 offen offset:3072 lds
  s_add_u32 s21, s21, 131072
  s_mov_b32 m0, 45056
  s_nop 0
  buffer_load_dwordx4 v36, s[40:43], s21 offen offset:0 lds
  buffer_load_dwordx4 v37, s[40:43], s21 offen offset:1024 lds
  buffer_load_dwordx4 v38, s[40:43], s21 offen offset:2048 lds
  buffer_load_dwordx4 v39, s[40:43], s21 offen offset:3072 lds
  s_waitcnt vmcnt(34)
  s_max_u32 s44, s44, 6
  v_mov_b32 v30, s44
  ds_write_b32 v40, v30 offset:20480
  s_cmp_ge_u32 s56, 2
  s_cbranch_scc1 L_free_8
  s_mov_b32 s54, 2
  s_mov_b32 s23, 8
  s_mov_b32 s45, 7
  s_call_b64 s[60:61], L_poll
L_free_8:
  s_add_u32 s21, s20, 2
  s_and_b32 s21, s21, 7
  s_lshl_b32 s21, s21, 19
  s_add_u32 s21, s21, s36
  s_mov_b32 m0, 98304
  s_nop 0
  buffer_load_dwordx4 v36, s[40:43], s21 offen offset:0 lds
  buffer_load_dwordx4 v37, s[40:43], s21 offen offset:1024 lds
  buffer_load_dwordx4 v38, s[40:43], s21 offen offset:2048 lds
  buffer_load_dwordx4 v39, s[40:43], s21 offen offset:3072 lds
  s_add_u32 s21, s21, 131072
  s_mov_b32 m0, 102400
  s_nop 0
  buffer_load_dwordx4 v36, s[40:43], s21 offen offset:0 lds
  buffer_load_dwordx4 v37, s[40:43], s21 offen offset:1024 lds
  buffer_load_dwordx4 v38, s[40:43], s21 offen offset:2048 lds
  buffer_load_dwordx4 v39, s[40:43], s21 offen offset:3072 lds
  s_add_u32 s21, s21, 131072
  s_mov_b32 m0, 106496
  s_nop 0
  buffer_load_dwordx4 v36, s[40:43], s21 offen offset:0 lds
  buffer_load_dwordx4 v37, s[40:43], s21 offen offset:1024 lds
  buffer_load_dwordx4 v38, s[40:43], s21 offen offset:2048 lds
  buffer_load_dwordx4 v39, s[40:43], s21 offen offset:3072 lds
  s_add_u32 s21, s21, 131072
  s_mov_b32 m0, 110592
  s_nop 0
  buffer_load_dwordx4 v36, s[40:43], s21 offen offset:0 lds
  buffer_load_dwordx4 v37, s[40:43], s21 offen offset:1024 lds
  buffer_load_dwordx4 v38, s[40:43], s21 offen offset:2048 lds
  buffer_load_dwordx4 v39, s[40:43], s21 offen offset:3072 lds
  s_waitcnt vmcnt(32)
  s_max_u32 s44, s44, 7
  v_mov_b32 v30, s44
  ds_write_b32 v40, v30 offset:20480
  s_mov_b32 m0, 0
  s_add_u32 s62, s33, 0
  buffer_load_dwordx4 v24, s[24:27], s62 offen offset:0 nt lds
  buffer_load_dwordx4 v24, s[24:27], s62 offen offset:1024 nt lds
  buffer_load_dwordx4 v25, s[24:27], s62 offen offset:2048 nt lds
  buffer_load_dwordx4 v25, s[24:27], s62 offen offset:3072 nt lds
  s_mov_b32 m0, 4096
  s_add_u32 s62, s33, 4096
  buffer_load_dwordx4 v26, s[24:27], s62 offen offset:0 nt lds
  buffer_load_dwordx4 v26, s[24:27], s62 offen offset:1024 nt lds
  buffer_load_dwordx4 v27, s[24:27], s62 offen offset:2048 nt lds
  buffer_load_dwordx4 v27, s[24:27], s62 offen offset:3072 nt lds
  s_mov_b32 m0, 8192
  s_add_u32 s62, s33, 8192
  buffer_load_dwordx4 v24, s[24:27], s62 offen offset:0 nt lds
  buffer_load_dwordx4 v24, s[24:27], s62 offen offset:1024 nt lds
  buffer_load_dwordx4 v25, s[24:27], s62 offen offset:2048 nt lds
  buffer_load_dwordx4 v25, s[24:27], s62 offen offset:3072 nt lds
  s_mov_b32 m0, 12288
  s_add_u32 s62, s33, 12288
  buffer_load_dwordx4 v26, s[24:27], s62 offen offset:0 nt lds
  buffer_load_dwordx4 v26, s[24:27], s62 offen offset:1024 nt lds
  buffer_load_dwordx4 v27, s[24:27], s62 offen offset:2048 nt lds
  buffer_load_dwordx4 v27, s[24:27], s62 offen offset:3072 nt lds
  s_waitcnt vmcnt(32)
  s_max_u32 s44, s44, 8
  v_mov_b32 v30, s44
  ds_write_b32 v40, v30 offset:20480
  s_cmp_ge_u32 s56, 3
  s_cbranch_scc1 L_free_10
  s_mov_b32 s54, 3
  s_mov_b32 s23, 10
  s_mov_b32 s45, 9
  s_call_b64 s[60:61], L_poll
L_free_10:
  s_add_u32 s22, s20, 3
  s_and_b32 s22, s22, 7
  s_lshl_b32 s22, s22, 7
  s_mov_b32 m0, 133120
  s_nop 0
  buffer_load_dwordx4 v20, s[16:19], s22 offen offset:0 lds
  buffer_load_dwordx4 v21, s[16:19], s22 offen offset:1024 lds
  buffer_load_dwordx4 v22, s[16:19], s22 offen offset:2048 lds
  buffer_load_dwordx4 v23, s[16:19], s22 offen offset:3072 lds
  s_add_u32 s22, s22, 32768
  s_mov_b32 m0, 137216
  s_nop 0
  buffer_load_dwordx4 v20, s[16:19], s22 offen offset:0 lds
  buffer_load_dwordx4 v21, s[16:19], s22 offen offset:1024 lds
  buffer_load_dwordx4 v22, s[16:19], s22 offen offset:2048 lds
  buffer_load_dwordx4 v23, s[16:19], s22 offen offset:3072 lds
  s_add_u32 s22, s22, 32768
  s_mov_b32 m0, 141312
  s_nop 0
  buffer_load_dwordx4 v20, s[16:19], s22 offen offset:0 lds
  buffer_load_dwordx4 v21, s[16:19], s22 offen offset:1024 lds
  buffer_load_dwordx4 v22, s[16:19], s22 offen offset:2048 lds
  buffer_load_dwordx4 v23, s[16:19], s22 offen offset:3072 lds
  s_add_u32 s22, s22, 32768
  s_mov_b32 m0, 145408
  s_nop 0
  buffer_load_dwordx4 v20, s[16:19], s22 offen offset:0 lds
  buffer_load_dwordx4 v21, s[16:19], s22 offen offset:1024 lds
  buffer_load_dwordx4 v22, s[16:19], s22 offen offset:2048 lds
  buffer_load_dwordx4 v23, s[16:19], s22 offen offset:3072 lds
  s_add_u32 s22, s22, 32768
  s_mov_b32 m0, 149504
  s_nop 0
  buffer_load_dwordx4 v20, s[16:19], s22 offen offset:0 lds
  buffer_load_dwordx4 v21, s[16:19], s22 offen offset:1024 lds
  s_waitcnt vmcnt(34)
  s_max_u32 s44, s44, 9
  v_mov_b32 v30, s44
  ds_write_b32 v40, v30 offset:20480
  s_cmp_ge_u32 s56, 3
  s_cbranch_scc1 L_free_11
  s_mov_b32 s54, 3
  s_mov_b32 s23, 11
  s_mov_b32 s45, 10
  s_call_b64 s[60:61], L_poll
L_free_11:
  s_add_u32 s21, s20, 3
  s_and_b32 s21, s21, 7
  s_lshl_b32 s21, s21, 19
  s_add_u32 s21, s21, s35
  s_mov_b32 m0, 49152
  s_nop 0
  buffer_load_dwordx4 v36, s[40:43], s21 offen offset:0 lds
  buffer_load_dwordx4 v37, s[40:43], s21 offen offset:1024 lds
  buffer_load_dwordx4 v38, s[40:43], s21 offen offset:2048 lds
  buffer_load_dwordx4 v39, s[40:43], s21 offen offset:3072 lds
  s_add_u32 s21, s21, 131072
  s_mov_b32 m0, 53248
  s_nop 0
  buffer_load_dwordx4 v36, s[40:43], s21 offen offset:0 lds
  buffer_load_dwordx4 v37, s[40:43], s21 offen offset:1024 lds
  buffer_load_dwordx4 v38, s[40:43], s21 offen offset:2048 lds
  buffer_load_dwordx4 v39, s[40:43], s21 offen offset:3072 lds
  s_add_u32 s21, s21, 131072
  s_mov_b32 m0, 57344
  s_nop 0
  buffer_load_dwordx4 v36, s[40:43], s21 offen offset:0 lds
  buffer_load_dwordx4 v37, s[40:43], s21 offen offset:1024 lds
  buffer_load_dwordx4 v38, s[40:43], s21 offen offset:2048 lds
  buffer_load_dwordx4 v39, s[40:43], s21 offen offset:3072 lds
  s_add_u32 s21, s21, 131072
  s_mov_b32 m0, 61440
  s_nop 0
  buffer_load_dwordx4 v36, s[40:43], s21 offen offset:0 lds
  buffer_load_dwordx4 v37, s[40:43], s21 offen offset:1024 lds
  buffer_load_dwordx4 v38, s[40:43], s21 offen offset:2048 lds
  buffer_load_dwordx4 v39, s[40:43], s21 offen offset:3072 lds
  s_waitcnt vmcnt(34)
  s_max_u32 s44, s44, 10
  v_mov_b32 v30, s44
  ds_write_b32 v40, v30 offset:20480
  s_cmp_ge_u32 s56, 4
  s_cbranch_scc1 L_free_12
  s_mov_b32 s54, 4
  s_mov_b32 s23, 12
  s_mov_b32 s45, 11
  s_call_b64 s[60:61], L_poll
L_free_12:
  s_add_u32 s21, s20, 3
  s_and_b32 s21, s21, 7
  s_lshl_b32 s21, s21, 19
  s_add_u32 s21, s21, s36
  s_mov_b32 m0, 65536
  s_nop 0
  buffer_load_dwordx4 v36, s[40:43], s21 offen offset:0 lds
  buffer_load_dwordx4 v37, s[40:43], s21 offen offset:1024 lds
  buffer_load_dwordx4 v38, s[40:43], s21 offen offset:2048 lds
  buffer_load_dwordx4 v39, s[40:43], s21 offen offset:3072 lds
  s_add_u32 s21, s21, 131072
  s_mov_b32 m0, 69632
  s_nop 0
  buffer_load_dwordx4 v36, s[40:43], s21 offen offset:0 lds
  buffer_load_dwordx4 v37, s[40:43], s21 offen offset:1024 lds
  buffer_load_dwordx4 v38, s[40:43], s21 offen offset:2048 lds
  buffer_load_dwordx4 v39, s[40:43], s21 offen offset:3072 lds
  s_add_u32 s21, s21, 131072
  s_mov_b32 m0, 73728
  s_nop 0
  buffer_load_dwordx4 v36, s[40:43], s21 offen offset:0 lds
  buffer_load_dwordx4 v37, s[40:43], s21 offen offset:1024 lds
  buffer_load_dwordx4 v38, s[40:43], s21 offen offset:2048 lds
  buffer_load_dwordx4 v39, s[40:43], s21 offen offset:3072 lds
  s_add_u32 s21, s21, 131072
  s_mov_b32 m0, 77824
  s_nop 0
  buffer_load_dwordx4 v36, s[40:43], s21 offen offset:0 lds
  buffer_load_dwordx4 v37, s[40:43], s21 offen offset:1024 lds
  buffer_load_dwordx4 v38, s[40:43], s21 offen offset:2048 lds
  buffer_load_dwordx4 v39, s[40:43], s21 offen offset:3072 lds
  s_waitcnt vmcnt(32)
  s_max_u32 s44, s44, 11
  v_mov_b32 v30, s44
  ds_write_b32 v40, v30 offset:20480
  s_cmp_ge_u32 s56, 5
  s_cbranch_scc1 L_free_13
  s_mov_b32 s54, 5
  s_mov_b32 s23, 13
  s_mov_b32 s45, 12
  s_call_b64 s[60:61], L_poll
L_free_13:
  s_add_u32 s22, s20, 4
  s_and_b32 s22, s22, 7
  s_lshl_b32 s22, s22, 7
  s_mov_b32 m0, 114688
  s_nop 0
  buffer_load_dwordx4 v20, s[16:19], s22 offen offset:0 lds
  buffer_load_dwordx4 v21, s[16:19], s22 offen offset:1024 lds
  buffer_load_dwordx4 v22, s[16:19], s22 offen offset:2048 lds
  buffer_load_dwordx4 v23, s[16:19], s22 offen offset:3072 lds
  s_add_u32 s22, s22, 32768
  s_mov_b32 m0, 118784
  s_nop 0
  buffer_load_dwordx4 v20, s[16:19], s22 offen offset:0 lds
  buffer_load_dwordx4 v21, s[16:19], s22 offen offset:1024 lds
  buffer_load_dwordx4 v22, s[16:19], s22 offen offset:2048 lds
  buffer_load_dwordx4 v23, s[16:19], s22 offen offset:3072 lds
  s_add_u32 s22, s22, 32768
  s_mov_b32 m0, 122880
  s_nop 0
  buffer_load_dwordx4 v20, s[16:19], s22 offen offset:0 lds
  buffer_load_dwordx4 v21, s[16:19], s22 offen offset:1024 lds
  buffer_load_dwordx4 v22, s[16:19], s22 offen offset:2048 lds
  buffer_load_dwordx4 v23, s[16:19], s22 offen offset:3072 lds
  s_add_u32 s22, s22, 32768
  s_mov_b32 m0, 126976
  s_nop 0
  buffer_load_dwordx4 v20, s[16:19], s22 offen offset:0 lds
  buffer_load_dwordx4 v21, s[16:19], s22 offen offset:1024 lds
  buffer_load_dwordx4 v22, s[16:19], s22 offen offset:2048 lds
  buffer_load_dwordx4 v23, s[16:19], s22 offen offset:3072 lds
  s_add_u32 s22, s22, 32768
  s_mov_b32 m0, 131072
  s_nop 0
  buffer_load_dwordx4 v20, s[16:19], s22 offen offset:0 lds
  buffer_load_dwordx4 v21, s[16:19], s22 offen offset:1024 lds
  s_waitcnt vmcnt(34)
  s_max_u32 s44, s44, 12
  v_mov_b32 v30, s44
  ds_write_b32 v40, v30 offset:20480
  s_cmp_ge_u32 s56, 5
  s_cbranch_scc1 L_free_14
  s_mov_b32 s54, 5
  s_mov_b32 s23, 14
  s_mov_b32 s45, 13
  s_call_b64 s[60:61], L_poll
L_free_14:
  s_add_u32 s21, s20, 4
  s_and_b32 s21, s21, 7
  s_lshl_b32 s21, s21, 19
  s_add_u32 s21, s21, s35
  s_mov_b32 m0, 32768
  s_nop 0
  buffer_load_dwordx4 v36, s[40:43], s21 offen offset:0 lds
  buffer_load_dwordx4 v37, s[40:43], s21 offen offset:1024 lds
  buffer_load_dwordx4 v38, s[40:43], s21 offen offset:2048 lds
  buffer_load_dwordx4 v39, s[40:43], s21 offen offset:3072 lds
  s_add_u32 s21, s21, 131072
  s_mov_b32 m0, 36864
  s_nop 0
  buffer_load_dwordx4 v36, s[40:43], s21 offen offset:0 lds
  buffer_load_dwordx4 v37, s[40:43], s21 offen offset:1024 lds
  buffer_load_dwordx4 v38, s[40:43], s21 offen offset:2048 lds
  buffer_load_dwordx4 v39, s[40:43], s21 offen offset:3072 lds
  s_add_u32 s21, s21, 131072
  s_mov_b32 m0, 40960
  s_nop 0
  buffer_load_dwordx4 v36, s[40:43], s21 offen offset:0 lds
  buffer_load_dwordx4 v37, s[40:43], s21 offen offset:1024 lds
  buffer_load_dwordx4 v38, s[40:43], s21 offen offset:2048 lds
  buffer_load_dwordx4 v39, s[40:43], s21 offen offset:3072 lds
  s_add_u32 s21, s21, 131072
  s_mov_b32 m0, 45056
  s_nop 0
  buffer_load_dwordx4 v36, s[40:43], s21 offen offset:0 lds
  buffer_load_dwordx4 v37, s[40:43], s21 offen offset:1024 lds
  buffer_load_dwordx4 v38, s[40:43], s21 offen offset:2048 lds
  buffer_load_dwordx4 v39, s[40:43], s21 offen offset:3072 lds
  s_waitcnt vmcnt(34)
  s_max_u32 s44, s44, 13
  v_mov_b32 v30, s44
  ds_write_b32 v40, v30 offset:20480
  s_mov_b32 m0, 16384
  s_add_u32 s62, s33, 16384
  buffer_load_dwordx4 v24, s[24:27], s62 offen offset:0 nt lds
  buffer_load_dwordx4 v24, s[24:27], s62 offen offset:1024 nt lds
  buffer_load_dwordx4 v25, s[24:27], s62 offen offset:2048 nt lds
  buffer_load_dwordx4 v25, s[24:27], s62 offen offset:3072 nt lds
  s_mov_b32 m0, 20480
  s_add_u32 s62, s33, 20480
  buffer_load_dwordx4 v26, s[24:27], s62 offen offset:0 nt lds
  buffer_load_dwordx4 v26, s[24:27], s62 offen offset:1024 nt lds
  buffer_load_dwordx4 v27, s[24:27], s62 offen offset:2048 nt lds
  buffer_load_dwordx4 v27, s[24:27], s62 offen offset:3072 nt lds
  s_mov_b32 m0, 24576
  s_add_u32 s62, s33, 24576
  buffer_load_dwordx4 v24, s[24:27], s62 offen offset:0 nt lds
  buffer_load_dwordx4 v24, s[24:27], s62 offen offset:1024 nt lds
  buffer_load_dwordx4 v25, s[24:27], s62 offen offset:2048 nt lds
  buffer_load_dwordx4 v25, s[24:27], s62 offen offset:3072 nt lds
  s_mov_b32 m0, 28672
  s_add_u32 s62, s33, 28672
  buffer_load_dwordx4 v26, s[24:27], s62 offen offset:0 nt lds
  buffer_load_dwordx4 v26, s[24:27], s62 offen offset:1024 nt lds
  buffer_load_dwordx4 v27, s[24:27], s62 offen offset:2048 nt lds
  buffer_load_dwordx4 v27, s[24:27], s62 offen offset:3072 nt lds
  s_waitcnt vmcnt(32)
  s_max_u32 s44, s44, 14
  v_mov_b32 v30, s44
  ds_write_b32 v40, v30 offset:20480
  s_cmp_ge_u32 s56, 6
  s_cbranch_scc1 L_free_16
  s_mov_b32 s54, 6
  s_mov_b32 s23, 16
  s_mov_b32 s45, 15
  s_call_b64 s[60:61], L_poll
L_free_16:
  s_add_u32 s21, s20, 4
  s_and_b32 s21, s21, 7
  s_lshl_b32 s21, s21, 19
  s_add_u32 s21, s21, s36
  s_mov_b32 m0, 98304
  s_nop 0
  buffer_load_dwordx4 v36, s[40:43], s21 offen offset:0 lds
  buffer_load_dwordx4 v37, s[40:43], s21 offen offset:1024 lds
  buffer_load_dwordx4 v38, s[40:43], s21 offen offset:2048 lds
  buffer_load_dwordx4 v39, s[40:43], s21 offen offset:3072 lds
  s_add_u32 s21, s21, 131072
  s_mov_b32 m0, 102400
  s_nop 0
  buffer_load_dwordx4 v36, s[40:43], s21 offen offset:0 lds
  buffer_load_dwordx4 v37, s[40:43], s21 offen offset:1024 lds
  buffer_load_dwordx4 v38, s[40:43], s21 offen offset:2048 lds
  buffer_load_dwordx4 v39, s[40:43], s21 offen offset:3072 lds
  s_add_u32 s21, s21, 131072
  s_mov_b32 m0, 106496
  s_nop 0
  buffer_load_dwordx4 v36, s[40:43], s21 offen offset:0 lds
  buffer_load_dwordx4 v37, s[40:43], s21 offen offset:1024 lds
  buffer_load_dwordx4 v38, s[40:43], s21 offen offset:2048 lds
  buffer_load_dwordx4 v39, s[40:43], s21 offen offset:3072 lds
  s_add_u32 s21, s21, 131072
  s_mov_b32 m0, 110592
  s_nop 0
  buffer_load_dwordx4 v36, s[40:43], s21 offen offset:0 lds
  buffer_load_dwordx4 v37, s[40:43], s21 offen offset:1024 lds
  buffer_load_dwordx4 v38, s[40:43], s21 offen offset:2048 lds
  buffer_load_dwordx4 v39, s[40:43], s21 offen offset:3072 lds
  s_waitcnt vmcnt(32)
  s_max_u32 s44, s44, 15
  v_mov_b32 v30, s44
  ds_write_b32 v40, v30 offset:20480
  s_cmp_ge_u32 s56, 7
  s_cbranch_scc1 L_free_17
  s_mov_b32 s54, 7
  s_mov_b32 s23, 17
  s_mov_b32 s45, 16
  s_call_b64 s[60:61], L_poll
L_free_17:
  s_add_u32 s22, s20, 5
  s_and_b32 s22, s22, 7
  s_lshl_b32 s22, s22, 7
  s_mov_b32 m0, 133120
  s_nop 0
  buffer_load_dwordx4 v20, s[16:19], s22 offen offset:0 lds
  buffer_load_dwordx4 v21, s[16:19], s22 offen offset:1024 lds
  buffer_load_dwordx4 v22, s[16:19], s22 offen offset:2048 lds
  buffer_load_dwordx4 v23, s[16:19], s22 offen offset:3072 lds
  s_add_u32 s22, s22, 32768
  s_mov_b32 m0, 137216
  s_nop 0
  buffer_load_dwordx4 v20, s[16:19], s22 offen offset:0 lds
  buffer_load_dwordx4 v21, s[16:19], s22 offen offset:1024 lds
  buffer_load_dwordx4 v22, s[16:19], s22 offen offset:2048 lds
  buffer_load_dwordx4 v23, s[16:19], s22 offen offset:3072 lds
  s_add_u32 s22, s22, 32768
  s_mov_b32 m0, 141312
  s_nop 0
  buffer_load_dwordx4 v20, s[16:19], s22 offen offset:0 lds
  buffer_load_dwordx4 v21, s[16:19], s22 offen offset:1024 lds
  buffer_load_dwordx4 v22, s[16:19], s22 offen offset:2048 lds
  buffer_load_dwordx4 v23, s[16:19], s22 offen offset:3072 lds
  s_add_u32 s22, s22, 32768
  s_mov_b32 m0, 145408
  s_nop 0
  buffer_load_dwordx4 v20, s[16:19], s22 offen offset:0 lds
  buffer_load_dwordx4 v21, s[16:19], s22 offen offset:1024 lds
  buffer_load_dwordx4 v22, s[16:19], s22 offen offset:2048 lds
  buffer_load_dwordx4 v23, s[16:19], s22 offen offset:3072 lds
  s_add_u32 s22, s22, 32768
  s_mov_b32 m0, 149504
  s_nop 0
  buffer_load_dwordx4 v20, s[16:19], s22 offen offset:0 lds
  buffer_load_dwordx4 v21, s[16:19], s22 offen offset:1024 lds
  s_waitcnt vmcnt(34)
  s_max_u32 s44, s44, 16
  v_mov_b32 v30, s44
  ds_write_b32 v40, v30 offset:20480
  s_cmp_ge_u32 s56, 7
  s_cbranch_scc1 L_free_18
  s_mov_b32 s54, 7
  s_mov_b32 s23, 18
  s_mov_b32 s45, 17
  s_call_b64 s[60:61], L_poll
L_free_18:
  s_add_u32 s21, s20, 5
  s_and_b32 s21, s21, 7
  s_lshl_b32 s21, s21, 19
  s_add_u32 s21, s21, s35
  s_mov_b32 m0, 49152
  s_nop 0
  buffer_load_dwordx4 v36, s[40:43], s21 offen offset:0 lds
  buffer_load_dwordx4 v37, s[40:43], s21 offen offset:1024 lds
  buffer_load_dwordx4 v38, s[40:43], s21 offen offset:2048 lds
  buffer_load_dwordx4 v39, s[40:43], s21 offen offset:3072 lds
  s_add_u32 s21, s21, 131072
  s_mov_b32 m0, 53248
  s_nop 0
  buffer_load_dwordx4 v36, s[40:43], s21 offen offset:0 lds
  buffer_load_dwordx4 v37, s[40:43], s21 offen offset:1024 lds
  buffer_load_dwordx4 v38, s[40:43], s21 offen offset:2048 lds
  buffer_load_dwordx4 v39, s[40:43], s21 offen offset:3072 lds
  s_add_u32 s21, s21, 131072
  s_mov_b32 m0, 57344
  s_nop 0
  buffer_load_dwordx4 v36, s[40:43], s21 offen offset:0 lds
  buffer_load_dwordx4 v37, s[40:43], s21 offen offset:1024 lds
  buffer_load_dwordx4 v38, s[40:43], s21 offen offset:2048 lds
  buffer_load_dwordx4 v39, s[40:43], s21 offen offset:3072 lds
  s_add_u32 s21, s21, 131072
  s_mov_b32 m0, 61440
  s_nop 0
  buffer_load_dwordx4 v36, s[40:43], s21 offen offset:0 lds
  buffer_load_dwordx4 v37, s[40:43], s21 offen offset:1024 lds
  buffer_load_dwordx4 v38, s[40:43], s21 offen offset:2048 lds
  buffer_load_dwordx4 v39, s[40:43], s21 offen offset:3072 lds
  s_waitcnt vmcnt(34)
  s_max_u32 s44, s44, 17
  v_mov_b32 v30, s44
  ds_write_b32 v40, v30 offset:20480
  s_cmp_ge_u32 s56, 8
  s_cbranch_scc1 L_free_19
  s_mov_b32 s54, 8
  s_mov_b32 s23, 19
  s_mov_b32 s45, 18
  s_call_b64 s[60:61], L_poll
L_free_19:
  s_add_u32 s21, s20, 5
  s_and_b32 s21, s21, 7
  s_lshl_b32 s21, s21, 19
  s_add_u32 s21, s21, s36
  s_mov_b32 m0, 65536
  s_nop 0
  buffer_load_dwordx4 v36, s[40:43], s21 offen offset:0 lds
  buffer_load_dwordx4 v37, s[40:43], s21 offen offset:1024 lds
  buffer_load_dwordx4 v38, s[40:43], s21 offen offset:2048 lds
  buffer_load_dwordx4 v39, s[40:43], s21 offen offset:3072 lds
  s_add_u32 s21, s21, 131072
  s_mov_b32 m0, 69632
  s_nop 0
  buffer_load_dwordx4 v36, s[40:43], s21 offen offset:0 lds
  buffer_load_dwordx4 v37, s[40:43], s21 offen offset:1024 lds
  buffer_load_dwordx4 v38, s[40:43], s21 offen offset:2048 lds
  buffer_load_dwordx4 v39, s[40:43], s21 offen offset:3072 lds
  s_add_u32 s21, s21, 131072
  s_mov_b32 m0, 73728
  s_nop 0
  buffer_load_dwordx4 v36, s[40:43], s21 offen offset:0 lds
  buffer_load_dwordx4 v37, s[40:43], s21 offen offset:1024 lds
  buffer_load_dwordx4 v38, s[40:43], s21 offen offset:2048 lds
  buffer_load_dwordx4 v39, s[40:43], s21 offen offset:3072 lds
  s_add_u32 s21, s21, 131072
  s_mov_b32 m0, 77824
  s_nop 0
  buffer_load_dwordx4 v36, s[40:43], s21 offen offset:0 lds
  buffer_load_dwordx4 v37, s[40:43], s21 offen offset:1024 lds
  buffer_load_dwordx4 v38, s[40:43], s21 offen offset:2048 lds
  buffer_load_dwordx4 v39, s[40:43], s21 offen offset:3072 lds
  s_waitcnt vmcnt(32)
  s_max_u32 s44, s44, 18
  v_mov_b32 v30, s44
  ds_write_b32 v40, v30 offset:20480
  s_mov_b32 m0, 81920
  s_add_u32 s62, s33, 0
  buffer_load_dwordx4 v28, s[28:31], s62 offen offset:0 nt lds
  buffer_load_dwordx4 v28, s[28:31], s62 offen offset:1024 nt lds
  buffer_load_dwordx4 v29, s[28:31], s62 offen offset:2048 nt lds
  buffer_load_dwordx4 v29, s[28:31], s62 offen offset:3072 nt lds
  s_mov_b32 m0, 86016
  s_add_u32 s62, s33, 4096
  buffer_load_dwordx4 v28, s[28:31], s62 offen offset:0 nt lds
  buffer_load_dwordx4 v28, s[28:31], s62 offen offset:1024 nt lds
  buffer_load_dwordx4 v29, s[28:31], s62 offen offset:2048 nt lds
  buffer_load_dwordx4 v29, s[28:31], s62 offen offset:3072 nt lds
  s_mov_b32 m0, 90112
  s_add_u32 s62, s33, 8192
  buffer_load_dwordx4 v28, s[28:31], s62 offen offset:0 nt lds
  buffer_load_dwordx4 v28, s[28:31], s62 offen offset:1024 nt lds
  buffer_load_dwordx4 v29, s[28:31], s62 offen offset:2048 nt lds
  buffer_load_dwordx4 v29, s[28:31], s62 offen offset:3072 nt lds
  s_mov_b32 m0, 94208
  s_add_u32 s62, s33, 12288
  buffer_load_dwordx4 v28, s[28:31], s62 offen offset:0 nt lds
  buffer_load_dwordx4 v28, s[28:31], s62 offen offset:1024 nt lds
  buffer_load_dwordx4 v29, s[28:31], s62 offen offset:2048 nt lds
  buffer_load_dwordx4 v29, s[28:31], s62 offen offset:3072 nt lds
  s_waitcnt vmcnt(32)
  s_max_u32 s44, s44, 19
  v_mov_b32 v30, s44
  ds_write_b32 v40, v30 offset:20480
  s_cmp_ge_u32 s56, 9
  s_cbranch_scc1 L_free_21
  s_mov_b32 s54, 9
  s_mov_b32 s23, 21
  s_mov_b32 s45, 20
  s_call_b64 s[60:61], L_poll
L_free_21:
  s_add_u32 s22, s20, 6
  s_and_b32 s22, s22, 7
  s_lshl_b32 s22, s22, 7
  s_mov_b32 m0, 114688
  s_nop 0
  buffer_load_dwordx4 v20, s[16:19], s22 offen offset:0 lds
  buffer_load_dwordx4 v21, s[16:19], s22 offen offset:1024 lds
  buffer_load_dwordx4 v22, s[16:19], s22 offen offset:2048 lds
  buffer_load_dwordx4 v23, s[16:19], s22 offen offset:3072 lds
  s_add_u32 s22, s22, 32768
  s_mov_b32 m0, 118784
  s_nop 0
  buffer_load_dwordx4 v20, s[16:19], s22 offen offset:0 lds
  buffer_load_dwordx4 v21, s[16:19], s22 offen offset:1024 lds
  buffer_load_dwordx4 v22, s[16:19], s22 offen offset:2048 lds
  buffer_load_dwordx4 v23, s[16:19], s22 offen offset:3072 lds
  s_add_u32 s22, s22, 32768
  s_mov_b32 m0, 122880
  s_nop 0
  buffer_load_dwordx4 v20, s[16:19], s22 offen offset:0 lds
  buffer_load_dwordx4 v21, s[16:19], s22 offen offset:1024 lds
  buffer_load_dwordx4 v22, s[16:19], s22 offen offset:2048 lds
  buffer_load_dwordx4 v23, s[16:19], s22 offen offset:3072 lds
  s_add_u32 s22, s22, 32768
  s_mov_b32 m0, 126976
  s_nop 0
  buffer_load_dwordx4 v20, s[16:19], s22 offen offset:0 lds
  buffer_load_dwordx4 v21, s[16:19], s22 offen offset:1024 lds
  buffer_load_dwordx4 v22, s[16:19], s22 offen offset:2048 lds
  buffer_load_dwordx4 v23, s[16:19], s22 offen offset:3072 lds
  s_add_u32 s22, s22, 32768
  s_mov_b32 m0, 131072
  s_nop 0
  buffer_load_dwordx4 v20, s[16:19], s22 offen offset:0 lds
  buffer_load_dwordx4 v21, s[16:19], s22 offen offset:1024 lds
  s_waitcnt vmcnt(34)
  s_max_u32 s44, s44, 20
  v_mov_b32 v30, s44
  ds_write_b32 v40, v30 offset:20480
  s_cmp_ge_u32 s56, 9
  s_cbranch_scc1 L_free_22
  s_mov_b32 s54, 9
  s_mov_b32 s23, 22
  s_mov_b32 s45, 21
  s_call_b64 s[60:61], L_poll
L_free_22:
  s_add_u32 s21, s20, 6
  s_and_b32 s21, s21, 7
  s_lshl_b32 s21, s21, 19
  s_add_u32 s21, s21, s35
  s_mov_b32 m0, 32768
  s_nop 0
  buffer_load_dwordx4 v36, s[40:43], s21 offen offset:0 lds
  buffer_load_dwordx4 v37, s[40:43], s21 offen offset:1024 lds
  buffer_load_dwordx4 v38, s[40:43], s21 offen offset:2048 lds
  buffer_load_dwordx4 v39, s[40:43], s21 offen offset:3072 lds
  s_add_u32 s21, s21, 131072
  s_mov_b32 m0, 36864
  s_nop 0
  buffer_load_dwordx4 v36, s[40:43], s21 offen offset:0 lds
  buffer_load_dwordx4 v37, s[40:43], s21 offen offset:1024 lds
  buffer_load_dwordx4 v38, s[40:43], s21 offen offset:2048 lds
  buffer_load_dwordx4 v39, s[40:43], s21 offen offset:3072 lds
  s_add_u32 s21, s21, 131072
  s_mov_b32 m0, 40960
  s_nop 0
  buffer_load_dwordx4 v36, s[40:43], s21 offen offset:0 lds
  buffer_load_dwordx4 v37, s[40:43], s21 offen offset:1024 lds
  buffer_load_dwordx4 v38, s[40:43], s21 offen offset:2048 lds
  buffer_load_dwordx4 v39, s[40:43], s21 offen offset:3072 lds
  s_add_u32 s21, s21, 131072
  s_mov_b32 m0, 45056
  s_nop 0
  buffer_load_dwordx4 v36, s[40:43], s21 offen offset:0 lds
  buffer_load_dwordx4 v37, s[40:43], s21 offen offset:1024 lds
  buffer_load_dwordx4 v38, s[40:43], s21 offen offset:2048 lds
  buffer_load_dwordx4 v39, s[40:43], s21 offen offset:3072 lds
  s_waitcnt vmcnt(34)
  s_max_u32 s44, s44, 21
  v_mov_b32 v30, s44
  ds_write_b32 v40, v30 offset:20480
  s_cmp_ge_u32 s56, 10
  s_cbranch_scc1 L_free_23
  s_mov_b32 s54, 10
  s_mov_b32 s23, 23
  s_mov_b32 s45, 22
  s_call_b64 s[60:61], L_poll
L_free_23:
  s_add_u32 s21, s20, 6
  s_and_b32 s21, s21, 7
  s_lshl_b32 s21, s21, 19
  s_add_u32 s21, s21, s36
  s_mov_b32 m0, 98304
  s_nop 0
  buffer_load_dwordx4 v36, s[40:43], s21 offen offset:0 lds
  buffer_load_dwordx4 v37, s[40:43], s21 offen offset:1024 lds
  buffer_load_dwordx4 v38, s[40:43], s21 offen offset:2048 lds
  buffer_load_dwordx4 v39, s[40:43], s21 offen offset:3072 lds
  s_add_u32 s21, s21, 131072
  s_mov_b32 m0, 102400
  s_nop 0
  buffer_load_dwordx4 v36, s[40:43], s21 offen offset:0 lds
  buffer_load_dwordx4 v37, s[40:43], s21 offen offset:1024 lds
  buffer_load_dwordx4 v38, s[40:43], s21 offen offset:2048 lds
  buffer_load_dwordx4 v39, s[40:43], s21 offen offset:3072 lds
  s_add_u32 s21, s21, 131072
  s_mov_b32 m0, 106496
  s_nop 0
  buffer_load_dwordx4 v36, s[40:43], s21 offen offset:0 lds
  buffer_load_dwordx4 v37, s[40:43], s21 offen offset:1024 lds
  buffer_load_dwordx4 v38, s[40:43], s21 offen offset:2048 lds
  buffer_load_dwordx4 v39, s[40:43], s21 offen offset:3072 lds
  s_add_u32 s21, s21, 131072
  s_mov_b32 m0, 110592
  s_nop 0
  buffer_load_dwordx4 v36, s[40:43], s21 offen offset:0 lds
  buffer_load_dwordx4 v37, s[40:43], s21 offen offset:1024 lds
  buffer_load_dwordx4 v38, s[40:43], s21 offen offset:2048 lds
  buffer_load_dwordx4 v39, s[40:43], s21 offen offset:3072 lds
  s_waitcnt vmcnt(32)
  s_max_u32 s44, s44, 22
  v_mov_b32 v30, s44
  ds_write_b32 v40, v30 offset:20480
  s_cmp_ge_u32 s56, 11
  s_cbranch_scc1 L_free_24
  s_mov_b32 s54, 11
  s_mov_b32 s23, 24
  s_mov_b32 s45, 23
  s_call_b64 s[60:61], L_poll
L_free_24:
  s_add_u32 s22, s20, 7
  s_and_b32 s22, s22, 7
  s_lshl_b32 s22, s22, 7
  s_mov_b32 m0, 133120
  s_nop 0
  buffer_load_dwordx4 v20, s[16:19], s22 offen offset:0 lds
  buffer_load_dwordx4 v21, s[16:19], s22 offen offset:1024 lds
  buffer_load_dwordx4 v22, s[16:19], s22 offen offset:2048 lds
  buffer_load_dwordx4 v23, s[16:19], s22 offen offset:3072 lds
  s_add_u32 s22, s22, 32768
  s_mov_b32 m0, 137216
  s_nop 0
  buffer_load_dwordx4 v20, s[16:19], s22 offen offset:0 lds
  buffer_load_dwordx4 v21, s[16:19], s22 offen offset:1024 lds
  buffer_load_dwordx4 v22, s[16:19], s22 offen offset:2048 lds
  buffer_load_dwordx4 v23, s[16:19], s22 offen offset:3072 lds
  s_add_u32 s22, s22, 32768
  s_mov_b32 m0, 141312
  s_nop 0
  buffer_load_dwordx4 v20, s[16:19], s22 offen offset:0 lds
  buffer_load_dwordx4 v21, s[16:19], s22 offen offset:1024 lds
  buffer_load_dwordx4 v22, s[16:19], s22 offen offset:2048 lds
  buffer_load_dwordx4 v23, s[16:19], s22 offen offset:3072 lds
  s_add_u32 s22, s22, 32768
  s_mov_b32 m0, 145408
  s_nop 0
  buffer_load_dwordx4 v20, s[16:19], s22 offen offset:0 lds
  buffer_load_dwordx4 v21, s[16:19], s22 offen offset:1024 lds
  buffer_load_dwordx4 v22, s[16:19], s22 offen offset:2048 lds
  buffer_load_dwordx4 v23, s[16:19], s22 offen offset:3072 lds
  s_add_u32 s22, s22, 32768
  s_mov_b32 m0, 149504
  s_nop 0
  buffer_load_dwordx4 v20, s[16:19], s22 offen offset:0 lds
  buffer_load_dwordx4 v21, s[16:19], s22 offen offset:1024 lds
  s_waitcnt vmcnt(34)
  s_max_u32 s44, s44, 23
  v_mov_b32 v30, s44
  ds_write_b32 v40, v30 offset:20480
  s_cmp_ge_u32 s56, 11
  s_cbranch_scc1 L_free_25
  s_mov_b32 s54, 11
  s_mov_b32 s23, 25
  s_mov_b32 s45, 24
  s_call_b64 s[60:61], L_poll
L_free_25:
  s_add_u32 s21, s20, 7
  s_and_b32 s21, s21, 7
  s_lshl_b32 s21, s21, 19
  s_add_u32 s21, s21, s35
  s_mov_b32 m0, 49152
  s_nop 0
  buffer_load_dwordx4 v36, s[40:43], s21 offen offset:0 lds
  buffer_load_dwordx4 v37, s[40:43], s21 offen offset:1024 lds
  buffer_load_dwordx4 v38, s[40:43], s21 offen offset:2048 lds
  buffer_load_dwordx4 v39, s[40:43], s21 offen offset:3072 lds
  s_add_u32 s21, s21, 131072
  s_mov_b32 m0, 53248
  s_nop 0
  buffer_load_dwordx4 v36, s[40:43], s21 offen offset:0 lds
  buffer_load_dwordx4 v37, s[40:43], s21 offen offset:1024 lds
  buffer_load_dwordx4 v38, s[40:43], s21 offen offset:2048 lds
  buffer_load_dwordx4 v39, s[40:43], s21 offen offset:3072 lds
  s_add_u32 s21, s21, 131072
  s_mov_b32 m0, 57344
  s_nop 0
  buffer_load_dwordx4 v36, s[40:43], s21 offen offset:0 lds
  buffer_load_dwordx4 v37, s[40:43], s21 offen offset:1024 lds
  buffer_load_dwordx4 v38, s[40:43], s21 offen offset:2048 lds
  buffer_load_dwordx4 v39, s[40:43], s21 offen offset:3072 lds
  s_add_u32 s21, s21, 131072
  s_mov_b32 m0, 61440
  s_nop 0
  buffer_load_dwordx4 v36, s[40:43], s21 offen offset:0 lds
  buffer_load_dwordx4 v37, s[40:43], s21 offen offset:1024 lds
  buffer_load_dwordx4 v38, s[40:43], s21 offen offset:2048 lds
  buffer_load_dwordx4 v39, s[40:43], s21 offen offset:3072 lds
  s_waitcnt vmcnt(34)
  s_max_u32 s44, s44, 24
  v_mov_b32 v30, s44
  ds_write_b32 v40, v30 offset:20480
  s_cmp_ge_u32 s56, 12
  s_cbranch_scc1 L_free_26
  s_mov_b32 s54, 12
  s_mov_b32 s23, 26
  s_mov_b32 s45, 25
  s_call_b64 s[60:61], L_poll
L_free_26:
  s_add_u32 s21, s20, 7
  s_and_b32 s21, s21, 7
  s_lshl_b32 s21, s21, 19
  s_add_u32 s21, s21, s36
  s_mov_b32 m0, 65536
  s_nop 0
  buffer_load_dwordx4 v36, s[40:43], s21 offen offset:0 lds
  buffer_load_dwordx4 v37, s[40:43], s21 offen offset:1024 lds
  buffer_load_dwordx4 v38, s[40:43], s21 offen offset:2048 lds
  buffer_load_dwordx4 v39, s[40:43], s21 offen offset:3072 lds
  s_add_u32 s21, s21, 131072
  s_mov_b32 m0, 69632
  s_nop 0
  buffer_load_dwordx4 v36, s[40:43], s21 offen offset:0 lds
  buffer_load_dwordx4 v37, s[40:43], s21 offen offset:1024 lds
  buffer_load_dwordx4 v38, s[40:43], s21 offen offset:2048 lds
  buffer_load_dwordx4 v39, s[40:43], s21 offen offset:3072 lds
  s_add_u32 s21, s21, 131072
  s_mov_b32 m0, 73728
  s_nop 0
  buffer_load_dwordx4 v36, s[40:43], s21 offen offset:0 lds
  buffer_load_dwordx4 v37, s[40:43], s21 offen offset:1024 lds
  buffer_load_dwordx4 v38, s[40:43], s21 offen offset:2048 lds
  buffer_load_dwordx4 v39, s[40:43], s21 offen offset:3072 lds
  s_add_u32 s21, s21, 131072
  s_mov_b32 m0, 77824
  s_nop 0
  buffer_load_dwordx4 v36, s[40:43], s21 offen offset:0 lds
  buffer_load_dwordx4 v37, s[40:43], s21 offen offset:1024 lds
  buffer_load_dwordx4 v38, s[40:43], s21 offen offset:2048 lds
  buffer_load_dwordx4 v39, s[40:43], s21 offen offset:3072 lds
  s_waitcnt vmcnt(32)
  s_max_u32 s44, s44, 25
  v_mov_b32 v30, s44
  ds_write_b32 v40, v30 offset:20480
  s_cmp_ge_u32 s56, 13
  s_cbranch_scc1 L_free_27
  s_mov_b32 s54, 13
  s_mov_b32 s23, 27
  s_mov_b32 s45, 26
  s_call_b64 s[60:61], L_poll
L_free_27:
  s_mov_b32 m0, 32768
  s_add_u32 s62, s33, 32768
  buffer_load_dwordx4 v24, s[24:27], s62 offen offset:0 nt lds
  buffer_load_dwordx4 v24, s[24:27], s62 offen offset:1024 nt lds
  buffer_load_dwordx4 v25, s[24:27], s62 offen offset:2048 nt lds
  buffer_load_dwordx4 v25, s[24:27], s62 offen offset:3072 nt lds
  s_mov_b32 m0, 36864
  s_add_u32 s62, s33, 36864
  buffer_load_dwordx4 v26, s[24:27], s62 offen offset:0 nt lds
  buffer_load_dwordx4 v26, s[24:27], s62 offen offset:1024 nt lds
  buffer_load_dwordx4 v27, s[24:27], s62 offen offset:2048 nt lds
  buffer_load_dwordx4 v27, s[24:27], s62 offen offset:3072 nt lds
  s_mov_b32 m0, 40960
  s_add_u32 s62, s33, 40960
  buffer_load_dwordx4 v24, s[24:27], s62 offen offset:0 nt lds
  buffer_load_dwordx4 v24, s[24:27], s62 offen offset:1024 nt lds
  buffer_load_dwordx4 v25, s[24:27], s62 offen offset:2048 nt lds
  buffer_load_dwordx4 v25, s[24:27], s62 offen offset:3072 nt lds
  s_mov_b32 m0, 45056
  s_add_u32 s62, s33, 45056
  buffer_load_dwordx4 v26, s[24:27], s62 offen offset:0 nt lds
  buffer_load_dwordx4 v26, s[24:27], s62 offen offset:1024 nt lds
  buffer_load_dwordx4 v27, s[24:27], s62 offen offset:2048 nt lds
  buffer_load_dwordx4 v27, s[24:27], s62 offen offset:3072 nt lds
  s_waitcnt vmcnt(16)
  s_max_u32 s44, s44, 27
  v_mov_b32 v30, s44
  ds_write_b32 v40, v30 offset:20480
  s_cmp_ge_u32 s56, 14
  s_cbranch_scc1 L_free_28
  s_mov_b32 s54, 14
  s_mov_b32 s23, 28
  s_mov_b32 s45, 27
  s_call_b64 s[60:61], L_poll
L_free_28:
  s_mov_b32 m0, 98304
  s_add_u32 s62, s33, 16384
  buffer_load_dwordx4 v28, s[28:31], s62 offen offset:0 nt lds
  buffer_load_dwordx4 v28, s[28:31], s62 offen offset:1024 nt lds
  buffer_load_dwordx4 v29, s[28:31], s62 offen offset:2048 nt lds
  buffer_load_dwordx4 v29, s[28:31], s62 offen offset:3072 nt lds
  s_mov_b32 m0, 102400
  s_add_u32 s62, s33, 20480
  buffer_load_dwordx4 v28, s[28:31], s62 offen offset:0 nt lds
  buffer_load_dwordx4 v28, s[28:31], s62 offen offset:1024 nt lds
  buffer_load_dwordx4 v29, s[28:31], s62 offen offset:2048 nt lds
  buffer_load_dwordx4 v29, s[28:31], s62 offen offset:3072 nt lds
  s_mov_b32 m0, 106496
  s_add_u32 s62, s33, 24576
  buffer_load_dwordx4 v28, s[28:31], s62 offen offset:0 nt lds
  buffer_load_dwordx4 v28, s[28:31], s62 offen offset:1024 nt lds
  buffer_load_dwordx4 v29, s[28:31], s62 offen offset:2048 nt lds
  buffer_load_dwordx4 v29, s[28:31], s62 offen offset:3072 nt lds
  s_mov_b32 m0, 110592
  s_add_u32 s62, s33, 28672
  buffer_load_dwordx4 v28, s[28:31], s62 offen offset:0 nt lds
  buffer_load_dwordx4 v28, s[28:31], s62 offen offset:1024 nt lds
  buffer_load_dwordx4 v29, s[28:31], s62 offen offset:2048 nt lds
  buffer_load_dwordx4 v29, s[28:31], s62 offen offset:3072 nt lds
  s_waitcnt vmcnt(16)
  s_max_u32 s44, s44, 28
  v_mov_b32 v30, s44
  ds_write_b32 v40, v30 offset:20480
  s_cmp_ge_u32 s56, 13
  s_cbranch_scc1 L_free_29
  s_mov_b32 s54, 13
  s_mov_b32 s23, 29
  s_mov_b32 s45, 28
  s_call_b64 s[60:61], L_poll
L_free_29:
  s_mov_b32 m0, 114688
  s_add_u32 s62, s33, 32768
  buffer_load_dwordx4 v28, s[28:31], s62 offen offset:0 nt lds
  buffer_load_dwordx4 v28, s[28:31], s62 offen offset:1024 nt lds
  buffer_load_dwordx4 v29, s[28:31], s62 offen offset:2048 nt lds
  buffer_load_dwordx4 v29, s[28:31], s62 offen offset:3072 nt lds
  s_mov_b32 m0, 118784
  s_add_u32 s62, s33, 36864
  buffer_load_dwordx4 v28, s[28:31], s62 offen offset:0 nt lds
  buffer_load_dwordx4 v28, s[28:31], s62 offen offset:1024 nt lds
  buffer_load_dwordx4 v29, s[28:31], s62 offen offset:2048 nt lds
  buffer_load_dwordx4 v29, s[28:31], s62 offen offset:3072 nt lds
  s_mov_b32 m0, 122880
  s_add_u32 s62, s33, 40960
  buffer_load_dwordx4 v28, s[28:31], s62 offen offset:0 nt lds
  buffer_load_dwordx4 v28, s[28:31], s62 offen offset:1024 nt lds
  buffer_load_dwordx4 v29, s[28:31], s62 offen offset:2048 nt lds
  buffer_load_dwordx4 v29, s[28:31], s62 offen offset:3072 nt lds
  s_mov_b32 m0, 126976
  s_add_u32 s62, s33, 45056
  buffer_load_dwordx4 v28, s[28:31], s62 offen offset:0 nt lds
  buffer_load_dwordx4 v28, s[28:31], s62 offen offset:1024 nt lds
  buffer_load_dwordx4 v29, s[28:31], s62 offen offset:2048 nt lds
  buffer_load_dwordx4 v29, s[28:31], s62 offen offset:3072 nt lds
  s_waitcnt vmcnt(16)
  s_max_u32 s44, s44, 29
  v_mov_b32 v30, s44
  ds_write_b32 v40, v30 offset:20480
  s_cmp_ge_u32 s56, 15
  s_cbranch_scc1 L_free_30
  s_mov_b32 s54, 15
  s_mov_b32 s23, 30
  s_mov_b32 s45, 29
  s_call_b64 s[60:61], L_poll
L_free_30:
  s_mov_b32 m0, 49152
  s_add_u32 s62, s33, 49152
  buffer_load_dwordx4 v24, s[24:27], s62 offen offset:0 nt lds
  buffer_load_dwordx4 v24, s[24:27], s62 offen offset:1024 nt lds
  buffer_load_dwordx4 v25, s[24:27], s62 offen offset:2048 nt lds
  buffer_load_dwordx4 v25, s[24:27], s62 offen offset:3072 nt lds
  s_mov_b32 m0, 53248
  s_add_u32 s62, s33, 53248
  buffer_load_dwordx4 v26, s[24:27], s62 offen offset:0 nt lds
  buffer_load_dwordx4 v26, s[24:27], s62 offen offset:1024 nt lds
  buffer_load_dwordx4 v27, s[24:27], s62 offen offset:2048 nt lds
  buffer_load_dwordx4 v27, s[24:27], s62 offen offset:3072 nt lds
  s_mov_b32 m0, 57344
  s_add_u32 s62, s33, 57344
  buffer_load_dwordx4 v24, s[24:27], s62 offen offset:0 nt lds
  buffer_load_dwordx4 v24, s[24:27], s62 offen offset:1024 nt lds
  buffer_load_dwordx4 v25, s[24:27], s62 offen offset:2048 nt lds
  buffer_load_dwordx4 v25, s[24:27], s62 offen offset:3072 nt lds
  s_mov_b32 m0, 61440
  s_add_u32 s62, s33, 61440
  buffer_load_dwordx4 v26, s[24:27], s62 offen offset:0 nt lds
  buffer_load_dwordx4 v26, s[24:27], s62 offen offset:1024 nt lds
  buffer_load_dwordx4 v27, s[24:27], s62 offen offset:2048 nt lds
  buffer_load_dwordx4 v27, s[24:27], s62 offen offset:3072 nt lds
  s_waitcnt vmcnt(16)
  s_max_u32 s44, s44, 30
  v_mov_b32 v30, s44
  ds_write_b32 v40, v30 offset:20480
  s_cmp_ge_u32 s56, 15
  s_cbranch_scc1 L_free_31
  s_mov_b32 s54, 15
  s_mov_b32 s23, 31
  s_mov_b32 s45, 30
  s_call_b64 s[60:61], L_poll
L_free_31:
  s_mov_b32 m0, 131072
  s_add_u32 s62, s33, 49152
  buffer_load_dwordx4 v28, s[28:31], s62 offen offset:0 nt lds
  buffer_load_dwordx4 v28, s[28:31], s62 offen offset:1024 nt lds
  buffer_load_dwordx4 v29, s[28:31], s62 offen offset:2048 nt lds
  buffer_load_dwordx4 v29, s[28:31], s62 offen offset:3072 nt lds
  s_mov_b32 m0, 135168
  s_add_u32 s62, s33, 53248
  buffer_load_dwordx4 v28, s[28:31], s62 offen offset:0 nt lds
  buffer_load_dwordx4 v28, s[28:31], s62 offen offset:1024 nt lds
  buffer_load_dwordx4 v29, s[28:31], s62 offen offset:2048 nt lds
  buffer_load_dwordx4 v29, s[28:31], s62 offen offset:3072 nt lds
  s_mov_b32 m0, 139264
  s_add_u32 s62, s33, 57344
  buffer_load_dwordx4 v28, s[28:31], s62 offen offset:0 nt lds
  buffer_load_dwordx4 v28, s[28:31], s62 offen offset:1024 nt lds
  buffer_load_dwordx4 v29, s[28:31], s62 offen offset:2048 nt lds
  buffer_load_dwordx4 v29, s[28:31], s62 offen offset:3072 nt lds
  s_mov_b32 m0, 143360
  s_add_u32 s62, s33, 61440
  buffer_load_dwordx4 v28, s[28:31], s62 offen offset:0 nt lds
  buffer_load_dwordx4 v28, s[28:31], s62 offen offset:1024 nt lds
  buffer_load_dwordx4 v29, s[28:31], s62 offen offset:2048 nt lds
  buffer_load_dwordx4 v29, s[28:31], s62 offen offset:3072 nt lds
  s_waitcnt vmcnt(16)
  s_max_u32 s44, s44, 31
  v_mov_b32 v30, s44
  ds_write_b32 v40, v30 offset:20480
  s_cmp_ge_u32 s56, 16
  s_cbranch_scc1 L_free_32
  s_mov_b32 s54, 16
  s_mov_b32 s23, 32
  s_mov_b32 s45, 31
  s_call_b64 s[60:61], L_poll
L_free_32:
  s_mov_b32 m0, 65536
  s_add_u32 s62, s33, 65536
  buffer_load_dwordx4 v24, s[24:27], s62 offen offset:0 nt lds
  buffer_load_dwordx4 v24, s[24:27], s62 offen offset:1024 nt lds
  buffer_load_dwordx4 v25, s[24:27], s62 offen offset:2048 nt lds
  buffer_load_dwordx4 v25, s[24:27], s62 offen offset:3072 nt lds
  s_mov_b32 m0, 69632
  s_add_u32 s62, s33, 69632
  buffer_load_dwordx4 v26, s[24:27], s62 offen offset:0 nt lds
  buffer_load_dwordx4 v26, s[24:27], s62 offen offset:1024 nt lds
  buffer_load_dwordx4 v27, s[24:27], s62 offen offset:2048 nt lds
  buffer_load_dwordx4 v27, s[24:27], s62 offen offset:3072 nt lds
  s_mov_b32 m0, 73728
  s_add_u32 s62, s33, 73728
  buffer_load_dwordx4 v24, s[24:27], s62 offen offset:0 nt lds
  buffer_load_dwordx4 v24, s[24:27], s62 offen offset:1024 nt lds
  buffer_load_dwordx4 v25, s[24:27], s62 offen offset:2048 nt lds
  buffer_load_dwordx4 v25, s[24:27], s62 offen offset:3072 nt lds
  s_mov_b32 m0, 77824
  s_add_u32 s62, s33, 77824
  buffer_load_dwordx4 v26, s[24:27], s62 offen offset:0 nt lds
  buffer_load_dwordx4 v26, s[24:27], s62 offen offset:1024 nt lds
  buffer_load_dwordx4 v27, s[24:27], s62 offen offset:2048 nt lds
  buffer_load_dwordx4 v27, s[24:27], s62 offen offset:3072 nt lds
  s_waitcnt vmcnt(16)
  s_max_u32 s44, s44, 32
  v_mov_b32 v30, s44
  ds_write_b32 v40, v30 offset:20480
  s_cmp_ge_u32 s56, 17
  s_cbranch_scc1 L_free_33
  s_mov_b32 s54, 17
  s_mov_b32 s23, 33
  s_mov_b32 s45, 32
  s_call_b64 s[60:61], L_poll
L_free_33:
  s_mov_b32 m0, 81920
  s_add_u32 s62, s33, 65536
  buffer_load_dwordx4 v28, s[28:31], s62 offen offset:0 nt lds
  buffer_load_dwordx4 v28, s[28:31], s62 offen offset:1024 nt lds
  buffer_load_dwordx4 v29, s[28:31], s62 offen offset:2048 nt lds
  buffer_load_dwordx4 v29, s[28:31], s62 offen offset:3072 nt lds
  s_mov_b32 m0, 86016
  s_add_u32 s62, s33, 69632
  buffer_load_dwordx4 v28, s[28:31], s62 offen offset:0 nt lds
  buffer_load_dwordx4 v28, s[28:31], s62 offen offset:1024 nt lds
  buffer_load_dwordx4 v29, s[28:31], s62 offen offset:2048 nt lds
  buffer_load_dwordx4 v29, s[28:31], s62 offen offset:3072 nt lds
  s_mov_b32 m0, 90112
  s_add_u32 s62, s33, 73728
  buffer_load_dwordx4 v28, s[28:31], s62 offen offset:0 nt lds
  buffer_load_dwordx4 v28, s[28:31], s62 offen offset:1024 nt lds
  buffer_load_dwordx4 v29, s[28:31], s62 offen offset:2048 nt lds
  buffer_load_dwordx4 v29, s[28:31], s62 offen offset:3072 nt lds
  s_mov_b32 m0, 94208
  s_add_u32 s62, s33, 77824
  buffer_load_dwordx4 v28, s[28:31], s62 offen offset:0 nt lds
  buffer_load_dwordx4 v28, s[28:31], s62 offen offset:1024 nt lds
  buffer_load_dwordx4 v29, s[28:31], s62 offen offset:2048 nt lds
  buffer_load_dwordx4 v29, s[28:31], s62 offen offset:3072 nt lds
  s_waitcnt vmcnt(16)
  s_max_u32 s44, s44, 33
  v_mov_b32 v30, s44
  ds_write_b32 v40, v30 offset:20480
  s_mov_b32 s52, 17
  s_mov_b32 s53, 0
  s_mov_b32 s55, 98304
  s_mov_b32 s57, 81920
  s_mov_b32 s58, 34
.p2align 6
L_kv:
  s_cmp_ge_u32 s56, s52
  s_cbranch_scc1 L_kvfreeK
  s_mov_b32 s54, s52
  s_mov_b32 s23, s58
  s_sub_u32 s45, s58, 1
  s_call_b64 s[60:61], L_poll
L_kvfreeK:
  s_xor_b32 s63, s57, s33
  s_add_u32 m0, s53, 0
  s_add_u32 s62, s63, 0
  buffer_load_dwordx4 v24, s[24:27], s62 offen offset:0 nt lds
  buffer_load_dwordx4 v24, s[24:27], s62 offen offset:1024 nt lds
  buffer_load_dwordx4 v25, s[24:27], s62 offen offset:2048 nt lds
  buffer_load_dwordx4 v25, s[24:27], s62 offen offset:3072 nt lds
  s_add_u32 m0, s53, 4096
  s_add_u32 s62, s63, 4096
  buffer_load_dwordx4 v26, s[24:27], s62 offen offset:0 nt lds
  buffer_load_dwordx4 v26, s[24:27], s62 offen offset:1024 nt lds
  buffer_load_dwordx4 v27, s[24:27], s62 offen offset:2048 nt lds
  buffer_load_dwordx4 v27, s[24:27], s62 offen offset:3072 nt lds
  s_add_u32 m0, s53, 8192
  s_add_u32 s62, s63, 8192
  buffer_load_dwordx4 v24, s[24:27], s62 offen offset:0 nt lds
  buffer_load_dwordx4 v24, s[24:27], s62 offen offset:1024 nt lds
  buffer_load_dwordx4 v25, s[24:27], s62 offen offset:2048 nt lds
  buffer_load_dwordx4 v25, s[24:27], s62 offen offset:3072 nt lds
  s_add_u32 m0, s53, 12288
  s_add_u32 s62, s63, 12288
  buffer_load_dwordx4 v26, s[24:27], s62 offen offset:0 nt lds
  buffer_load_dwordx4 v26, s[24:27], s62 offen offset:1024 nt lds
  buffer_load_dwordx4 v27, s[24:27], s62 offen offset:2048 nt lds
  buffer_load_dwordx4 v27, s[24:27], s62 offen offset:3072 nt lds
  s_add_u32 s53, s53, 16384
  s_cmp_eq_u32 s53, 81920
  s_cselect_b32 s53, 0, s53
  s_add_u32 s52, s52, 1
  s_waitcnt vmcnt(16)
  s_max_u32 s44, s44, s58
  v_mov_b32 v30, s44
  ds_write_b32 v40, v30 offset:20480
  s_add_u32 s58, s58, 1
  s_cmp_ge_u32 s56, s52
  s_cbranch_scc1 L_kvfreeV
  s_mov_b32 s54, s52
  s_mov_b32 s23, s58
  s_sub_u32 s45, s58, 1
  s_call_b64 s[60:61], L_poll
L_kvfreeV:
  s_xor_b32 s63, s57, s33
  s_add_u32 m0, s55, 0
  s_add_u32 s62, s63, 0
  buffer_load_dwordx4 v28, s[28:31], s62 offen offset:0 nt lds
  buffer_load_dwordx4 v28, s[28:31], s62 offen offset:1024 nt lds
  buffer_load_dwordx4 v29, s[28:31], s62 offen offset:2048 nt lds
  buffer_load_dwordx4 v29, s[28:31], s62 offen offset:3072 nt lds
  s_add_u32 m0, s55, 4096
  s_add_u32 s62, s63, 4096
  buffer_load_dwordx4 v28, s[28:31], s62 offen offset:0 nt lds
  buffer_load_dwordx4 v28, s[28:31], s62 offen offset:1024 nt lds
  buffer_load_dwordx4 v29, s[28:31], s62 offen offset:2048 nt lds
  buffer_load_dwordx4 v29, s[28:31], s62 offen offset:3072 nt lds
  s_add_u32 m0, s55, 8192
  s_add_u32 s62, s63, 8192
  buffer_load_dwordx4 v28, s[28:31], s62 offen offset:0 nt lds
  buffer_load_dwordx4 v28, s[28:31], s62 offen offset:1024 nt lds
  buffer_load_dwordx4 v29, s[28:31], s62 offen offset:2048 nt lds
  buffer_load_dwordx4 v29, s[28:31], s62 offen offset:3072 nt lds
  s_add_u32 m0, s55, 12288
  s_add_u32 s62, s63, 12288
  buffer_load_dwordx4 v28, s[28:31], s62 offen offset:0 nt lds
  buffer_load_dwordx4 v28, s[28:31], s62 offen offset:1024 nt lds
  buffer_load_dwordx4 v29, s[28:31], s62 offen offset:2048 nt lds
  buffer_load_dwordx4 v29, s[28:31], s62 offen offset:3072 nt lds
  s_add_u32 s55, s55, 16384
  s_cmp_eq_u32 s55, 147456
  s_cselect_b32 s55, 81920, s55
  s_waitcnt vmcnt(16)
  s_max_u32 s44, s44, s58
  v_mov_b32 v30, s44
  ds_write_b32 v40, v30 offset:20480
  s_add_u32 s58, s58, 1
  s_add_u32 s57, s57, 16384
  s_cmp_lt_u32 s57, 524288
  s_cbranch_scc1 L_kv
  s_cmp_ge_u32 s56, 43
  s_cbranch_scc1 L_free_88
  s_mov_b32 s54, 43
  s_mov_b32 s23, 88
  s_mov_b32 s45, 87
  s_call_b64 s[60:61], L_poll
L_free_88:
  s_add_u32 s21, s5, 0
  s_and_b32 s21, s21, 3
  s_lshl_b32 s62, s4, 2
  s_add_u32 s21, s21, s62
  s_lshl_b32 s21, s21, 1
  s_xor_b32 s62, s8, 0
  s_add_u32 s21, s21, s62
  s_lshl_b32 s21, s21, 17
  s_mov_b32 m0, 32768
  s_add_u32 s62, s21, 0
  buffer_load_dwordx4 v44, s[48:51], s62 offen offset:0 lds
  buffer_load_dwordx4 v45, s[48:51], s62 offen offset:1024 lds
  buffer_load_dwordx4 v46, s[48:51], s62 offen offset:2048 lds
  buffer_load_dwordx4 v47, s[48:51], s62 offen offset:3072 lds
  s_mov_b32 m0, 36864
  s_add_u32 s62, s21, 8192
  buffer_load_dwordx4 v44, s[48:51], s62 offen offset:0 lds
  buffer_load_dwordx4 v45, s[48:51], s62 offen offset:1024 lds
  buffer_load_dwordx4 v46, s[48:51], s62 offen offset:2048 lds
  buffer_load_dwordx4 v47, s[48:51], s62 offen offset:3072 lds
  s_mov_b32 m0, 40960
  s_add_u32 s62, s21, 32768
  buffer_load_dwordx4 v44, s[48:51], s62 offen offset:0 lds
  buffer_load_dwordx4 v45, s[48:51], s62 offen offset:1024 lds
  buffer_load_dwordx4 v46, s[48:51], s62 offen offset:2048 lds
  buffer_load_dwordx4 v47, s[48:51], s62 offen offset:3072 lds
  s_mov_b32 m0, 45056
  s_add_u32 s62, s21, 40960
  buffer_load_dwordx4 v44, s[48:51], s62 offen offset:0 lds
  buffer_load_dwordx4 v45, s[48:51], s62 offen offset:1024 lds
  buffer_load_dwordx4 v46, s[48:51], s62 offen offset:2048 lds
  buffer_load_dwordx4 v47, s[48:51], s62 offen offset:3072 lds
  s_waitcnt vmcnt(16)
  s_max_u32 s44, s44, 88
  v_mov_b32 v30, s44
  ds_write_b32 v40, v30 offset:20480
  s_cmp_ge_u32 s56, 44
  s_cbranch_scc1 L_free_89
  s_mov_b32 s54, 44
  s_mov_b32 s23, 89
  s_mov_b32 s45, 88
  s_call_b64 s[60:61], L_poll
L_free_89:
  s_add_u32 s21, s5, 0
  s_and_b32 s21, s21, 3
  s_lshl_b32 s62, s4, 2
  s_add_u32 s21, s21, s62
  s_lshl_b32 s21, s21, 1
  s_xor_b32 s62, s8, 0
  s_add_u32 s21, s21, s62
  s_lshl_b32 s21, s21, 17
  s_mov_b32 m0, 49152
  s_add_u32 s62, s21, 65536
  buffer_load_dwordx4 v44, s[48:51], s62 offen offset:0 lds
  buffer_load_dwordx4 v45, s[48:51], s62 offen offset:1024 lds
  buffer_load_dwordx4 v46, s[48:51], s62 offen offset:2048 lds
  buffer_load_dwordx4 v47, s[48:51], s62 offen offset:3072 lds
  s_mov_b32 m0, 53248
  s_add_u32 s62, s21, 73728
  buffer_load_dwordx4 v44, s[48:51], s62 offen offset:0 lds
  buffer_load_dwordx4 v45, s[48:51], s62 offen offset:1024 lds
  buffer_load_dwordx4 v46, s[48:51], s62 offen offset:2048 lds
  buffer_load_dwordx4 v47, s[48:51], s62 offen offset:3072 lds
  s_mov_b32 m0, 57344
  s_add_u32 s62, s21, 98304
  buffer_load_dwordx4 v44, s[48:51], s62 offen offset:0 lds
  buffer_load_dwordx4 v45, s[48:51], s62 offen offset:1024 lds
  buffer_load_dwordx4 v46, s[48:51], s62 offen offset:2048 lds
  buffer_load_dwordx4 v47, s[48:51], s62 offen offset:3072 lds
  s_mov_b32 m0, 61440
  s_add_u32 s62, s21, 106496
  buffer_load_dwordx4 v44, s[48:51], s62 offen offset:0 lds
  buffer_load_dwordx4 v45, s[48:51], s62 offen offset:1024 lds
  buffer_load_dwordx4 v46, s[48:51], s62 offen offset:2048 lds
  buffer_load_dwordx4 v47, s[48:51], s62 offen offset:3072 lds
  s_waitcnt vmcnt(16)
  s_max_u32 s44, s44, 89
  v_mov_b32 v30, s44
  ds_write_b32 v40, v30 offset:20480
  s_cmp_ge_u32 s56, 45
  s_cbranch_scc1 L_free_90
  s_mov_b32 s54, 45
  s_mov_b32 s23, 90
  s_mov_b32 s45, 89
  s_call_b64 s[60:61], L_poll
L_free_90:
  s_add_u32 s21, s5, 0
  s_and_b32 s21, s21, 3
  s_lshl_b32 s62, s4, 2
  s_add_u32 s21, s21, s62
  s_lshl_b32 s21, s21, 1
  s_xor_b32 s62, s8, 1
  s_add_u32 s21, s21, s62
  s_lshl_b32 s21, s21, 17
  s_mov_b32 m0, 65536
  s_add_u32 s62, s21, 0
  buffer_load_dwordx4 v44, s[48:51], s62 offen offset:0 lds
  buffer_load_dwordx4 v45, s[48:51], s62 offen offset:1024 lds
  buffer_load_dwordx4 v46, s[48:51], s62 offen offset:2048 lds
  buffer_load_dwordx4 v47, s[48:51], s62 offen offset:3072 lds
  s_mov_b32 m0, 69632
  s_add_u32 s62, s21, 8192
  buffer_load_dwordx4 v44, s[48:51], s62 offen offset:0 lds
  buffer_load_dwordx4 v45, s[48:51], s62 offen offset:1024 lds
  buffer_load_dwordx4 v46, s[48:51], s62 offen offset:2048 lds
  buffer_load_dwordx4 v47, s[48:51], s62 offen offset:3072 lds
  s_mov_b32 m0, 73728
  s_add_u32 s62, s21, 32768
  buffer_load_dwordx4 v44, s[48:51], s62 offen offset:0 lds
  buffer_load_dwordx4 v45, s[48:51], s62 offen offset:1024 lds
  buffer_load_dwordx4 v46, s[48:51], s62 offen offset:2048 lds
  buffer_load_dwordx4 v47, s[48:51], s62 offen offset:3072 lds
  s_mov_b32 m0, 77824
  s_add_u32 s62, s21, 40960
  buffer_load_dwordx4 v44, s[48:51], s62 offen offset:0 lds
  buffer_load_dwordx4 v45, s[48:51], s62 offen offset:1024 lds
  buffer_load_dwordx4 v46, s[48:51], s62 offen offset:2048 lds
  buffer_load_dwordx4 v47, s[48:51], s62 offen offset:3072 lds
  s_waitcnt vmcnt(16)
  s_max_u32 s44, s44, 90
  v_mov_b32 v30, s44
  ds_write_b32 v40, v30 offset:20480
  s_cmp_ge_u32 s56, 45
  s_cbranch_scc1 L_free_91
  s_mov_b32 s54, 45
  s_mov_b32 s23, 91
  s_mov_b32 s45, 90
  s_call_b64 s[60:61], L_poll
L_free_91:
  s_add_u32 s21, s5, 0
  s_and_b32 s21, s21, 3
  s_lshl_b32 s62, s4, 2
  s_add_u32 s21, s21, s62
  s_lshl_b32 s21, s21, 1
  s_xor_b32 s62, s8, 1
  s_add_u32 s21, s21, s62
  s_lshl_b32 s21, s21, 17
  s_mov_b32 m0, 81920
  s_add_u32 s62, s21, 65536
  buffer_load_dwordx4 v44, s[48:51], s62 offen offset:0 lds
  buffer_load_dwordx4 v45, s[48:51], s62 offen offset:1024 lds
  buffer_load_dwordx4 v46, s[48:51], s62 offen offset:2048 lds
  buffer_load_dwordx4 v47, s[48:51], s62 offen offset:3072 lds
  s_mov_b32 m0, 86016
  s_add_u32 s62, s21, 73728
  buffer_load_dwordx4 v44, s[48:51], s62 offen offset:0 lds
  buffer_load_dwordx4 v45, s[48:51], s62 offen offset:1024 lds
  buffer_load_dwordx4 v46, s[48:51], s62 offen offset:2048 lds
  buffer_load_dwordx4 v47, s[48:51], s62 offen offset:3072 lds
  s_mov_b32 m0, 90112
  s_add_u32 s62, s21, 98304
  buffer_load_dwordx4 v44, s[48:51], s62 offen offset:0 lds
  buffer_load_dwordx4 v45, s[48:51], s62 offen offset:1024 lds
  buffer_load_dwordx4 v46, s[48:51], s62 offen offset:2048 lds
  buffer_load_dwordx4 v47, s[48:51], s62 offen offset:3072 lds
  s_mov_b32 m0, 94208
  s_add_u32 s62, s21, 106496
  buffer_load_dwordx4 v44, s[48:51], s62 offen offset:0 lds
  buffer_load_dwordx4 v45, s[48:51], s62 offen offset:1024 lds
  buffer_load_dwordx4 v46, s[48:51], s62 offen offset:2048 lds
  buffer_load_dwordx4 v47, s[48:51], s62 offen offset:3072 lds
  s_waitcnt vmcnt(16)
  s_max_u32 s44, s44, 91
  v_mov_b32 v30, s44
  ds_write_b32 v40, v30 offset:20480
  s_cmp_ge_u32 s56, 46
  s_cbranch_scc1 L_free_92
  s_mov_b32 s54, 46
  s_mov_b32 s23, 92
  s_mov_b32 s45, 91
  s_call_b64 s[60:61], L_poll
L_free_92:
  s_add_u32 s21, s5, 1
  s_and_b32 s21, s21, 3
  s_lshl_b32 s62, s4, 2
  s_add_u32 s21, s21, s62
  s_lshl_b32 s21, s21, 1
  s_xor_b32 s62, s8, 0
  s_add_u32 s21, s21, s62
  s_lshl_b32 s21, s21, 17
  s_mov_b32 m0, 0
  s_add_u32 s62, s21, 0
  buffer_load_dwordx4 v44, s[48:51], s62 offen offset:0 lds
  buffer_load_dwordx4 v45, s[48:51], s62 offen offset:1024 lds
  buffer_load_dwordx4 v46, s[48:51], s62 offen offset:2048 lds
  buffer_load_dwordx4 v47, s[48:51], s62 offen offset:3072 lds
  s_mov_b32 m0, 4096
  s_add_u32 s62, s21, 8192
  buffer_load_dwordx4 v44, s[48:51], s62 offen offset:0 lds
  buffer_load_dwordx4 v45, s[48:51], s62 offen offset:1024 lds
  buffer_load_dwordx4 v46, s[48:51], s62 offen offset:2048 lds
  buffer_load_dwordx4 v47, s[48:51], s62 offen offset:3072 lds
  s_mov_b32 m0, 8192
  s_add_u32 s62, s21, 32768
  buffer_load_dwordx4 v44, s[48:51], s62 offen offset:0 lds
  buffer_load_dwordx4 v45, s[48:51], s62 offen offset:1024 lds
  buffer_load_dwordx4 v46, s[48:51], s62 offen offset:2048 lds
  buffer_load_dwordx4 v47, s[48:51], s62 offen offset:3072 lds
  s_mov_b32 m0, 12288
  s_add_u32 s62, s21, 40960
  buffer_load_dwordx4 v44, s[48:51], s62 offen offset:0 lds
  buffer_load_dwordx4 v45, s[48:51], s62 offen offset:1024 lds
  buffer_load_dwordx4 v46, s[48:51], s62 offen offset:2048 lds
  buffer_load_dwordx4 v47, s[48:51], s62 offen offset:3072 lds
  s_waitcnt vmcnt(16)
  s_max_u32 s44, s44, 92
  v_mov_b32 v30, s44
  ds_write_b32 v40, v30 offset:20480
  s_cmp_ge_u32 s56, 50
  s_cbranch_scc1 L_free_93
  s_mov_b32 s54, 50
  s_mov_b32 s23, 93
  s_mov_b32 s45, 92
  s_call_b64 s[60:61], L_poll
L_free_93:
  s_add_u32 s21, s5, 1
  s_and_b32 s21, s21, 3
  s_lshl_b32 s62, s4, 2
  s_add_u32 s21, s21, s62
  s_lshl_b32 s21, s21, 1
  s_xor_b32 s62, s8, 0
  s_add_u32 s21, s21, s62
  s_lshl_b32 s21, s21, 17
  s_mov_b32 m0, 98304
  s_add_u32 s62, s21, 65536
  buffer_load_dwordx4 v44, s[48:51], s62 offen offset:0 lds
  buffer_load_dwordx4 v45, s[48:51], s62 offen offset:1024 lds
  buffer_load_dwordx4 v46, s[48:51], s62 offen offset:2048 lds
  buffer_load_dwordx4 v47, s[48:51], s62 offen offset:3072 lds
  s_mov_b32 m0, 102400
  s_add_u32 s62, s21, 73728
  buffer_load_dwordx4 v44, s[48:51], s62 offen offset:0 lds
  buffer_load_dwordx4 v45, s[48:51], s62 offen offset:1024 lds
  buffer_load_dwordx4 v46, s[48:51], s62 offen offset:2048 lds
  buffer_load_dwordx4 v47, s[48:51], s62 offen offset:3072 lds
  s_mov_b32 m0, 106496
  s_add_u32 s62, s21, 98304
  buffer_load_dwordx4 v44, s[48:51], s62 offen offset:0 lds
  buffer_load_dwordx4 v45, s[48:51], s62 offen offset:1024 lds
  buffer_load_dwordx4 v46, s[48:51], s62 offen offset:2048 lds
  buffer_load_dwordx4 v47, s[48:51], s62 offen offset:3072 lds
  s_mov_b32 m0, 110592
  s_add_u32 s62, s21, 106496
  buffer_load_dwordx4 v44, s[48:51], s62 offen offset:0 lds
  buffer_load_dwordx4 v45, s[48:51], s62 offen offset:1024 lds
  buffer_load_dwordx4 v46, s[48:51], s62 offen offset:2048 lds
  buffer_load_dwordx4 v47, s[48:51], s62 offen offset:3072 lds
  s_waitcnt vmcnt(16)
  s_max_u32 s44, s44, 93
  v_mov_b32 v30, s44
  ds_write_b32 v40, v30 offset:20480
  s_cmp_ge_u32 s56, 51
  s_cbranch_scc1 L_free_94
  s_mov_b32 s54, 51
  s_mov_b32 s23, 94
  s_mov_b32 s45, 93
  s_call_b64 s[60:61], L_poll
L_free_94:
  s_add_u32 s21, s5, 2
  s_and_b32 s21, s21, 3
  s_lshl_b32 s62, s4, 2
  s_add_u32 s21, s21, s62
  s_lshl_b32 s21, s21, 1
  s_xor_b32 s62, s8, 0
  s_add_u32 s21, s21, s62
  s_lshl_b32 s21, s21, 17
  s_mov_b32 m0, 16384
  s_add_u32 s62, s21, 0
  buffer_load_dwordx4 v44, s[48:51], s62 offen offset:0 lds
  buffer_load_dwordx4 v45, s[48:51], s62 offen offset:1024 lds
  buffer_load_dwordx4 v46, s[48:51], s62 offen offset:2048 lds
  buffer_load_dwordx4 v47, s[48:51], s62 offen offset:3072 lds
  s_mov_b32 m0, 20480
  s_add_u32 s62, s21, 8192
  buffer_load_dwordx4 v44, s[48:51], s62 offen offset:0 lds
  buffer_load_dwordx4 v45, s[48:51], s62 offen offset:1024 lds
  buffer_load_dwordx4 v46, s[48:51], s62 offen offset:2048 lds
  buffer_load_dwordx4 v47, s[48:51], s62 offen offset:3072 lds
  s_mov_b32 m0, 24576
  s_add_u32 s62, s21, 32768
  buffer_load_dwordx4 v44, s[48:51], s62 offen offset:0 lds
  buffer_load_dwordx4 v45, s[48:51], s62 offen offset:1024 lds
  buffer_load_dwordx4 v46, s[48:51], s62 offen offset:2048 lds
  buffer_load_dwordx4 v47, s[48:51], s62 offen offset:3072 lds
  s_mov_b32 m0, 28672
  s_add_u32 s62, s21, 40960
  buffer_load_dwordx4 v44, s[48:51], s62 offen offset:0 lds
  buffer_load_dwordx4 v45, s[48:51], s62 offen offset:1024 lds
  buffer_load_dwordx4 v46, s[48:51], s62 offen offset:2048 lds
  buffer_load_dwordx4 v47, s[48:51], s62 offen offset:3072 lds
  s_waitcnt vmcnt(16)
  s_max_u32 s44, s44, 94
  v_mov_b32 v30, s44
  ds_write_b32 v40, v30 offset:20480
  s_cmp_ge_u32 s56, 52
  s_cbranch_scc1 L_free_95
  s_mov_b32 s54, 52
  s_mov_b32 s23, 95
  s_mov_b32 s45, 94
  s_call_b64 s[60:61], L_poll
L_free_95:
  s_add_u32 s21, s5, 2
  s_and_b32 s21, s21, 3
  s_lshl_b32 s62, s4, 2
  s_add_u32 s21, s21, s62
  s_lshl_b32 s21, s21, 1
  s_xor_b32 s62, s8, 0
  s_add_u32 s21, s21, s62
  s_lshl_b32 s21, s21, 17
  s_mov_b32 m0, 114688
  s_add_u32 s62, s21, 65536
  buffer_load_dwordx4 v44, s[48:51], s62 offen offset:0 lds
  buffer_load_dwordx4 v45, s[48:51], s62 offen offset:1024 lds
  buffer_load_dwordx4 v46, s[48:51], s62 offen offset:2048 lds
  buffer_load_dwordx4 v47, s[48:51], s62 offen offset:3072 lds
  s_mov_b32 m0, 118784
  s_add_u32 s62, s21, 73728
  buffer_load_dwordx4 v44, s[48:51], s62 offen offset:0 lds
  buffer_load_dwordx4 v45, s[48:51], s62 offen offset:1024 lds
  buffer_load_dwordx4 v46, s[48:51], s62 offen offset:2048 lds
  buffer_load_dwordx4 v47, s[48:51], s62 offen offset:3072 lds
  s_mov_b32 m0, 122880
  s_add_u32 s62, s21, 98304
  buffer_load_dwordx4 v44, s[48:51], s62 offen offset:0 lds
  buffer_load_dwordx4 v45, s[48:51], s62 offen offset:1024 lds
  buffer_load_dwordx4 v46, s[48:51], s62 offen offset:2048 lds
  buffer_load_dwordx4 v47, s[48:51], s62 offen offset:3072 lds
  s_mov_b32 m0, 126976
  s_add_u32 s62, s21, 106496
  buffer_load_dwordx4 v44, s[48:51], s62 offen offset:0 lds
  buffer_load_dwordx4 v45, s[48:51], s62 offen offset:1024 lds
  buffer_load_dwordx4 v46, s[48:51], s62 offen offset:2048 lds
  buffer_load_dwordx4 v47, s[48:51], s62 offen offset:3072 lds
  s_waitcnt vmcnt(16)
  s_max_u32 s44, s44, 95
  v_mov_b32 v30, s44
  ds_write_b32 v40, v30 offset:20480
  s_cmp_ge_u32 s56, 53
  s_cbranch_scc1 L_free_96
  s_mov_b32 s54, 53
  s_mov_b32 s23, 96
  s_mov_b32 s45, 95
  s_call_b64 s[60:61], L_poll
L_free_96:
  s_add_u32 s21, s5, 3
  s_and_b32 s21, s21, 3
  s_lshl_b32 s62, s4, 2
  s_add_u32 s21, s21, s62
  s_lshl_b32 s21, s21, 1
  s_xor_b32 s62, s8, 0
  s_add_u32 s21, s21, s62
  s_lshl_b32 s21, s21, 17
  s_mov_b32 m0, 131072
  s_add_u32 s62, s21, 0
  buffer_load_dwordx4 v44, s[48:51], s62 offen offset:0 lds
  buffer_load_dwordx4 v45, s[48:51], s62 offen offset:1024 lds
  buffer_load_dwordx4 v46, s[48:51], s62 offen offset:2048 lds
  buffer_load_dwordx4 v47, s[48:51], s62 offen offset:3072 lds
  s_mov_b32 m0, 135168
  s_add_u32 s62, s21, 8192
  buffer_load_dwordx4 v44, s[48:51], s62 offen offset:0 lds
  buffer_load_dwordx4 v45, s[48:51], s62 offen offset:1024 lds
  buffer_load_dwordx4 v46, s[48:51], s62 offen offset:2048 lds
  buffer_load_dwordx4 v47, s[48:51], s62 offen offset:3072 lds
  s_mov_b32 m0, 139264
  s_add_u32 s62, s21, 32768
  buffer_load_dwordx4 v44, s[48:51], s62 offen offset:0 lds
  buffer_load_dwordx4 v45, s[48:51], s62 offen offset:1024 lds
  buffer_load_dwordx4 v46, s[48:51], s62 offen offset:2048 lds
  buffer_load_dwordx4 v47, s[48:51], s62 offen offset:3072 lds
  s_mov_b32 m0, 143360
  s_add_u32 s62, s21, 40960
  buffer_load_dwordx4 v44, s[48:51], s62 offen offset:0 lds
  buffer_load_dwordx4 v45, s[48:51], s62 offen offset:1024 lds
  buffer_load_dwordx4 v46, s[48:51], s62 offen offset:2048 lds
  buffer_load_dwordx4 v47, s[48:51], s62 offen offset:3072 lds
  s_waitcnt vmcnt(16)
  s_max_u32 s44, s44, 96
  v_mov_b32 v30, s44
  ds_write_b32 v40, v30 offset:20480
  s_cmp_ge_u32 s56, 49
  s_cbranch_scc1 L_free_97
  s_mov_b32 s54, 49
  s_mov_b32 s23, 97
  s_mov_b32 s45, 96
  s_call_b64 s[60:61], L_poll
L_free_97:
  s_add_u32 s21, s5, 3
  s_and_b32 s21, s21, 3
  s_lshl_b32 s62, s4, 2
  s_add_u32 s21, s21, s62
  s_lshl_b32 s21, s21, 1
  s_xor_b32 s62, s8, 0
  s_add_u32 s21, s21, s62
  s_lshl_b32 s21, s21, 17
  s_mov_b32 m0, 32768
  s_add_u32 s62, s21, 65536
  buffer_load_dwordx4 v44, s[48:51], s62 offen offset:0 lds
  buffer_load_dwordx4 v45, s[48:51], s62 offen offset:1024 lds
  buffer_load_dwordx4 v46, s[48:51], s62 offen offset:2048 lds
  buffer_load_dwordx4 v47, s[48:51], s62 offen offset:3072 lds
  s_mov_b32 m0, 36864
  s_add_u32 s62, s21, 73728
  buffer_load_dwordx4 v44, s[48:51], s62 offen offset:0 lds
  buffer_load_dwordx4 v45, s[48:51], s62 offen offset:1024 lds
  buffer_load_dwordx4 v46, s[48:51], s62 offen offset:2048 lds
  buffer_load_dwordx4 v47, s[48:51], s62 offen offset:3072 lds
  s_mov_b32 m0, 40960
  s_add_u32 s62, s21, 98304
  buffer_load_dwordx4 v44, s[48:51], s62 offen offset:0 lds
  buffer_load_dwordx4 v45, s[48:51], s62 offen offset:1024 lds
  buffer_load_dwordx4 v46, s[48:51], s62 offen offset:2048 lds
  buffer_load_dwordx4 v47, s[48:51], s62 offen offset:3072 lds
  s_mov_b32 m0, 45056
  s_add_u32 s62, s21, 106496
  buffer_load_dwordx4 v44, s[48:51], s62 offen offset:0 lds
  buffer_load_dwordx4 v45, s[48:51], s62 offen offset:1024 lds
  buffer_load_dwordx4 v46, s[48:51], s62 offen offset:2048 lds
  buffer_load_dwordx4 v47, s[48:51], s62 offen offset:3072 lds
  s_waitcnt vmcnt(16)
  s_max_u32 s44, s44, 97
  v_mov_b32 v30, s44
  ds_write_b32 v40, v30 offset:20480
  s_cmp_ge_u32 s56, 50
  s_cbranch_scc1 L_free_98
  s_mov_b32 s54, 50
  s_mov_b32 s23, 98
  s_mov_b32 s45, 97
  s_call_b64 s[60:61], L_poll
L_free_98:
  s_add_u32 s21, s5, 1
  s_and_b32 s21, s21, 3
  s_lshl_b32 s62, s4, 2
  s_add_u32 s21, s21, s62
  s_lshl_b32 s21, s21, 1
  s_xor_b32 s62, s8, 1
  s_add_u32 s21, s21, s62
  s_lshl_b32 s21, s21, 17
  s_mov_b32 m0, 49152
  s_add_u32 s62, s21, 0
  buffer_load_dwordx4 v44, s[48:51], s62 offen offset:0 lds
  buffer_load_dwordx4 v45, s[48:51], s62 offen offset:1024 lds
  buffer_load_dwordx4 v46, s[48:51], s62 offen offset:2048 lds
  buffer_load_dwordx4 v47, s[48:51], s62 offen offset:3072 lds
  s_mov_b32 m0, 53248
  s_add_u32 s62, s21, 8192
  buffer_load_dwordx4 v44, s[48:51], s62 offen offset:0 lds
  buffer_load_dwordx4 v45, s[48:51], s62 offen offset:1024 lds
  buffer_load_dwordx4 v46, s[48:51], s62 offen offset:2048 lds
  buffer_load_dwordx4 v47, s[48:51], s62 offen offset:3072 lds
  s_mov_b32 m0, 57344
  s_add_u32 s62, s21, 32768
  buffer_load_dwordx4 v44, s[48:51], s62 offen offset:0 lds
  buffer_load_dwordx4 v45, s[48:51], s62 offen offset:1024 lds
  buffer_load_dwordx4 v46, s[48:51], s62 offen offset:2048 lds
  buffer_load_dwordx4 v47, s[48:51], s62 offen offset:3072 lds
  s_mov_b32 m0, 61440
  s_add_u32 s62, s21, 40960
  buffer_load_dwordx4 v44, s[48:51], s62 offen offset:0 lds
  buffer_load_dwordx4 v45, s[48:51], s62 offen offset:1024 lds
  buffer_load_dwordx4 v46, s[48:51], s62 offen offset:2048 lds
  buffer_load_dwordx4 v47, s[48:51], s62 offen offset:3072 lds
  s_waitcnt vmcnt(16)
  s_max_u32 s44, s44, 98
  v_mov_b32 v30, s44
  ds_write_b32 v40, v30 offset:20480
  s_cmp_ge_u32 s56, 51
  s_cbranch_scc1 L_free_99
  s_mov_b32 s54, 51
  s_mov_b32 s23, 99
  s_mov_b32 s45, 98
  s_call_b64 s[60:61], L_poll
L_free_99:
  s_add_u32 s21, s5, 1
  s_and_b32 s21, s21, 3
  s_lshl_b32 s62, s4, 2
  s_add_u32 s21, s21, s62
  s_lshl_b32 s21, s21, 1
  s_xor_b32 s62, s8, 1
  s_add_u32 s21, s21, s62
  s_lshl_b32 s21, s21, 17
  s_mov_b32 m0, 65536
  s_add_u32 s62, s21, 65536
  buffer_load_dwordx4 v44, s[48:51], s62 offen offset:0 lds
  buffer_load_dwordx4 v45, s[48:51], s62 offen offset:1024 lds
  buffer_load_dwordx4 v46, s[48:51], s62 offen offset:2048 lds
  buffer_load_dwordx4 v47, s[48:51], s62 offen offset:3072 lds
  s_mov_b32 m0, 69632
  s_add_u32 s62, s21, 73728
  buffer_load_dwordx4 v44, s[48:51], s62 offen offset:0 lds
  buffer_load_dwordx4 v45, s[48:51], s62 offen offset:1024 lds
  buffer_load_dwordx4 v46, s[48:51], s62 offen offset:2048 lds
  buffer_load_dwordx4 v47, s[48:51], s62 offen offset:3072 lds
  s_mov_b32 m0, 73728
  s_add_u32 s62, s21, 98304
  buffer_load_dwordx4 v44, s[48:51], s62 offen offset:0 lds
  buffer_load_dwordx4 v45, s[48:51], s62 offen offset:1024 lds
  buffer_load_dwordx4 v46, s[48:51], s62 offen offset:2048 lds
  buffer_load_dwordx4 v47, s[48:51], s62 offen offset:3072 lds
  s_mov_b32 m0, 77824
  s_add_u32 s62, s21, 106496
  buffer_load_dwordx4 v44, s[48:51], s62 offen offset:0 lds
  buffer_load_dwordx4 v45, s[48:51], s62 offen offset:1024 lds
  buffer_load_dwordx4 v46, s[48:51], s62 offen offset:2048 lds
  buffer_load_dwordx4 v47, s[48:51], s62 offen offset:3072 lds
  s_waitcnt vmcnt(16)
  s_max_u32 s44, s44, 99
  v_mov_b32 v30, s44
  ds_write_b32 v40, v30 offset:20480
  s_cmp_ge_u32 s56, 52
  s_cbranch_scc1 L_free_100
  s_mov_b32 s54, 52
  s_mov_b32 s23, 100
  s_mov_b32 s45, 99
  s_call_b64 s[60:61], L_poll
L_free_100:
  s_add_u32 s21, s5, 2
  s_and_b32 s21, s21, 3
  s_lshl_b32 s62, s4, 2
  s_add_u32 s21, s21, s62
  s_lshl_b32 s21, s21, 1
  s_xor_b32 s62, s8, 1
  s_add_u32 s21, s21, s62
  s_lshl_b32 s21, s21, 17
  s_mov_b32 m0, 81920
  s_add_u32 s62, s21, 0
  buffer_load_dwordx4 v44, s[48:51], s62 offen offset:0 lds
  buffer_load_dwordx4 v45, s[48:51], s62 offen offset:1024 lds
  buffer_load_dwordx4 v46, s[48:51], s62 offen offset:2048 lds
  buffer_load_dwordx4 v47, s[48:51], s62 offen offset:3072 lds
  s_mov_b32 m0, 86016
  s_add_u32 s62, s21, 8192
  buffer_load_dwordx4 v44, s[48:51], s62 offen offset:0 lds
  buffer_load_dwordx4 v45, s[48:51], s62 offen offset:1024 lds
  buffer_load_dwordx4 v46, s[48:51], s62 offen offset:2048 lds
  buffer_load_dwordx4 v47, s[48:51], s62 offen offset:3072 lds
  s_mov_b32 m0, 90112
  s_add_u32 s62, s21, 32768
  buffer_load_dwordx4 v44, s[48:51], s62 offen offset:0 lds
  buffer_load_dwordx4 v45, s[48:51], s62 offen offset:1024 lds
  buffer_load_dwordx4 v46, s[48:51], s62 offen offset:2048 lds
  buffer_load_dwordx4 v47, s[48:51], s62 offen offset:3072 lds
  s_mov_b32 m0, 94208
  s_add_u32 s62, s21, 40960
  buffer_load_dwordx4 v44, s[48:51], s62 offen offset:0 lds
  buffer_load_dwordx4 v45, s[48:51], s62 offen offset:1024 lds
  buffer_load_dwordx4 v46, s[48:51], s62 offen offset:2048 lds
  buffer_load_dwordx4 v47, s[48:51], s62 offen offset:3072 lds
  s_waitcnt vmcnt(16)
  s_max_u32 s44, s44, 100
  v_mov_b32 v30, s44
  ds_write_b32 v40, v30 offset:20480
  s_cmp_ge_u32 s56, 53
  s_cbranch_scc1 L_free_101
  s_mov_b32 s54, 53
  s_mov_b32 s23, 101
  s_mov_b32 s45, 100
  s_call_b64 s[60:61], L_poll
L_free_101:
  s_add_u32 s21, s5, 2
  s_and_b32 s21, s21, 3
  s_lshl_b32 s62, s4, 2
  s_add_u32 s21, s21, s62
  s_lshl_b32 s21, s21, 1
  s_xor_b32 s62, s8, 1
  s_add_u32 s21, s21, s62
  s_lshl_b32 s21, s21, 17
  s_mov_b32 m0, 0
  s_add_u32 s62, s21, 65536
  buffer_load_dwordx4 v44, s[48:51], s62 offen offset:0 lds
  buffer_load_dwordx4 v45, s[48:51], s62 offen offset:1024 lds
  buffer_load_dwordx4 v46, s[48:51], s62 offen offset:2048 lds
  buffer_load_dwordx4 v47, s[48:51], s62 offen offset:3072 lds
  s_mov_b32 m0, 4096
  s_add_u32 s62, s21, 73728
  buffer_load_dwordx4 v44, s[48:51], s62 offen offset:0 lds
  buffer_load_dwordx4 v45, s[48:51], s62 offen offset:1024 lds
  buffer_load_dwordx4 v46, s[48:51], s62 offen offset:2048 lds
  buffer_load_dwordx4 v47, s[48:51], s62 offen offset:3072 lds
  s_mov_b32 m0, 8192
  s_add_u32 s62, s21, 98304
  buffer_load_dwordx4 v44, s[48:51], s62 offen offset:0 lds
  buffer_load_dwordx4 v45, s[48:51], s62 offen offset:1024 lds
  buffer_load_dwordx4 v46, s[48:51], s62 offen offset:2048 lds
  buffer_load_dwordx4 v47, s[48:51], s62 offen offset:3072 lds
  s_mov_b32 m0, 12288
  s_add_u32 s62, s21, 106496
  buffer_load_dwordx4 v44, s[48:51], s62 offen offset:0 lds
  buffer_load_dwordx4 v45, s[48:51], s62 offen offset:1024 lds
  buffer_load_dwordx4 v46, s[48:51], s62 offen offset:2048 lds
  buffer_load_dwordx4 v47, s[48:51], s62 offen offset:3072 lds
  s_waitcnt vmcnt(16)
  s_max_u32 s44, s44, 101
  v_mov_b32 v30, s44
  ds_write_b32 v40, v30 offset:20480
  s_cmp_ge_u32 s56, 54
  s_cbranch_scc1 L_free_102
  s_mov_b32 s54, 54
  s_mov_b32 s23, 102
  s_mov_b32 s45, 101
  s_call_b64 s[60:61], L_poll
L_free_102:
  s_add_u32 s21, s5, 3
  s_and_b32 s21, s21, 3
  s_lshl_b32 s62, s4, 2
  s_add_u32 s21, s21, s62
  s_lshl_b32 s21, s21, 1
  s_xor_b32 s62, s8, 1
  s_add_u32 s21, s21, s62
  s_lshl_b32 s21, s21, 17
  s_mov_b32 m0, 98304
  s_add_u32 s62, s21, 0
  buffer_load_dwordx4 v44, s[48:51], s62 offen offset:0 lds
  buffer_load_dwordx4 v45, s[48:51], s62 offen offset:1024 lds
  buffer_load_dwordx4 v46, s[48:51], s62 offen offset:2048 lds
  buffer_load_dwordx4 v47, s[48:51], s62 offen offset:3072 lds
  s_mov_b32 m0, 102400
  s_add_u32 s62, s21, 8192
  buffer_load_dwordx4 v44, s[48:51], s62 offen offset:0 lds
  buffer_load_dwordx4 v45, s[48:51], s62 offen offset:1024 lds
  buffer_load_dwordx4 v46, s[48:51], s62 offen offset:2048 lds
  buffer_load_dwordx4 v47, s[48:51], s62 offen offset:3072 lds
  s_mov_b32 m0, 106496
  s_add_u32 s62, s21, 32768
  buffer_load_dwordx4 v44, s[48:51], s62 offen offset:0 lds
  buffer_load_dwordx4 v45, s[48:51], s62 offen offset:1024 lds
  buffer_load_dwordx4 v46, s[48:51], s62 offen offset:2048 lds
  buffer_load_dwordx4 v47, s[48:51], s62 offen offset:3072 lds
  s_mov_b32 m0, 110592
  s_add_u32 s62, s21, 40960
  buffer_load_dwordx4 v44, s[48:51], s62 offen offset:0 lds
  buffer_load_dwordx4 v45, s[48:51], s62 offen offset:1024 lds
  buffer_load_dwordx4 v46, s[48:51], s62 offen offset:2048 lds
  buffer_load_dwordx4 v47, s[48:51], s62 offen offset:3072 lds
  s_waitcnt vmcnt(16)
  s_max_u32 s44, s44, 102
  v_mov_b32 v30, s44
  ds_write_b32 v40, v30 offset:20480
  s_cmp_ge_u32 s56, 55
  s_cbranch_scc1 L_free_103
  s_mov_b32 s54, 55
  s_mov_b32 s23, 103
  s_mov_b32 s45, 102
  s_call_b64 s[60:61], L_poll
L_free_103:
  s_add_u32 s21, s5, 3
  s_and_b32 s21, s21, 3
  s_lshl_b32 s62, s4, 2
  s_add_u32 s21, s21, s62
  s_lshl_b32 s21, s21, 1
  s_xor_b32 s62, s8, 1
  s_add_u32 s21, s21, s62
  s_lshl_b32 s21, s21, 17
  s_mov_b32 m0, 16384
  s_add_u32 s62, s21, 65536
  buffer_load_dwordx4 v44, s[48:51], s62 offen offset:0 lds
  buffer_load_dwordx4 v45, s[48:51], s62 offen offset:1024 lds
  buffer_load_dwordx4 v46, s[48:51], s62 offen offset:2048 lds
  buffer_load_dwordx4 v47, s[48:51], s62 offen offset:3072 lds
  s_mov_b32 m0, 20480
  s_add_u32 s62, s21, 73728
  buffer_load_dwordx4 v44, s[48:51], s62 offen offset:0 lds
  buffer_load_dwordx4 v45, s[48:51], s62 offen offset:1024 lds
  buffer_load_dwordx4 v46, s[48:51], s62 offen offset:2048 lds
  buffer_load_dwordx4 v47, s[48:51], s62 offen offset:3072 lds
  s_mov_b32 m0, 24576
  s_add_u32 s62, s21, 98304
  buffer_load_dwordx4 v44, s[48:51], s62 offen offset:0 lds
  buffer_load_dwordx4 v45, s[48:51], s62 offen offset:1024 lds
  buffer_load_dwordx4 v46, s[48:51], s62 offen offset:2048 lds
  buffer_load_dwordx4 v47, s[48:51], s62 offen offset:3072 lds
  s_mov_b32 m0, 28672
  s_add_u32 s62, s21, 106496
  buffer_load_dwordx4 v44, s[48:51], s62 offen offset:0 lds
  buffer_load_dwordx4 v45, s[48:51], s62 offen offset:1024 lds
  buffer_load_dwordx4 v46, s[48:51], s62 offen offset:2048 lds
  buffer_load_dwordx4 v47, s[48:51], s62 offen offset:3072 lds
  s_waitcnt vmcnt(16)
  s_max_u32 s44, s44, 103
  v_mov_b32 v30, s44
  ds_write_b32 v40, v30 offset:20480
  s_waitcnt vmcnt(0)
  s_max_u32 s44, s44, 104
  v_mov_b32 v30, s44
  ds_write_b32 v40, v30 offset:20480
  s_branch L_k1_end
L_poll:
  ds_read_b128 v[32:35], v40 offset:20496
  s_waitcnt lgkmcnt(0)
  v_min3_u32 v32, v32, v33, v34
  s_nop 0
  v_readfirstlane_b32 s56, v32
  s_nop 1
  s_cmp_ge_u32 s56, s54
  s_cbranch_scc1 L_poll_ret
  s_waitcnt vmcnt(16)
  s_max_u32 s44, s44, s45
  v_mov_b32 v30, s44
  ds_write_b32 v40, v30 offset:20480
  ds_read_b128 v[32:35], v40 offset:20496
  s_waitcnt lgkmcnt(0)
  v_min3_u32 v32, v32, v33, v34
  s_nop 0
  v_readfirstlane_b32 s56, v32
  s_nop 1
  s_cmp_ge_u32 s56, s54
  s_cbranch_scc1 L_poll_ret
  s_waitcnt vmcnt(0)
  s_max_u32 s44, s44, s23
  v_mov_b32 v30, s44
  ds_write_b32 v40, v30 offset:20480
L_poll_spin:
  s_sleep 2
  s_add_u32 s32, s32, 1
  s_cmp_gt_u32 s32, 4194304
  s_cbranch_scc1 L_k1_end
  ds_read_b128 v[32:35], v40 offset:20496
  s_waitcnt lgkmcnt(0)
  v_min3_u32 v32, v32, v33, v34
  s_nop 0
  v_readfirstlane_b32 s56, v32
  s_nop 1
  s_cmp_ge_u32 s56, s54
  s_cbranch_scc0 L_poll_spin
L_poll_ret:
  s_setpc_b64 s[60:61]
L_k1_end:
  s_endpgm
.section .rodata,"a"
.p2align 6
.amdhsa_kernel concat_heads__gqa_block_cached__gqa_block_cached__near_ridge_kernel
  .amdhsa_next_free_vgpr 512
  .amdhsa_next_free_sgpr 102
  .amdhsa_accum_offset 256
  .amdhsa_group_segment_fixed_size 0
  .amdhsa_kernarg_size 104
  .amdhsa_user_sgpr_count 2
  .amdhsa_user_sgpr_kernarg_segment_ptr 1
  .amdhsa_system_sgpr_workgroup_id_x 1
.end_amdhsa_kernel
```
